```python
import torch

def _softmax(x, axis=-1):
    return torch.softmax(x, dim=axis)
def _gelu(x):
    return torch.nn.functional.gelu(x, approximate="tanh")
def _silu(x):
    return torch.nn.functional.silu(x)
def _sigmoid(x):
    return torch.sigmoid(x)
def _layernorm(x, axis=-1, eps=1e-5):
    m = x.mean(dim=axis, keepdim=True)
    v = x.var(dim=axis, keepdim=True, unbiased=False)
    return (x - m) / torch.sqrt(v + eps)
def _scatter_add(tgt, idx, src, axis=0):
    return tgt.clone().index_add_(axis, idx, src)
def _segment_sum(src, seg, n):
    out = torch.zeros((n,) + src.shape[1:], dtype=src.dtype)
    return out.index_add_(0, seg, src)
def _pad(x, pw):
    flat = tuple(v for pair in reversed(pw) for v in pair)
    return torch.nn.functional.pad(x, flat)

kernel_name = 'parallel_sum__ssm_conv_s5__geglu_ffn__prompt'

def setup_inputs():

    _w = (lambda a: (lambda t: t.to(torch.bfloat16) if t.is_floating_point() else t)(torch.as_tensor(a)))
    def _A_setup():
        B, S, D = 1, 2048, 1024
        P = D
        Lambda_re = -0.5 * (lambda _x: torch.exp(torch.as_tensor(_x)))((lambda *s: torch.randn(*s, dtype=torch.bfloat16) * 0.8)(P))
        Lambda_im = (lambda *s: torch.randn(*s, dtype=torch.bfloat16) * 0.8)(P) * 1.0
        B_re = (lambda *s: torch.randn(*s, dtype=torch.bfloat16) * 1.6)(P, D) * (D ** -0.5)
        B_im = (lambda *s: torch.randn(*s, dtype=torch.bfloat16) * 1.6)(P, D) * (D ** -0.5)
        C_re = (lambda *s: torch.randn(*s, dtype=torch.bfloat16) * 1.6)(D, P) * (P ** -0.5)
        C_im = (lambda *s: torch.randn(*s, dtype=torch.bfloat16) * 1.6)(D, P) * (P ** -0.5)
        log_dt = (lambda *s: torch.randn(*s, dtype=torch.bfloat16) * 0.8)(P) * 0.3 - 2.0
        Dskip = (lambda *s: torch.randn(*s, dtype=torch.bfloat16) * 0.4)(D)
        return {
            "x": _w((lambda *s: torch.randn(*s, dtype=torch.bfloat16) * 0.05)(B, S, D)),
            "Lambda_re": _w(Lambda_re),
            "Lambda_im": _w(Lambda_im),
            "B_re": _w(B_re),
            "B_im": _w(B_im),
            "C_re": _w(C_re),
            "C_im": _w(C_im),
            "log_dt": _w(log_dt),
            "Dskip": _w(Dskip),
        }
    _A_in = _A_setup()

    def _B_setup():
        B, S, D, F = 1, 2048, 1024, 3584
        return {
            "x": _w((lambda *s: torch.randn(*s, dtype=torch.bfloat16) * 0.05)(B, S, D)),
            "w_gate": _w((lambda *s: torch.randn(*s, dtype=torch.bfloat16) * 0.05)(D, F)),
            "w_up": _w((lambda *s: torch.randn(*s, dtype=torch.bfloat16) * 0.05)(D, F)),
            "w_down": _w((lambda *s: torch.randn(*s, dtype=torch.bfloat16) * 0.05)(F, D)),
        }
    _B_in = _B_setup()

    return {
        "A_x": _A_in["x"],
        "A_Lambda_re": _A_in["Lambda_re"],
        "A_Lambda_im": _A_in["Lambda_im"],
        "A_B_re": _A_in["B_re"],
        "A_B_im": _A_in["B_im"],
        "A_C_re": _A_in["C_re"],
        "A_C_im": _A_in["C_im"],
        "A_log_dt": _A_in["log_dt"],
        "A_Dskip": _A_in["Dskip"],
        "B_x": _B_in["x"],
        "B_w_gate": _B_in["w_gate"],
        "B_w_up": _B_in["w_up"],
        "B_w_down": _B_in["w_down"],
    }

def reference(A_x, A_Lambda_re, A_Lambda_im, A_B_re, A_B_im, A_C_re, A_C_im, A_log_dt, A_Dskip, B_x, B_w_gate, B_w_up, B_w_down):
    def _A_ref(x, Lambda_re, Lambda_im, B_re, B_im, C_re, C_im, log_dt, Dskip):
        Bsz, L, H = x.shape
        Lam = Lambda_re + 1j * Lambda_im
        Bmat = B_re + 1j * B_im
        Cmat = C_re + 1j * C_im
        dt = torch.exp(log_dt)
        Lam_bar = torch.exp(dt * Lam)
        B_bar = ((Lam_bar - 1.0) / Lam)[:, None] * Bmat
        Bu = torch.einsum("bld,pd->blp", x + 0j, B_bar)
        h = torch.zeros_like(Bu[:, 0, :])
        hs = []
        for t in range(L):
            h = Lam_bar[None, :] * h + Bu[:, t, :]
            hs.append(h)
        hseq = torch.stack(hs, 1)
        y = 2.0 * torch.einsum("blp,dp->bld", hseq, Cmat).real + x * Dskip[None, None, :]
        return y

    def _B_ref(x, w_gate, w_up, w_down):
        return (_gelu(x @ w_gate) * (x @ w_up)) @ w_down

    x = A_x
    xn = _layernorm(x, axis=-1)
    return x + _A_ref(xn, A_Lambda_re, A_Lambda_im, A_B_re, A_B_im, A_C_re, A_C_im, A_log_dt, A_Dskip) + _B_ref(xn, B_w_gate, B_w_up, B_w_down)
```

```asm
; @launch kernel=parallel_sum__ssm_conv_s5__geglu_ffn__prompt_kernel grid=(256,1,1) block=(256,1,1) lds=163840
.amdgcn_target "amdgcn-amd-amdhsa--gfx950"
.text
.globl parallel_sum__ssm_conv_s5__geglu_ffn__prompt_kernel
.p2align 8
.type parallel_sum__ssm_conv_s5__geglu_ffn__prompt_kernel,@function
parallel_sum__ssm_conv_s5__geglu_ffn__prompt_kernel:
    s_cmp_ge_u32 s2, 256
    s_cbranch_scc1 LF_end
    s_nop 0
    s_load_dwordx2 s[44:45], s[0:1], 0
    s_load_dwordx8 s[24:31], s[0:1], 80
    s_load_dwordx8 s[32:39], s[0:1], 8
    s_load_dwordx8 s[16:23], s[0:1], 40
    s_load_dwordx2 s[76:77], s[0:1], 120
    v_lshrrev_b32 v64, 6, v0
    v_and_b32 v1, 63, v0
    v_readfirstlane_b32 s48, v64
    v_lshlrev_b32 v2, 4, v1
    s_getpc_b64 s[82:83]
LF_pc0:
    s_lshr_b32 s81, s2, 3
    s_lshl_b32 s81, s81, 11
    v_lshrrev_b32 v64, 4, v0
    v_lshl_add_u32 v64, v64, 7, s81
    v_min_u32 v64, LF_end-LF_pc0, v64
    v_add_co_u32 v64, vcc, s82, v64
    v_mov_b32 v65, s83
    s_and_b32 s53, s2, 3
    v_addc_co_u32 v65, vcc, 0, v65, vcc
    global_load_dword v0, v[64:65], off
    s_bfe_u32 s54, s2, 0x30003
    s_and_b32 s51, s2, 4
    s_lshr_b32 s81, s2, 6
    s_add_u32 s51, s51, s81
    s_lshl_b32 s50, s53, 3
    s_add_u32 s50, s50, s54
    s_lshl_b32 s49, s51, 2
    s_add_u32 s49, s49, s48
    s_and_b32 s81, s48, 1
    s_lshr_b32 s82, s2, 2
    s_lshl_b32 s82, s82, 1
    s_add_u32 s81, s81, s82
    s_lshl_b32 s82, s53, 7
    s_add_u32 s82, s82, s81
    s_lshl_b32 s74, s82, 12
    s_mul_i32 s82, s81, 4682
    s_lshr_b32 s82, s82, 16
    s_mul_i32 s82, s82, 434
    s_mul_i32 s83, s53, 14
    s_add_u32 s82, s82, s83
    s_add_u32 s82, s82, s81
    s_lshl_b32 s84, s82, 7
    s_cmp_ge_u32 s81, 112
    s_cselect_b32 s84, 0x3ff80000, s84
    s_lshl_b32 s75, s49, 5
    s_add_u32 s75, s75, s50
    s_lshl_b32 s75, s75, 12
    v_lshrrev_b32 v66, 3, v1
    v_mul_u32_u24 v40, 7040, v66
    v_add_u32 v40, v40, v2
    v_lshrrev_b32 v36, 5, v1
    v_mul_u32_u24 v36, 1536, v36
    v_add_u32 v36, v36, v2
    s_mov_b32 s46, 4194304
    s_mov_b32 s47, 0x20000
    s_mov_b32 s6, 7340032
    s_mov_b32 s7, 0x20000
    s_mov_b32 s10, 2097152
    s_mov_b32 s11, 0x20000
    s_movk_i32 s81, 6944
    s_movk_i32 s82, 28672
    v_lshrrev_b32 v66, 3, v1
    v_lshrrev_b32 v67, 4, v1
    v_and_b32 v65, 7, v1
    v_xor_b32 v67, v67, v65
    v_lshlrev_b32 v67, 4, v67
    v_lshl_add_u32 v62, v66, 13, v67
    v_xor_b32 v63, 64, v62
    v_add_u32 v63, 64512, v63
    v_lshl_add_u32 v10, v66, 11, v67
    v_xor_b32 v11, 64, v10
    v_add_u32 v11, 15360, v11
    s_lshl_b32 s58, s49, 17
    s_add_u32 s59, s58, 4096
    s_lshl_b32 s78, s48, 13
    s_nop 0
    s_add_u32 s78, s78, 131072
    v_mul_u32_u24 v68, 4682, v1
    v_bfe_u32 v66, v68, 18, 1
    v_bfe_u32 v67, v68, 19, 1
    v_lshrrev_b32 v3, 16, v68
    v_sub_u32 v66, v66, v67
    s_cmp_lt_u32 s48, 2
    s_waitcnt lgkmcnt(0)
    s_cselect_b32 s4, s24, s26
    s_cselect_b32 s5, s25, s27
    s_cselect_b32 s8, s36, s38
    s_cselect_b32 s9, s37, s39
    buffer_load_dwordx4 v[54:57], v36, s[44:47], s75 offen offset:0
    buffer_load_dwordx4 v[50:53], v36, s[8:11], s74 offen offset:0
    buffer_load_dwordx4 v[24:27], v40, s[4:7], s84 offen
    s_add_u32 s84, s84, 458752
    buffer_load_dwordx4 v[42:45], v40, s[4:7], s84 offen
    s_add_u32 s84, s84, 458752
    s_mov_b32 m0, s78
    s_nop 0
    buffer_load_dwordx4 v62, s[44:47], s58 offen offset:0 lds
    v_mad_u32_u24 v3, v3, s81, v2
    v_mad_i32_i24 v3, v66, s82, v3
    v_add_u32 v68, 299648, v68
    v_bfe_u32 v66, v68, 18, 1
    v_bfe_u32 v67, v68, 19, 1
    v_lshrrev_b32 v4, 16, v68
    v_sub_u32 v66, v66, v67
    v_mad_u32_u24 v4, v4, s81, v2
    v_mad_i32_i24 v4, v66, s82, v4
    v_add_u32 v68, 299648, v68
    v_bfe_u32 v66, v68, 18, 1
    v_bfe_u32 v67, v68, 19, 1
    buffer_load_dwordx4 v63, s[44:47], s58 offen offset:1024 lds
    v_lshrrev_b32 v5, 16, v68
    v_sub_u32 v66, v66, v67
    v_mad_u32_u24 v5, v5, s81, v2
    v_mad_i32_i24 v5, v66, s82, v5
    v_add_u32 v68, 299648, v68
    v_bfe_u32 v66, v68, 18, 1
    v_bfe_u32 v67, v68, 19, 1
    v_lshrrev_b32 v6, 16, v68
    v_sub_u32 v66, v66, v67
    v_mad_u32_u24 v6, v6, s81, v2
    v_mad_i32_i24 v6, v66, s82, v6
    v_add_u32 v68, 299648, v68
    buffer_load_dwordx4 v62, s[44:47], s58 offen offset:2048 lds
    v_bfe_u32 v66, v68, 18, 1
    v_bfe_u32 v67, v68, 19, 1
    v_lshrrev_b32 v7, 16, v68
    v_sub_u32 v66, v66, v67
    v_mad_u32_u24 v7, v7, s81, v2
    v_mad_i32_i24 v7, v66, s82, v7
    v_add_u32 v7, 4096, v7
    v_add_u32 v68, 299648, v68
    v_bfe_u32 v66, v68, 18, 1
    v_bfe_u32 v67, v68, 19, 1
    v_lshrrev_b32 v8, 16, v68
    v_sub_u32 v66, v66, v67
    buffer_load_dwordx4 v63, s[44:47], s58 offen offset:3072 lds
    s_add_u32 s58, s58, 128
    v_mad_u32_u24 v8, v8, s81, v2
    v_mad_i32_i24 v8, v66, s82, v8
    v_add_u32 v8, 4096, v8
    v_add_u32 v68, 299648, v68
    v_bfe_u32 v66, v68, 18, 1
    v_bfe_u32 v67, v68, 19, 1
    v_lshrrev_b32 v9, 16, v68
    v_sub_u32 v66, v66, v67
    v_mad_u32_u24 v9, v9, s81, v2
    v_mad_i32_i24 v9, v66, s82, v9
    v_add_u32 v9, 4096, v9
    s_and_b32 s81, s48, 1
    s_add_u32 m0, s78, 4096
    s_nop 0
    buffer_load_dwordx4 v62, s[44:47], s59 offen offset:0 lds
    s_mul_i32 s56, s81, 229376
    s_mul_i32 s82, s50, 224
    s_add_u32 s56, s56, s82
    s_lshl_b32 s57, s50, 16
    s_lshl_b32 s81, s81, 15
    s_add_u32 s57, s57, s81
    s_lshr_b32 s81, s48, 1
    s_mul_i32 s60, s81, 7168
    s_lshl_b32 s61, s48, 11
    s_add_u32 s61, s61, 14336
    s_mov_b32 s62, 102400
    s_mov_b32 s12, 45056
    buffer_load_dwordx4 v63, s[44:47], s59 offen offset:1024 lds
    s_bitcmp1_b32 s48, 0
    s_cselect_b32 s63, s12, s62
    s_add_u32 s63, s63, s60
    s_add_u32 s64, s61, s62
    s_add_u32 s36, s76, 0x1a00000
    s_addc_u32 s37, s77, 0
    s_mov_b32 s38, 0xca000
    s_mov_b32 s39, 0x20000
    s_load_dword s80, s[36:37], 32768
    s_and_b32 s52, s50, 1
    v_lshrrev_b32 v64, 4, v1
    v_bfe_u32 v65, v1, 2, 3
    v_and_b32 v66, 3, v1
    v_and_b32 v67, 15, v1
    buffer_load_dwordx4 v62, s[44:47], s59 offen offset:2048 lds
    v_lshrrev_b32 v68, 5, v1
    v_lshl_add_u32 v68, v68, 4, v65
    v_mul_u32_u24 v68, 224, v68
    v_lshl_add_u32 v68, v66, 3, v68
    s_lshl_b32 s81, s52, 5
    s_mul_i32 s82, s52, 192
    s_sub_u32 s82, 102592, s82
    s_add_u32 s81, s81, 102400
    v_add_u32 v12, s81, v68
    v_add_u32_e64 v13, s82, v68
    v_subrev_u32 v16, 57344, v12
    v_subrev_u32 v17, 57344, v13
    buffer_load_dwordx4 v63, s[44:47], s59 offen offset:3072 lds
    s_add_u32 s59, s59, 128
    v_lshrrev_b32 v68, 1, v67
    v_xor_b32 v68, v68, v64
    v_lshlrev_b32 v68, 4, v68
    v_lshl_add_u32 v68, v67, 7, v68
    v_add_u32 v14, 102400, v68
    v_xor_b32 v15, 64, v14
    v_add_u32 v18, s78, v68
    v_xor_b32 v19, 64, v18
    s_mov_b32 s65, 102400
    s_mov_b32 s13, 45056
    s_mov_b32 s66, 0
    s_mov_b32 s24, s28
    s_mov_b32 s25, s29
    s_mov_b64 exec, 0
    s_cmp_eq_u32 s48, 0
    s_cbranch_scc1 LF_pad0
    s_cmp_eq_u32 s48, 1
    s_cbranch_scc1 LF_pad1
    s_cmp_eq_u32 s48, 2
    s_cbranch_scc1 LF_pad2
    s_branch LF_pad3
LF_walked:
    s_mov_b64 exec, -1
    s_branch LF_main
.p2align 12
LF_main:
LF_pad0:
    s_cbranch_execz LF_pad4
    s_mov_b32 m0, s63
    s_nop 0
    buffer_load_dwordx4 v3, s[4:7], s56 offen offset:0  lds
    s_mov_b32 s26, 0x700000
    s_mov_b32 s27, 0x20000
    s_mov_b32 s40, s30
    s_mov_b32 s41, s31
    s_mov_b32 s42, 0x800000
    s_mov_b32 s43, 0x20000
    s_cmp_lt_u32 s48, 2
    s_cselect_b32 s28, s16, s18
    s_cselect_b32 s29, s17, s19
    s_mov_b32 s30, 2097152
    s_mov_b32 s31, 0x20000
    v_and_b32 v41, 15, v1
    v_lshlrev_b32_e64 v41, 1, v41
    s_lshl_b32 s81, s50, 6
    s_mov_b32 s16, s32
    s_mov_b32 s17, s33
    buffer_load_dwordx4 v4, s[4:7], s56 offen offset:1024  lds
    s_mov_b32 s18, 0x800
    s_mov_b32 s19, 0x20000
    buffer_load_ushort a200, v41, s[16:19], s81 offen offset:0
    buffer_load_ushort a201, v41, s[16:19], s81 offen offset:32
    s_mov_b32 s16, s34
    s_mov_b32 s17, s35
    s_mov_b32 s18, 0x800
    s_mov_b32 s19, 0x20000
    buffer_load_ushort a202, v41, s[16:19], s81 offen offset:0
    buffer_load_ushort a203, v41, s[16:19], s81 offen offset:32
    s_mov_b32 s16, s20
    s_mov_b32 s17, s21
    s_mov_b32 s18, 0x800
    s_mov_b32 s19, 0x20000
    buffer_load_dwordx4 v5, s[4:7], s56 offen offset:2048  lds
    buffer_load_ushort a204, v41, s[16:19], s81 offen offset:0
    buffer_load_ushort a205, v41, s[16:19], s81 offen offset:32
    s_mov_b32 s0, s22
    s_mov_b32 s1, s23
    s_add_u32 s16, s76, 0x400000
    s_addc_u32 s17, s77, 0
    s_mov_b32 s18, 0x1600000
    s_mov_b32 s19, 0x20000
    s_add_u32 s32, s76, 0x1b00000
    s_addc_u32 s33, s77, 0
    s_mov_b32 s34, 0xc00000
    s_mov_b32 s35, 0x20000
    s_lshl_b32 s81, s50, 13
    s_add_u32 s81, s81, 0x1a10000
    s_add_u32 s20, s76, s81
    s_addc_u32 s21, s77, 0
    buffer_load_dwordx4 v6, s[4:7], s56 offen offset:3072  lds
    s_mov_b32 s22, 8192
    s_mov_b32 s23, 0x20000
    s_lshl_b32 s55, s51, 3
    s_add_u32 s55, s55, s54
    s_mul_i32 s81, s49, 720896
    s_lshl_b32 s82, s53, 16
    s_add_u32 s70, s81, s82
    s_add_u32 s70, s70, 458752
    s_mul_i32 s82, s53, 114688
    s_add_u32 s67, s81, s82
    s_mul_i32 s72, s54, 3
    s_lshl_b32 s82, s72, 12
    s_add_u32 m0, s63, 4096
    s_nop 0
    buffer_load_dwordx4 v7, s[4:7], s56 offen offset:0  lds
    s_add_u32 s69, s67, s82
    s_add_u32 s68, s69, 12288
    s_cmp_eq_u32 s67, s69
    s_cselect_b32 s67, s68, s67
    s_mul_i32 s82, s53, 1835008
    s_lshl_b32 s83, s54, 8
    s_add_u32 s89, s82, s83
    s_sub_u32 s3, s48, 3
    s_add_u32 s71, s72, s48
    s_cmp_eq_u32 s48, 3
    s_cselect_b32 s81, s54, 0
    s_cmp_lg_u32 s81, 0
    s_cselect_b32 s71, 0, s71
    s_add_u32 s88, s71, 3
    s_mul_i32 s88, s88, 43
    buffer_load_dwordx4 v8, s[4:7], s56 offen offset:1024  lds
    s_lshr_b32 s88, s88, 8
    s_add_u32 s71, s71, s88
    s_lshl_b32 s71, s71, 16
    s_add_u32 s71, s71, s89
    s_lshl_b32 s73, s54, 18
    s_lshl_b32 s81, s53, 9
    s_add_u32 s73, s73, s81
    s_lshl_b32 s79, s2, 2
    s_add_u32 s79, s79, 507904
    s_cmp_eq_u32 s48, 0
    s_cselect_b32 s79, s79, 0x7ff00000
    s_lshr_b32 s86, s74, 2
    s_lshr_b32 s85, s75, 2
    buffer_load_dwordx4 v9, s[4:7], s56 offen offset:2048  lds
    v_mov_b32 v41, 0
    s_bfe_u32 s82, s74, 0x7000c
    s_mul_i32 s83, s82, 4682
    s_lshr_b32 s83, s83, 16
    s_mul_i32 s83, s83, 98
    s_mul_i32 s81, s53, 14
    s_add_u32 s81, s81, s83
    s_add_u32 s81, s81, s82
    s_lshr_b32 s88, s48, 1
    s_mul_i32 s83, s88, 56
    s_add_u32 s81, s81, s83
    s_lshl_b32 s81, s81, 8
    s_mov_b32 m0, s64
    s_nop 0
    buffer_load_dwordx4 v10, s[8:11], s57 offen offset:0  lds
    s_add_u32 s81, s81, 589824
    s_cmp_ge_u32 s82, 112
    s_cselect_b32 s81, 0x7ff00000, s81
    s_lshl_b32 s88, s88, 12
    s_lshr_b32 s82, s74, 9
    s_add_u32 s82, s82, s88
    s_add_u32 s82, s82, 819200
    s_lshr_b32 s83, s75, 8
    buffer_load_dwordx4 v11, s[8:11], s57 offen offset:1024  lds
    s_add_u32 s56, s56, 458752
    s_add_u32 s57, s57, 128
    s_add_u32 s62, s62, 22528
    s_cmp_eq_u32 s62, 45056
    s_cselect_b32 s62, 102400, s62
    s_cmp_eq_u32 s62, 124928
    s_cselect_b32 s62, 0, s62
    s_add_u32 s12, s12, 14336
    s_cmp_eq_u32 s12, 102400
    s_cselect_b32 s12, 45056, s12
    s_bitcmp1_b32 s48, 0
    s_cselect_b32 s63, s12, s62
    s_add_u32 s63, s63, s60
    s_add_u32 s64, s61, s62
    s_waitcnt vmcnt(25)
    v_lshlrev_b32 v31, 16, v54
    v_mov_b32 v28, 0
    v_mov_b32 v29, 0
    v_mov_b32 v30, 0
    v_lshlrev_b32 v39, 16, v50
    v_and_b32 v50, 0xffff0000, v50
    v_add_f32 v28, v28, v39
    v_add_f32 v28, v28, v50
    v_lshlrev_b32 v39, 16, v54
    v_and_b32 v54, 0xffff0000, v54
    v_sub_f32 v39, v39, v31
    v_sub_f32 v54, v54, v31
    v_add_f32 v29, v29, v39
    v_fmac_f32 v30, v39, v39
    v_add_f32 v29, v29, v54
    v_fmac_f32 v30, v54, v54
    v_lshlrev_b32 v39, 16, v51
    v_and_b32 v51, 0xffff0000, v51
    v_add_f32 v28, v28, v39
    v_add_f32 v28, v28, v51
    v_lshlrev_b32 v39, 16, v55
    v_and_b32 v55, 0xffff0000, v55
    v_sub_f32 v39, v39, v31
    v_sub_f32 v55, v55, v31
    v_add_f32 v29, v29, v39
    v_fmac_f32 v30, v39, v39
    v_add_f32 v29, v29, v55
    v_fmac_f32 v30, v55, v55
    v_lshlrev_b32 v39, 16, v52
    v_and_b32 v52, 0xffff0000, v52
    v_add_f32 v28, v28, v39
    v_add_f32 v28, v28, v52
    v_lshlrev_b32 v39, 16, v56
    v_and_b32 v56, 0xffff0000, v56
    v_sub_f32 v39, v39, v31
    v_sub_f32 v56, v56, v31
    v_add_f32 v29, v29, v39
    v_fmac_f32 v30, v39, v39
    v_add_f32 v29, v29, v56
    v_fmac_f32 v30, v56, v56
    v_lshlrev_b32 v39, 16, v53
    v_and_b32 v53, 0xffff0000, v53
    v_add_f32 v28, v28, v39
    v_add_f32 v28, v28, v53
    v_lshlrev_b32 v39, 16, v57
    v_and_b32 v57, 0xffff0000, v57
    v_sub_f32 v39, v39, v31
    v_sub_f32 v57, v57, v31
    v_add_f32 v29, v29, v39
    v_fmac_f32 v30, v39, v39
    v_add_f32 v29, v29, v57
    v_fmac_f32 v30, v57, v57
    buffer_load_dwordx4 v[54:57], v36, s[44:47], s75 offen offset:512
    buffer_load_dwordx4 v[50:53], v36, s[8:11], s74 offen offset:512
    s_waitcnt vmcnt(26)
    v_lshlrev_b32 v20, 16, v24
    v_and_b32 v21, 0xffff0000, v24
    v_lshlrev_b32 v22, 16, v25
    v_and_b32 v23, 0xffff0000, v25
    v_lshlrev_b32 v24, 16, v26
    v_and_b32 v25, 0xffff0000, v26
    v_lshlrev_b32 v26, 16, v27
    v_and_b32 v27, 0xffff0000, v27
    s_waitcnt vmcnt(25)
    v_lshlrev_b32 v38, 16, v42
    v_and_b32 v42, 0xffff0000, v42
    v_add_f32 v20, v20, v38
    v_add_f32 v21, v21, v42
    v_lshlrev_b32 v38, 16, v43
    v_and_b32 v43, 0xffff0000, v43
    v_add_f32 v22, v22, v38
    v_add_f32 v23, v23, v43
    v_lshlrev_b32 v38, 16, v44
    v_and_b32 v44, 0xffff0000, v44
    v_add_f32 v24, v24, v38
    v_add_f32 v25, v25, v44
    v_lshlrev_b32 v38, 16, v45
    v_and_b32 v45, 0xffff0000, v45
    v_add_f32 v26, v26, v38
    v_add_f32_e64 v27, v27, v45
    s_waitcnt vmcnt(17)
    ds_read_b128 a[96:99], v18 offset:0
    ds_read_b128 a[112:115], v19 offset:0
    ds_read_b128 a[100:103], v18 offset:2048
    ds_read_b128 a[116:119], v19 offset:2048
    ds_read_b128 a[104:107], v18 offset:4096
    ds_read_b128 a[120:123], v19 offset:4096
    ds_read_b128 a[108:111], v18 offset:6144
    ds_read_b128 a[124:127], v19 offset:6144
    s_waitcnt vmcnt(2) lgkmcnt(0)
    s_barrier
    ds_read_b128 a[160:163], v14 offset:14336
    ds_read_b128 a[164:167], v14 offset:18432
    ds_read_b128 a[168:171], v14 offset:16384
    ds_read_b128 a[172:175], v14 offset:20480
    s_mul_i32 s80, s80, 1664525
    s_add_u32 s80, s80, 1013904223
    v_mov_b32 v37, s80
    s_waitcnt lgkmcnt(2)
    v_mfma_f32_16x16x32_bf16 v[64:67], a[96:99], a[160:163], 0
    ds_read_b64_tr_b16 a[176:177], v12 offset:0
    v_mfma_f32_16x16x32_bf16 v[68:71], a[96:99], a[164:167], 0
    ds_read_b64_tr_b16 a[178:179], v12 offset:1792
    v_mfma_f32_16x16x32_bf16 v[84:87], a[100:103], a[164:167], 0
    buffer_load_dwordx4 v[46:49], v40, s[4:7], s84 offen
    v_mfma_f32_16x16x32_bf16 v[80:83], a[100:103], a[160:163], 0
    s_add_u32 s84, s84, 458752
    ds_read_b64_tr_b16 a[180:181], v12 offset:7168
    v_mfma_f32_16x16x32_bf16 v[96:99], a[104:107], a[160:163], 0
    ds_read_b64_tr_b16 a[182:183], v12 offset:8960
    v_mfma_f32_16x16x32_bf16 v[100:103], a[104:107], a[164:167], 0
    buffer_load_dwordx4 v[32:35], v40, s[4:7], s84 offen
    v_mfma_f32_16x16x32_bf16 v[116:119], a[108:111], a[164:167], 0
    s_add_u32 s84, s84, 458752
    s_mov_b32 m0, s78
    v_mfma_f32_16x16x32_bf16 v[112:115], a[108:111], a[160:163], 0
    s_waitcnt lgkmcnt(4)
    buffer_load_dwordx4 v62, s[44:47], s58 offen offset:0 lds
    v_mfma_f32_16x16x32_bf16 v[120:123], a[108:111], a[168:171], 0
    ds_read_b64_tr_b16 a[160:161], v12 offset:32
    v_mfma_f32_16x16x32_bf16 v[124:127], a[108:111], a[172:175], 0
    ds_read_b64_tr_b16 a[162:163], v12 offset:1824
    v_mfma_f32_16x16x32_bf16 v[108:111], a[104:107], a[172:175], 0
    buffer_load_dwordx4 v63, s[44:47], s58 offen offset:1024 lds
    v_mfma_f32_16x16x32_bf16 v[104:107], a[104:107], a[168:171], 0
    ds_read_b64_tr_b16 a[164:165], v12 offset:7200
    v_mfma_f32_16x16x32_bf16 v[88:91], a[100:103], a[168:171], 0
    ds_read_b64_tr_b16 a[166:167], v12 offset:8992
    v_mfma_f32_16x16x32_bf16 v[92:95], a[100:103], a[172:175], 0
    buffer_load_dwordx4 v62, s[44:47], s58 offen offset:2048 lds
    v_mfma_f32_16x16x32_bf16 v[76:79], a[96:99], a[172:175], 0
    v_mfma_f32_16x16x32_bf16 v[72:75], a[96:99], a[168:171], 0
    s_waitcnt lgkmcnt(4)
    v_mfma_f32_16x16x32_bf16 v[128:131], a[176:179], a[96:99], 0
    ds_read_b64_tr_b16 a[168:169], v12 offset:64
    v_mfma_f32_16x16x32_bf16 v[192:195], a[180:183], a[96:99], 0
    ds_read_b64_tr_b16 a[170:171], v12 offset:1856
    v_mfma_f32_16x16x32_bf16 v[196:199], a[180:183], a[100:103], 0
    buffer_load_dwordx4 v63, s[44:47], s58 offen offset:3072 lds
    v_mfma_f32_16x16x32_bf16 v[132:135], a[176:179], a[100:103], 0
    s_add_u32 s58, s58, 128
    ds_read_b64_tr_b16 a[172:173], v12 offset:7232
    v_mfma_f32_16x16x32_bf16 v[136:139], a[176:179], a[104:107], 0
    s_add_u32 m0, s78, 4096
    ds_read_b64_tr_b16 a[174:175], v12 offset:9024
    v_mfma_f32_16x16x32_bf16 v[200:203], a[180:183], a[104:107], 0
    buffer_load_dwordx4 v62, s[44:47], s59 offen offset:0 lds
    v_mfma_f32_16x16x32_bf16 v[204:207], a[180:183], a[108:111], 0
    v_mfma_f32_16x16x32_bf16 v[140:143], a[176:179], a[108:111], 0
    s_waitcnt lgkmcnt(4)
    v_mfma_f32_16x16x32_bf16 v[156:159], a[160:163], a[108:111], 0
    ds_read_b64_tr_b16 a[176:177], v12 offset:96
    v_mfma_f32_16x16x32_bf16 v[220:223], a[164:167], a[108:111], 0
    ds_read_b64_tr_b16 a[178:179], v12 offset:1888
    v_mfma_f32_16x16x32_bf16 v[216:219], a[164:167], a[104:107], 0
    buffer_load_dwordx4 v63, s[44:47], s59 offen offset:1024 lds
    v_mfma_f32_16x16x32_bf16 v[152:155], a[160:163], a[104:107], 0
    ds_read_b64_tr_b16 a[180:181], v12 offset:7264
    v_mfma_f32_16x16x32_bf16 v[148:151], a[160:163], a[100:103], 0
    ds_read_b64_tr_b16 a[182:183], v12 offset:9056
    v_mfma_f32_16x16x32_bf16 v[212:215], a[164:167], a[100:103], 0
    buffer_load_dwordx4 v62, s[44:47], s59 offen offset:2048 lds
    v_mfma_f32_16x16x32_bf16 v[208:211], a[164:167], a[96:99], 0
    s_waitcnt vmcnt(9)
    v_lshlrev_b32 v39, 16, v50
    v_and_b32 v50, 0xffff0000, v50
    v_mfma_f32_16x16x32_bf16 v[144:147], a[160:163], a[96:99], 0
    s_waitcnt lgkmcnt(4)
    v_add_f32 v28, v28, v39
    v_add_f32 v28, v28, v50
    v_mfma_f32_16x16x32_bf16 v[160:163], a[168:171], a[96:99], 0
    ds_read_b64_tr_b16 a[160:161], v12 offset:128
    v_lshlrev_b32 v39, 16, v54
    v_mfma_f32_16x16x32_bf16 v[224:227], a[172:175], a[96:99], 0
    ds_read_b64_tr_b16 a[162:163], v12 offset:1920
    v_and_b32 v54, 0xffff0000, v54
    v_mfma_f32_16x16x32_bf16 v[228:231], a[172:175], a[100:103], 0
    buffer_load_dwordx4 v63, s[44:47], s59 offen offset:3072 lds
    v_mfma_f32_16x16x32_bf16 v[164:167], a[168:171], a[100:103], 0
    s_add_u32 s59, s59, 128
    ds_read_b64_tr_b16 a[164:165], v12 offset:7296
    v_sub_f32 v39, v39, v31
    v_mfma_f32_16x16x32_bf16 v[168:171], a[168:171], a[104:107], 0
    s_mov_b32 m0, s63
    ds_read_b64_tr_b16 a[166:167], v12 offset:9088
    v_sub_f32 v54, v54, v31
    v_mfma_f32_16x16x32_bf16 v[232:235], a[172:175], a[104:107], 0
    buffer_load_dwordx4 v3, s[4:7], s56 offen offset:0  lds
    v_mfma_f32_16x16x32_bf16 v[236:239], a[172:175], a[108:111], 0
    v_add_f32 v29, v29, v39
    v_fmac_f32 v30, v39, v39
    v_mfma_f32_16x16x32_bf16 v[172:175], a[168:171], a[108:111], 0
    s_waitcnt lgkmcnt(4)
    v_add_f32 v29, v29, v54
    v_fmac_f32 v30, v54, v54
    v_mfma_f32_16x16x32_bf16 v[188:191], a[176:179], a[108:111], 0
    ds_read_b64_tr_b16 a[168:169], v12 offset:160
    v_lshlrev_b32 v39, 16, v51
    v_mfma_f32_16x16x32_bf16 v[252:255], a[180:183], a[108:111], 0
    ds_read_b64_tr_b16 a[170:171], v12 offset:1952
    v_and_b32 v51, 0xffff0000, v51
    v_mfma_f32_16x16x32_bf16 v[248:251], a[180:183], a[104:107], 0
    buffer_load_dwordx4 v4, s[4:7], s56 offen offset:1024  lds
    v_mfma_f32_16x16x32_bf16 v[184:187], a[176:179], a[104:107], 0
    ds_read_b64_tr_b16 a[172:173], v12 offset:7328
    v_add_f32 v28, v28, v39
    v_mfma_f32_16x16x32_bf16 v[180:183], a[176:179], a[100:103], 0
    ds_read_b64_tr_b16 a[174:175], v12 offset:9120
    v_add_f32 v28, v28, v51
    v_mfma_f32_16x16x32_bf16 v[244:247], a[180:183], a[100:103], 0
    buffer_load_dwordx4 v5, s[4:7], s56 offen offset:2048  lds
    v_mfma_f32_16x16x32_bf16 v[240:243], a[180:183], a[96:99], 0
    v_lshlrev_b32 v39, 16, v55
    v_and_b32 v55, 0xffff0000, v55
    v_mfma_f32_16x16x32_bf16 v[176:179], a[176:179], a[96:99], 0
    s_waitcnt lgkmcnt(4)
    v_sub_f32 v39, v39, v31
    v_sub_f32 v55, v55, v31
    v_mfma_f32_16x16x32_bf16 a[0:3], a[160:163], a[96:99], 0
    ds_read_b64_tr_b16 a[176:177], v13 offset:0
    v_add_f32 v29, v29, v39
    v_mfma_f32_16x16x32_bf16 a[48:51], a[164:167], a[96:99], 0
    ds_read_b64_tr_b16 a[178:179], v13 offset:1792
    v_fmac_f32 v30, v39, v39
    v_mfma_f32_16x16x32_bf16 a[52:55], a[164:167], a[100:103], 0
    buffer_load_dwordx4 v6, s[4:7], s56 offen offset:3072  lds
    v_mfma_f32_16x16x32_bf16 a[4:7], a[160:163], a[100:103], 0
    ds_read_b64_tr_b16 a[180:181], v13 offset:7168
    v_add_f32 v29, v29, v55
    v_mfma_f32_16x16x32_bf16 a[8:11], a[160:163], a[104:107], 0
    s_add_u32 m0, s63, 4096
    ds_read_b64_tr_b16 a[182:183], v13 offset:8960
    v_fmac_f32 v30, v55, v55
    v_mfma_f32_16x16x32_bf16 a[56:59], a[164:167], a[104:107], 0
    buffer_load_dwordx4 v7, s[4:7], s56 offen offset:0  lds
    v_mfma_f32_16x16x32_bf16 a[60:63], a[164:167], a[108:111], 0
    v_lshlrev_b32 v39, 16, v52
    v_and_b32 v52, 0xffff0000, v52
    v_mfma_f32_16x16x32_bf16 a[12:15], a[160:163], a[108:111], 0
    s_waitcnt lgkmcnt(4)
    v_add_f32 v28, v28, v39
    v_add_f32 v28, v28, v52
    v_mfma_f32_16x16x32_bf16 a[28:31], a[168:171], a[108:111], 0
    ds_read_b128 a[160:163], v15 offset:14336
    v_lshlrev_b32 v39, 16, v56
    v_mfma_f32_16x16x32_bf16 a[76:79], a[172:175], a[108:111], 0
    buffer_load_dwordx4 v8, s[4:7], s56 offen offset:1024  lds
    v_mfma_f32_16x16x32_bf16 a[72:75], a[172:175], a[104:107], 0
    v_and_b32 v56, 0xffff0000, v56
    v_sub_f32 v39, v39, v31
    v_mfma_f32_16x16x32_bf16 a[24:27], a[168:171], a[104:107], 0
    ds_read_b128 a[164:167], v15 offset:18432
    v_sub_f32 v56, v56, v31
    v_mfma_f32_16x16x32_bf16 a[20:23], a[168:171], a[100:103], 0
    buffer_load_dwordx4 v9, s[4:7], s56 offen offset:2048  lds
    v_mfma_f32_16x16x32_bf16 a[68:71], a[172:175], a[100:103], 0
    v_add_f32 v29, v29, v39
    v_fmac_f32 v30, v39, v39
    v_mfma_f32_16x16x32_bf16 a[64:67], a[172:175], a[96:99], 0
    s_mov_b32 m0, s64
    v_add_f32 v29, v29, v56
    v_fmac_f32 v30, v56, v56
    v_mfma_f32_16x16x32_bf16 a[16:19], a[168:171], a[96:99], 0
    s_waitcnt lgkmcnt(2)
    buffer_load_dwordx4 v10, s[8:11], s57 offen offset:0  lds
    v_mfma_f32_16x16x32_bf16 a[32:35], a[176:179], a[96:99], 0
    ds_read_b128 a[168:171], v15 offset:16384
    v_lshlrev_b32 v39, 16, v53
    v_mfma_f32_16x16x32_bf16 a[80:83], a[180:183], a[96:99], 0
    v_and_b32 v53, 0xffff0000, v53
    v_add_f32 v28, v28, v39
    v_mfma_f32_16x16x32_bf16 a[84:87], a[180:183], a[100:103], 0
    buffer_load_dwordx4 v11, s[8:11], s57 offen offset:1024  lds
    v_mfma_f32_16x16x32_bf16 a[36:39], a[176:179], a[100:103], 0
    s_add_u32 s56, s56, 458752
    ds_read_b128 a[172:175], v15 offset:20480
    v_add_f32 v28, v28, v53
    v_mfma_f32_16x16x32_bf16 a[40:43], a[176:179], a[104:107], 0
    s_add_u32 s57, s57, 128
    s_waitcnt vmcnt(13)
    ds_read_b128 a[128:131], v18 offset:0
    v_mfma_f32_16x16x32_bf16 a[88:91], a[180:183], a[104:107], 0
    s_add_u32 s62, s62, 22528
    v_lshlrev_b32 v39, 16, v57
    v_and_b32 v57, 0xffff0000, v57
    v_mfma_f32_16x16x32_bf16 a[92:95], a[180:183], a[108:111], 0
    s_cmp_eq_u32 s62, 45056
    s_cselect_b32 s62, 102400, s62
    ds_read_b128 a[144:147], v19 offset:0
    v_mfma_f32_16x16x32_bf16 a[44:47], a[176:179], a[108:111], 0
    s_waitcnt lgkmcnt(4)
    v_sub_f32 v39, v39, v31
    v_sub_f32 v57, v57, v31
    v_mfma_f32_16x16x32_bf16 v[112:115], a[124:127], a[160:163], v[112:115]
    s_cmp_eq_u32 s62, 124928
    s_cselect_b32 s62, 0, s62
    ds_read_b64_tr_b16 a[176:177], v16 offset:0
    v_mfma_f32_16x16x32_bf16 v[116:119], a[124:127], a[164:167], v[116:119]
    s_add_u32 s12, s12, 14336
    ds_read_b64_tr_b16 a[178:179], v16 offset:1792
    v_add_f32 v29, v29, v39
    v_mfma_f32_16x16x32_bf16 v[100:103], a[120:123], a[164:167], v[100:103]
    s_cmp_eq_u32 s12, 102400
    s_cselect_b32 s12, 45056, s12
    ds_read_b128 a[132:135], v18 offset:2048
    v_mfma_f32_16x16x32_bf16 v[96:99], a[120:123], a[160:163], v[96:99]
    s_bitcmp1_b32 s48, 0
    s_cselect_b32 s63, s12, s62
    ds_read_b64_tr_b16 a[180:181], v16 offset:7168
    v_mfma_f32_16x16x32_bf16 v[80:83], a[116:119], a[160:163], v[80:83]
    s_add_u32 s14, s65, 22528
    ds_read_b64_tr_b16 a[182:183], v16 offset:8960
    v_fmac_f32 v30, v39, v39
    v_mfma_f32_16x16x32_bf16 v[84:87], a[116:119], a[164:167], v[84:87]
    s_cmp_eq_u32 s14, 45056
    s_cselect_b32 s14, 102400, s14
    ds_read_b128 a[148:151], v19 offset:2048
    v_mfma_f32_16x16x32_bf16 v[68:71], a[112:115], a[164:167], v[68:71]
    s_cmp_eq_u32 s14, 124928
    s_cselect_b32 s14, 0, s14
    v_add_f32 v29, v29, v57
    v_mfma_f32_16x16x32_bf16 v[64:67], a[112:115], a[160:163], v[64:67]
    s_waitcnt lgkmcnt(8)
    v_fmac_f32 v30, v57, v57
    v_mfma_f32_16x16x32_bf16 v[72:75], a[112:115], a[168:171], v[72:75]
    s_sub_u32 s65, s14, s65
    ds_read_b64_tr_b16 a[160:161], v16 offset:32
    v_add_u32 v12, s65, v12
    v_mfma_f32_16x16x32_bf16 v[76:79], a[112:115], a[172:175], v[76:79]
    s_add_u32 s63, s63, s60
    ds_read_b64_tr_b16 a[162:163], v16 offset:1824
    v_add_u32 v13, s65, v13
    v_mfma_f32_16x16x32_bf16 v[92:95], a[116:119], a[172:175], v[92:95]
    s_add_u32 s64, s61, s62
    v_add_u32 v14, s65, v14
    v_add_u32 v15, s65, v15
    v_mfma_f32_16x16x32_bf16 v[88:91], a[116:119], a[168:171], v[88:91]
    s_mov_b32 s65, s14
    ds_read_b64_tr_b16 a[164:165], v16 offset:7200
    v_mfma_f32_16x16x32_bf16 v[104:107], a[120:123], a[168:171], v[104:107]
    s_add_u32 s14, s13, 14336
    ds_read_b64_tr_b16 a[166:167], v16 offset:8992
    v_mfma_f32_16x16x32_bf16 v[108:111], a[120:123], a[172:175], v[108:111]
    s_cmp_eq_u32 s14, 102400
    s_cselect_b32 s14, 45056, s14
    v_mfma_f32_16x16x32_bf16 v[124:127], a[124:127], a[172:175], v[124:127]
    s_sub_u32 s15, s14, s13
    s_waitcnt vmcnt(9)
    ds_read_b128 a[136:139], v18 offset:4096
    v_mfma_f32_16x16x32_bf16 v[120:123], a[124:127], a[168:171], v[120:123]
    s_waitcnt lgkmcnt(6)
    v_lshlrev_b32 v38, 16, v46
    v_mfma_f32_16x16x32_bf16 v[140:143], a[176:179], a[124:127], v[140:143]
    s_mov_b32 s13, s14
    ds_read_b64_tr_b16 a[168:169], v16 offset:64
    v_and_b32 v46, 0xffff0000, v46
    v_mfma_f32_16x16x32_bf16 v[204:207], a[180:183], a[124:127], v[204:207]
    ds_read_b64_tr_b16 a[170:171], v16 offset:1856
    v_add_f32 v20, v20, v38
    v_mfma_f32_16x16x32_bf16 v[200:203], a[180:183], a[120:123], v[200:203]
    ds_read_b128 a[152:155], v19 offset:4096
    v_add_f32 v21, v21, v46
    v_mfma_f32_16x16x32_bf16 v[136:139], a[176:179], a[120:123], v[136:139]
    ds_read_b64_tr_b16 a[172:173], v16 offset:7232
    v_lshlrev_b32 v38, 16, v47
    v_mfma_f32_16x16x32_bf16 v[132:135], a[176:179], a[116:119], v[132:135]
    ds_read_b64_tr_b16 a[174:175], v16 offset:9024
    v_and_b32 v47, 0xffff0000, v47
    v_mfma_f32_16x16x32_bf16 v[196:199], a[180:183], a[116:119], v[196:199]
    s_mov_b32 m0, s78
    ds_read_b128 a[140:143], v18 offset:6144
    v_add_f32 v22, v22, v38
    v_mfma_f32_16x16x32_bf16 v[192:195], a[180:183], a[112:115], v[192:195]
    s_waitcnt lgkmcnt(11)
    buffer_load_dwordx4 v62, s[44:47], s58 offen offset:0 lds
    v_mfma_f32_16x16x32_bf16 v[128:131], a[176:179], a[112:115], v[128:131]
    s_waitcnt lgkmcnt(7)
    ds_read_b128 a[156:159], v19 offset:6144
    v_add_f32 v23, v23, v47
    v_mfma_f32_16x16x32_bf16 v[144:147], a[160:163], a[112:115], v[144:147]
    ds_read_b64_tr_b16 a[176:177], v16 offset:96
    v_lshlrev_b32 v38, 16, v48
    v_mfma_f32_16x16x32_bf16 v[208:211], a[164:167], a[112:115], v[208:211]
    ds_read_b64_tr_b16 a[178:179], v16 offset:1888
    v_and_b32 v48, 0xffff0000, v48
    v_mfma_f32_16x16x32_bf16 v[212:215], a[164:167], a[116:119], v[212:215]
    buffer_load_dwordx4 v63, s[44:47], s58 offen offset:1024 lds
    v_mfma_f32_16x16x32_bf16 v[148:151], a[160:163], a[116:119], v[148:151]
    ds_read_b64_tr_b16 a[180:181], v16 offset:7264
    v_add_f32 v24, v24, v38
    v_mfma_f32_16x16x32_bf16 v[152:155], a[160:163], a[120:123], v[152:155]
    ds_read_b64_tr_b16 a[182:183], v16 offset:9056
    v_add_f32 v25, v25, v48
    v_mfma_f32_16x16x32_bf16 v[216:219], a[164:167], a[120:123], v[216:219]
    buffer_load_dwordx4 v62, s[44:47], s58 offen offset:2048 lds
    v_mfma_f32_16x16x32_bf16 v[220:223], a[164:167], a[124:127], v[220:223]
    v_lshlrev_b32 v38, 16, v49
    v_and_b32 v49, 0xffff0000, v49
    v_mfma_f32_16x16x32_bf16 v[156:159], a[160:163], a[124:127], v[156:159]
    s_waitcnt lgkmcnt(6)
    v_add_f32 v26, v26, v38
    v_add_f32 v27, v27, v49
    v_mfma_f32_16x16x32_bf16 v[172:175], a[168:171], a[124:127], v[172:175]
    ds_read_b64_tr_b16 a[160:161], v16 offset:128
    v_mfma_f32_16x16x32_bf16 v[236:239], a[172:175], a[124:127], v[236:239]
    ds_read_b64_tr_b16 a[162:163], v16 offset:1920
    v_mfma_f32_16x16x32_bf16 v[232:235], a[172:175], a[120:123], v[232:235]
    buffer_load_dwordx4 v63, s[44:47], s58 offen offset:3072 lds
    v_mfma_f32_16x16x32_bf16 v[168:171], a[168:171], a[120:123], v[168:171]
    s_add_u32 s58, s58, 128
    ds_read_b64_tr_b16 a[164:165], v16 offset:7296
    v_mfma_f32_16x16x32_bf16 v[164:167], a[168:171], a[116:119], v[164:167]
    s_add_u32 m0, s78, 4096
    ds_read_b64_tr_b16 a[166:167], v16 offset:9088
    v_mfma_f32_16x16x32_bf16 v[228:231], a[172:175], a[116:119], v[228:231]
    s_waitcnt lgkmcnt(8)
    buffer_load_dwordx4 v62, s[44:47], s59 offen offset:0 lds
    v_mfma_f32_16x16x32_bf16 v[224:227], a[172:175], a[112:115], v[224:227]
    v_lshlrev_b32 v38, 16, v32
    v_and_b32 v32, 0xffff0000, v32
    v_mfma_f32_16x16x32_bf16 v[160:163], a[168:171], a[112:115], v[160:163]
    s_waitcnt lgkmcnt(4)
    v_add_f32 v20, v20, v38
    v_add_f32 v21, v21, v32
    v_mfma_f32_16x16x32_bf16 v[176:179], a[176:179], a[112:115], v[176:179]
    ds_read_b64_tr_b16 a[168:169], v16 offset:160
    v_lshlrev_b32 v38, 16, v33
    v_mfma_f32_16x16x32_bf16 v[240:243], a[180:183], a[112:115], v[240:243]
    ds_read_b64_tr_b16 a[170:171], v16 offset:1952
    v_and_b32 v33, 0xffff0000, v33
    v_mfma_f32_16x16x32_bf16 v[244:247], a[180:183], a[116:119], v[244:247]
    buffer_load_dwordx4 v63, s[44:47], s59 offen offset:1024 lds
    v_mfma_f32_16x16x32_bf16 v[180:183], a[176:179], a[116:119], v[180:183]
    ds_read_b64_tr_b16 a[172:173], v16 offset:7328
    v_add_f32 v22, v22, v38
    v_mfma_f32_16x16x32_bf16 v[184:187], a[176:179], a[120:123], v[184:187]
    ds_read_b64_tr_b16 a[174:175], v16 offset:9120
    v_add_f32 v23, v23, v33
    v_mfma_f32_16x16x32_bf16 v[248:251], a[180:183], a[120:123], v[248:251]
    buffer_load_dwordx4 v62, s[44:47], s59 offen offset:2048 lds
    v_mfma_f32_16x16x32_bf16 v[252:255], a[180:183], a[124:127], v[252:255]
    v_lshlrev_b32 v38, 16, v34
    v_and_b32 v34, 0xffff0000, v34
    v_mfma_f32_16x16x32_bf16 v[188:191], a[176:179], a[124:127], v[188:191]
    s_waitcnt lgkmcnt(4)
    v_add_f32 v24, v24, v38
    v_add_f32 v25, v25, v34
    v_mfma_f32_16x16x32_bf16 a[12:15], a[160:163], a[124:127], a[12:15]
    ds_read_b64_tr_b16 a[176:177], v17 offset:0
    v_lshlrev_b32 v38, 16, v35
    v_mfma_f32_16x16x32_bf16 a[60:63], a[164:167], a[124:127], a[60:63]
    ds_read_b64_tr_b16 a[178:179], v17 offset:1792
    v_and_b32 v35, 0xffff0000, v35
    v_mfma_f32_16x16x32_bf16 a[56:59], a[164:167], a[120:123], a[56:59]
    buffer_load_dwordx4 v63, s[44:47], s59 offen offset:3072 lds
    v_mfma_f32_16x16x32_bf16 a[8:11], a[160:163], a[120:123], a[8:11]
    s_add_u32 s59, s59, 128
    ds_read_b64_tr_b16 a[180:181], v17 offset:7168
    v_add_f32 v26, v26, v38
    v_mfma_f32_16x16x32_bf16 a[4:7], a[160:163], a[116:119], a[4:7]
    ds_read_b64_tr_b16 a[182:183], v17 offset:8960
    v_add_f32 v27, v27, v35
    v_mfma_f32_16x16x32_bf16 a[52:55], a[164:167], a[116:119], a[52:55]
    buffer_load_dwordx4 v[58:61], v36, s[44:47], s75 offen offset:1024
    v_mfma_f32_16x16x32_bf16 a[48:51], a[164:167], a[112:115], a[48:51]
    buffer_load_dwordx4 v[42:45], v36, s[8:11], s74 offen offset:1024
    v_mfma_f32_16x16x32_bf16 a[0:3], a[160:163], a[112:115], a[0:3]
    s_waitcnt vmcnt(10) lgkmcnt(4)
    s_barrier
    v_mfma_f32_16x16x32_bf16 a[16:19], a[168:171], a[112:115], a[16:19]
    ds_read_b128 a[160:163], v14 offset:14336
    v_add_u32 v16, s15, v16
    v_mfma_f32_16x16x32_bf16 a[64:67], a[172:175], a[112:115], a[64:67]
    v_add_u32 v17, s15, v17
    v_mfma_f32_16x16x32_bf16 a[68:71], a[172:175], a[116:119], a[68:71]
    buffer_load_dwordx4 v[32:35], v40, s[4:7], s84 offen
    v_mfma_f32_16x16x32_bf16 a[20:23], a[168:171], a[116:119], a[20:23]
    s_add_u32 s84, s84, 458752
    ds_read_b128 a[164:167], v14 offset:18432
    v_mfma_f32_16x16x32_bf16 a[24:27], a[168:171], a[120:123], a[24:27]
    buffer_load_dword v0, v2, s[24:27], s85 offen
    v_mfma_f32_16x16x32_bf16 a[72:75], a[172:175], a[120:123], a[72:75]
    s_add_u32 s85, s85, 1048576
    v_mfma_f32_16x16x32_bf16 a[76:79], a[172:175], a[124:127], a[76:79]
    v_mfma_f32_16x16x32_bf16 a[28:31], a[168:171], a[124:127], a[28:31]
    s_waitcnt lgkmcnt(2)
    v_mfma_f32_16x16x32_bf16 a[44:47], a[176:179], a[124:127], a[44:47]
    ds_read_b128 a[168:171], v14 offset:16384
    v_mfma_f32_16x16x32_bf16 a[92:95], a[180:183], a[124:127], a[92:95]
    v_mfma_f32_16x16x32_bf16 a[88:91], a[180:183], a[120:123], a[88:91]
    v_mfma_f32_16x16x32_bf16 a[40:43], a[176:179], a[120:123], a[40:43]
    ds_read_b128 a[172:175], v14 offset:20480
    v_mfma_f32_16x16x32_bf16 a[36:39], a[176:179], a[116:119], a[36:39]
    v_mfma_f32_16x16x32_bf16 a[84:87], a[180:183], a[116:119], a[84:87]
    v_mfma_f32_16x16x32_bf16 a[80:83], a[180:183], a[112:115], a[80:83]
    v_mfma_f32_16x16x32_bf16 a[32:35], a[176:179], a[112:115], a[32:35]
    s_waitcnt lgkmcnt(2)
    v_mfma_f32_16x16x32_bf16 v[64:67], a[128:131], a[160:163], v[64:67]
    ds_read_b64_tr_b16 a[176:177], v12 offset:0
    v_mfma_f32_16x16x32_bf16 v[68:71], a[128:131], a[164:167], v[68:71]
LF_pad1:
    s_cbranch_execz LF_pad5
    s_mov_b32 m0, s63
    ds_read_b64_tr_b16 a[178:179], v12 offset:1792
    v_mfma_f32_16x16x32_bf16 v[84:87], a[132:135], a[164:167], v[84:87]
    buffer_load_dwordx4 v3, s[4:7], s56 offen offset:0  lds
    v_mfma_f32_16x16x32_bf16 v[80:83], a[132:135], a[160:163], v[80:83]
    ds_read_b64_tr_b16 a[180:181], v12 offset:7168
    v_mfma_f32_16x16x32_bf16 v[96:99], a[136:139], a[160:163], v[96:99]
    ds_read_b64_tr_b16 a[182:183], v12 offset:8960
    v_mfma_f32_16x16x32_bf16 v[100:103], a[136:139], a[164:167], v[100:103]
    v_mfma_f32_16x16x32_bf16 v[116:119], a[140:143], a[164:167], v[116:119]
    v_mfma_f32_16x16x32_bf16 v[112:115], a[140:143], a[160:163], v[112:115]
    s_waitcnt lgkmcnt(4)
    v_mfma_f32_16x16x32_bf16 v[120:123], a[140:143], a[168:171], v[120:123]
    ds_read_b64_tr_b16 a[160:161], v12 offset:32
    v_mfma_f32_16x16x32_bf16 v[124:127], a[140:143], a[172:175], v[124:127]
    ds_read_b64_tr_b16 a[162:163], v12 offset:1824
    v_mfma_f32_16x16x32_bf16 v[108:111], a[136:139], a[172:175], v[108:111]
    buffer_load_dwordx4 v4, s[4:7], s56 offen offset:1024  lds
    v_mfma_f32_16x16x32_bf16 v[104:107], a[136:139], a[168:171], v[104:107]
    ds_read_b64_tr_b16 a[164:165], v12 offset:7200
    v_mfma_f32_16x16x32_bf16 v[88:91], a[132:135], a[168:171], v[88:91]
    ds_read_b64_tr_b16 a[166:167], v12 offset:8992
    v_mfma_f32_16x16x32_bf16 v[92:95], a[132:135], a[172:175], v[92:95]
    v_mfma_f32_16x16x32_bf16 v[76:79], a[128:131], a[172:175], v[76:79]
    v_mfma_f32_16x16x32_bf16 v[72:75], a[128:131], a[168:171], v[72:75]
    s_waitcnt lgkmcnt(4)
    v_mfma_f32_16x16x32_bf16 v[128:131], a[176:179], a[128:131], v[128:131]
    ds_read_b64_tr_b16 a[168:169], v12 offset:64
    v_mfma_f32_16x16x32_bf16 v[192:195], a[180:183], a[128:131], v[192:195]
    ds_read_b64_tr_b16 a[170:171], v12 offset:1856
    v_mfma_f32_16x16x32_bf16 v[196:199], a[180:183], a[132:135], v[196:199]
    buffer_load_dwordx4 v5, s[4:7], s56 offen offset:2048  lds
    v_mfma_f32_16x16x32_bf16 v[132:135], a[176:179], a[132:135], v[132:135]
    ds_read_b64_tr_b16 a[172:173], v12 offset:7232
    v_mfma_f32_16x16x32_bf16 v[136:139], a[176:179], a[136:139], v[136:139]
    ds_read_b64_tr_b16 a[174:175], v12 offset:9024
    v_mfma_f32_16x16x32_bf16 v[200:203], a[180:183], a[136:139], v[200:203]
    v_mfma_f32_16x16x32_bf16 v[204:207], a[180:183], a[140:143], v[204:207]
    v_mfma_f32_16x16x32_bf16 v[140:143], a[176:179], a[140:143], v[140:143]
    s_waitcnt lgkmcnt(4)
    v_mfma_f32_16x16x32_bf16 v[156:159], a[160:163], a[140:143], v[156:159]
    ds_read_b64_tr_b16 a[176:177], v12 offset:96
    v_mfma_f32_16x16x32_bf16 v[220:223], a[164:167], a[140:143], v[220:223]
    ds_read_b64_tr_b16 a[178:179], v12 offset:1888
    v_mfma_f32_16x16x32_bf16 v[216:219], a[164:167], a[136:139], v[216:219]
    buffer_load_dwordx4 v6, s[4:7], s56 offen offset:3072  lds
    v_mfma_f32_16x16x32_bf16 v[152:155], a[160:163], a[136:139], v[152:155]
    ds_read_b64_tr_b16 a[180:181], v12 offset:7264
    v_mfma_f32_16x16x32_bf16 v[148:151], a[160:163], a[132:135], v[148:151]
    ds_read_b64_tr_b16 a[182:183], v12 offset:9056
    v_mfma_f32_16x16x32_bf16 v[212:215], a[164:167], a[132:135], v[212:215]
    v_mfma_f32_16x16x32_bf16 v[208:211], a[164:167], a[128:131], v[208:211]
    buffer_load_dwordx4 v[54:57], v36, s[44:47], s75 offen offset:1536
    v_mfma_f32_16x16x32_bf16 v[144:147], a[160:163], a[128:131], v[144:147]
    s_waitcnt lgkmcnt(4)
    buffer_load_dwordx4 v[50:53], v36, s[8:11], s74 offen offset:1536
    v_mfma_f32_16x16x32_bf16 v[160:163], a[168:171], a[128:131], v[160:163]
    ds_read_b64_tr_b16 a[160:161], v12 offset:128
    v_mfma_f32_16x16x32_bf16 v[224:227], a[172:175], a[128:131], v[224:227]
    s_add_u32 m0, s63, 4096
    ds_read_b64_tr_b16 a[162:163], v12 offset:1920
    v_mfma_f32_16x16x32_bf16 v[228:231], a[172:175], a[132:135], v[228:231]
    buffer_load_dwordx4 v7, s[4:7], s56 offen offset:0  lds
    v_mfma_f32_16x16x32_bf16 v[164:167], a[168:171], a[132:135], v[164:167]
    ds_read_b64_tr_b16 a[164:165], v12 offset:7296
    v_mfma_f32_16x16x32_bf16 v[168:171], a[168:171], a[136:139], v[168:171]
    ds_read_b64_tr_b16 a[166:167], v12 offset:9088
    v_mfma_f32_16x16x32_bf16 v[232:235], a[172:175], a[136:139], v[232:235]
    v_mfma_f32_16x16x32_bf16 v[236:239], a[172:175], a[140:143], v[236:239]
    v_mfma_f32_16x16x32_bf16 v[172:175], a[168:171], a[140:143], v[172:175]
    s_waitcnt lgkmcnt(4)
    v_mfma_f32_16x16x32_bf16 v[188:191], a[176:179], a[140:143], v[188:191]
    ds_read_b64_tr_b16 a[168:169], v12 offset:160
    v_mfma_f32_16x16x32_bf16 v[252:255], a[180:183], a[140:143], v[252:255]
    ds_read_b64_tr_b16 a[170:171], v12 offset:1952
    v_mfma_f32_16x16x32_bf16 v[248:251], a[180:183], a[136:139], v[248:251]
    buffer_load_dwordx4 v8, s[4:7], s56 offen offset:1024  lds
    v_mfma_f32_16x16x32_bf16 v[184:187], a[176:179], a[136:139], v[184:187]
    ds_read_b64_tr_b16 a[172:173], v12 offset:7328
    v_mfma_f32_16x16x32_bf16 v[180:183], a[176:179], a[132:135], v[180:183]
    ds_read_b64_tr_b16 a[174:175], v12 offset:9120
    v_mfma_f32_16x16x32_bf16 v[244:247], a[180:183], a[132:135], v[244:247]
    v_mfma_f32_16x16x32_bf16 v[240:243], a[180:183], a[128:131], v[240:243]
    v_mfma_f32_16x16x32_bf16 v[176:179], a[176:179], a[128:131], v[176:179]
    s_waitcnt lgkmcnt(4)
    v_mfma_f32_16x16x32_bf16 a[0:3], a[160:163], a[128:131], a[0:3]
    ds_read_b64_tr_b16 a[176:177], v13 offset:0
    v_mfma_f32_16x16x32_bf16 a[48:51], a[164:167], a[128:131], a[48:51]
    ds_read_b64_tr_b16 a[178:179], v13 offset:1792
    v_mfma_f32_16x16x32_bf16 a[52:55], a[164:167], a[132:135], a[52:55]
    buffer_load_dwordx4 v9, s[4:7], s56 offen offset:2048  lds
    v_mfma_f32_16x16x32_bf16 a[4:7], a[160:163], a[132:135], a[4:7]
    ds_read_b64_tr_b16 a[180:181], v13 offset:7168
    v_mfma_f32_16x16x32_bf16 a[8:11], a[160:163], a[136:139], a[8:11]
    ds_read_b64_tr_b16 a[182:183], v13 offset:8960
    v_mfma_f32_16x16x32_bf16 a[56:59], a[164:167], a[136:139], a[56:59]
    v_mfma_f32_16x16x32_bf16 a[60:63], a[164:167], a[140:143], a[60:63]
    s_waitcnt vmcnt(17)
    ds_read_b128 a[96:99], v18 offset:0
    v_mfma_f32_16x16x32_bf16 a[12:15], a[160:163], a[140:143], a[12:15]
    s_waitcnt lgkmcnt(5)
    v_mfma_f32_16x16x32_bf16 a[28:31], a[168:171], a[140:143], a[28:31]
    s_mov_b32 m0, s64
    ds_read_b128 a[160:163], v15 offset:14336
    v_mfma_f32_16x16x32_bf16 a[76:79], a[172:175], a[140:143], a[76:79]
    buffer_load_dwordx4 v10, s[8:11], s57 offen offset:0  lds
    v_mfma_f32_16x16x32_bf16 a[72:75], a[172:175], a[136:139], a[72:75]
    ds_read_b128 a[112:115], v19 offset:0
    v_mfma_f32_16x16x32_bf16 a[24:27], a[168:171], a[136:139], a[24:27]
    ds_read_b128 a[164:167], v15 offset:18432
    v_mfma_f32_16x16x32_bf16 a[20:23], a[168:171], a[132:135], a[20:23]
    ds_read_b128 a[100:103], v18 offset:2048
    v_mfma_f32_16x16x32_bf16 a[68:71], a[172:175], a[132:135], a[68:71]
    v_mfma_f32_16x16x32_bf16 a[64:67], a[172:175], a[128:131], a[64:67]
    ds_read_b128 a[116:119], v19 offset:2048
    v_mfma_f32_16x16x32_bf16 a[16:19], a[168:171], a[128:131], a[16:19]
    s_waitcnt lgkmcnt(6)
    buffer_load_dwordx4 v11, s[8:11], s57 offen offset:1024  lds
    v_mfma_f32_16x16x32_bf16 a[32:35], a[176:179], a[128:131], a[32:35]
    s_add_u32 s56, s56, 458752
    s_add_u32 s57, s57, 128
    ds_read_b128 a[168:171], v15 offset:16384
    v_mfma_f32_16x16x32_bf16 a[80:83], a[180:183], a[128:131], a[80:83]
    s_add_u32 s62, s62, 22528
    s_cmp_eq_u32 s62, 45056
    s_cselect_b32 s62, 102400, s62
    v_mfma_f32_16x16x32_bf16 a[84:87], a[180:183], a[132:135], a[84:87]
    s_cmp_eq_u32 s62, 124928
    s_cselect_b32 s62, 0, s62
    s_add_u32 s12, s12, 14336
    v_mfma_f32_16x16x32_bf16 a[36:39], a[176:179], a[132:135], a[36:39]
    s_cmp_eq_u32 s12, 102400
    s_cselect_b32 s12, 45056, s12
    ds_read_b128 a[172:175], v15 offset:20480
    v_mfma_f32_16x16x32_bf16 a[40:43], a[176:179], a[136:139], a[40:43]
    s_bitcmp1_b32 s48, 0
    s_cselect_b32 s63, s12, s62
    s_add_u32 s63, s63, s60
    v_mfma_f32_16x16x32_bf16 a[88:91], a[180:183], a[136:139], a[88:91]
    s_add_u32 s64, s61, s62
    v_mfma_f32_16x16x32_bf16 a[92:95], a[180:183], a[140:143], a[92:95]
    s_waitcnt vmcnt(13)
    v_lshlrev_b32 v39, 16, v42
    v_and_b32 v42, 0xffff0000, v42
    v_mfma_f32_16x16x32_bf16 a[44:47], a[176:179], a[140:143], a[44:47]
    s_waitcnt lgkmcnt(4)
    v_add_f32 v28, v28, v39
    v_add_f32 v28, v28, v42
    v_mfma_f32_16x16x32_bf16 v[112:115], a[156:159], a[160:163], v[112:115]
    ds_read_b64_tr_b16 a[176:177], v16 offset:0
    v_lshlrev_b32 v39, 16, v58
    v_mfma_f32_16x16x32_bf16 v[116:119], a[156:159], a[164:167], v[116:119]
    s_mov_b32 m0, s78
    ds_read_b64_tr_b16 a[178:179], v16 offset:1792
    v_and_b32 v58, 0xffff0000, v58
    v_mfma_f32_16x16x32_bf16 v[100:103], a[152:155], a[164:167], v[100:103]
    s_waitcnt lgkmcnt(4)
    buffer_load_dwordx4 v62, s[44:47], s58 offen offset:0 lds
    v_mfma_f32_16x16x32_bf16 v[96:99], a[152:155], a[160:163], v[96:99]
    ds_read_b64_tr_b16 a[180:181], v16 offset:7168
    v_sub_f32 v39, v39, v31
    v_mfma_f32_16x16x32_bf16 v[80:83], a[148:151], a[160:163], v[80:83]
    s_add_u32 s14, s65, 22528
    ds_read_b64_tr_b16 a[182:183], v16 offset:8960
    v_sub_f32 v58, v58, v31
    v_mfma_f32_16x16x32_bf16 v[84:87], a[148:151], a[164:167], v[84:87]
    s_cmp_eq_u32 s14, 45056
    s_cselect_b32 s14, 102400, s14
    v_add_f32 v29, v29, v39
    v_mfma_f32_16x16x32_bf16 v[68:71], a[144:147], a[164:167], v[68:71]
    s_cmp_eq_u32 s14, 124928
    s_cselect_b32 s14, 0, s14
    v_fmac_f32 v30, v39, v39
    v_mfma_f32_16x16x32_bf16 v[64:67], a[144:147], a[160:163], v[64:67]
    s_waitcnt lgkmcnt(4)
    buffer_load_dwordx4 v63, s[44:47], s58 offen offset:1024 lds
    v_mfma_f32_16x16x32_bf16 v[72:75], a[144:147], a[168:171], v[72:75]
    s_sub_u32 s65, s14, s65
    ds_read_b64_tr_b16 a[160:161], v16 offset:32
    v_add_u32 v12, s65, v12
    v_mfma_f32_16x16x32_bf16 v[76:79], a[144:147], a[172:175], v[76:79]
    ds_read_b64_tr_b16 a[162:163], v16 offset:1824
    v_add_u32 v13, s65, v13
    v_mfma_f32_16x16x32_bf16 v[92:95], a[148:151], a[172:175], v[92:95]
    v_add_u32 v14, s65, v14
    v_add_u32 v15, s65, v15
    v_mfma_f32_16x16x32_bf16 v[88:91], a[148:151], a[168:171], v[88:91]
    s_mov_b32 s65, s14
    ds_read_b64_tr_b16 a[164:165], v16 offset:7200
    v_add_f32 v29, v29, v58
    v_mfma_f32_16x16x32_bf16 v[104:107], a[152:155], a[168:171], v[104:107]
    s_add_u32 s14, s13, 14336
    ds_read_b64_tr_b16 a[166:167], v16 offset:8992
    v_fmac_f32 v30, v58, v58
    v_mfma_f32_16x16x32_bf16 v[108:111], a[152:155], a[172:175], v[108:111]
    s_cmp_eq_u32 s14, 102400
    s_cselect_b32 s14, 45056, s14
    v_lshlrev_b32 v39, 16, v43
    v_mfma_f32_16x16x32_bf16 v[124:127], a[156:159], a[172:175], v[124:127]
    s_sub_u32 s15, s14, s13
    ds_read_b128 a[104:107], v18 offset:4096
    v_mfma_f32_16x16x32_bf16 v[120:123], a[156:159], a[168:171], v[120:123]
    s_waitcnt lgkmcnt(5)
    buffer_load_dwordx4 v62, s[44:47], s58 offen offset:2048 lds
    v_mfma_f32_16x16x32_bf16 v[140:143], a[176:179], a[156:159], v[140:143]
    s_mov_b32 s13, s14
    ds_read_b64_tr_b16 a[168:169], v16 offset:64
    v_and_b32 v43, 0xffff0000, v43
    v_mfma_f32_16x16x32_bf16 v[204:207], a[180:183], a[156:159], v[204:207]
    ds_read_b64_tr_b16 a[170:171], v16 offset:1856
    v_add_f32 v28, v28, v39
    v_mfma_f32_16x16x32_bf16 v[200:203], a[180:183], a[152:155], v[200:203]
    ds_read_b128 a[120:123], v19 offset:4096
    v_add_f32 v28, v28, v43
    v_mfma_f32_16x16x32_bf16 v[136:139], a[176:179], a[152:155], v[136:139]
    ds_read_b64_tr_b16 a[172:173], v16 offset:7232
    v_lshlrev_b32 v39, 16, v59
    v_mfma_f32_16x16x32_bf16 v[132:135], a[176:179], a[148:151], v[132:135]
    ds_read_b64_tr_b16 a[174:175], v16 offset:9024
    v_and_b32 v59, 0xffff0000, v59
    v_mfma_f32_16x16x32_bf16 v[196:199], a[180:183], a[148:151], v[196:199]
    ds_read_b128 a[108:111], v18 offset:6144
    v_sub_f32 v39, v39, v31
    v_mfma_f32_16x16x32_bf16 v[192:195], a[180:183], a[144:147], v[192:195]
    buffer_load_dwordx4 v63, s[44:47], s58 offen offset:3072 lds
    v_mfma_f32_16x16x32_bf16 v[128:131], a[176:179], a[144:147], v[128:131]
    s_waitcnt lgkmcnt(7)
    ds_read_b128 a[124:127], v19 offset:6144
    v_sub_f32 v59, v59, v31
    v_mfma_f32_16x16x32_bf16 v[144:147], a[160:163], a[144:147], v[144:147]
    s_add_u32 s58, s58, 128
    ds_read_b64_tr_b16 a[176:177], v16 offset:96
    v_add_f32 v29, v29, v39
    v_mfma_f32_16x16x32_bf16 v[208:211], a[164:167], a[144:147], v[208:211]
    ds_read_b64_tr_b16 a[178:179], v16 offset:1888
    v_fmac_f32 v30, v39, v39
    v_mfma_f32_16x16x32_bf16 v[212:215], a[164:167], a[148:151], v[212:215]
    v_add_f32 v29, v29, v59
    v_fmac_f32 v30, v59, v59
    v_mfma_f32_16x16x32_bf16 v[148:151], a[160:163], a[148:151], v[148:151]
    ds_read_b64_tr_b16 a[180:181], v16 offset:7264
    v_lshlrev_b32 v39, 16, v44
    v_mfma_f32_16x16x32_bf16 v[152:155], a[160:163], a[152:155], v[152:155]
    ds_read_b64_tr_b16 a[182:183], v16 offset:9056
    v_and_b32 v44, 0xffff0000, v44
    v_mfma_f32_16x16x32_bf16 v[216:219], a[164:167], a[152:155], v[216:219]
    v_add_f32 v28, v28, v39
    v_add_f32 v28, v28, v44
    v_mfma_f32_16x16x32_bf16 v[220:223], a[164:167], a[156:159], v[220:223]
    s_waitcnt vmcnt(16)
    v_lshlrev_b32 v38, 16, v32
    v_and_b32 v32, 0xffff0000, v32
    v_mfma_f32_16x16x32_bf16 v[156:159], a[160:163], a[156:159], v[156:159]
    s_waitcnt lgkmcnt(6)
    v_add_f32 v20, v20, v38
    v_add_f32 v21, v21, v32
    v_mfma_f32_16x16x32_bf16 v[172:175], a[168:171], a[156:159], v[172:175]
    ds_read_b64_tr_b16 a[160:161], v16 offset:128
    v_lshlrev_b32 v38, 16, v33
    v_mfma_f32_16x16x32_bf16 v[236:239], a[172:175], a[156:159], v[236:239]
    s_add_u32 m0, s78, 4096
    ds_read_b64_tr_b16 a[162:163], v16 offset:1920
    v_and_b32 v33, 0xffff0000, v33
    v_mfma_f32_16x16x32_bf16 v[232:235], a[172:175], a[152:155], v[232:235]
    s_waitcnt lgkmcnt(6)
    buffer_load_dwordx4 v62, s[44:47], s59 offen offset:0 lds
    v_mfma_f32_16x16x32_bf16 v[168:171], a[168:171], a[152:155], v[168:171]
    ds_read_b64_tr_b16 a[164:165], v16 offset:7296
    v_add_f32 v22, v22, v38
    v_mfma_f32_16x16x32_bf16 v[164:167], a[168:171], a[148:151], v[164:167]
    ds_read_b64_tr_b16 a[166:167], v16 offset:9088
    v_add_f32 v23, v23, v33
    v_mfma_f32_16x16x32_bf16 v[228:231], a[172:175], a[148:151], v[228:231]
    v_lshlrev_b32 v38, 16, v34
    v_and_b32 v34, 0xffff0000, v34
    v_mfma_f32_16x16x32_bf16 v[224:227], a[172:175], a[144:147], v[224:227]
    buffer_load_dwordx4 v63, s[44:47], s59 offen offset:1024 lds
    v_mfma_f32_16x16x32_bf16 v[160:163], a[168:171], a[144:147], v[160:163]
    s_waitcnt lgkmcnt(4)
    v_add_f32 v24, v24, v38
    v_add_f32 v25, v25, v34
    v_mfma_f32_16x16x32_bf16 v[176:179], a[176:179], a[144:147], v[176:179]
    ds_read_b64_tr_b16 a[168:169], v16 offset:160
    v_lshlrev_b32 v38, 16, v35
    v_mfma_f32_16x16x32_bf16 v[240:243], a[180:183], a[144:147], v[240:243]
    ds_read_b64_tr_b16 a[170:171], v16 offset:1952
    v_and_b32 v35, 0xffff0000, v35
    v_mfma_f32_16x16x32_bf16 v[244:247], a[180:183], a[148:151], v[244:247]
    buffer_load_dwordx4 v62, s[44:47], s59 offen offset:2048 lds
    v_mfma_f32_16x16x32_bf16 v[180:183], a[176:179], a[148:151], v[180:183]
    ds_read_b64_tr_b16 a[172:173], v16 offset:7328
    v_add_f32 v26, v26, v38
    v_mfma_f32_16x16x32_bf16 v[184:187], a[176:179], a[152:155], v[184:187]
    ds_read_b64_tr_b16 a[174:175], v16 offset:9120
    v_add_f32 v27, v27, v35
    v_mfma_f32_16x16x32_bf16 v[248:251], a[180:183], a[152:155], v[248:251]
    v_lshlrev_b32 v39, 16, v60
    v_and_b32 v60, 0xffff0000, v60
    v_mfma_f32_16x16x32_bf16 v[252:255], a[180:183], a[156:159], v[252:255]
    buffer_load_dwordx4 v63, s[44:47], s59 offen offset:3072 lds
    v_mfma_f32_16x16x32_bf16 v[188:191], a[176:179], a[156:159], v[188:191]
    s_waitcnt lgkmcnt(4)
    v_sub_f32 v39, v39, v31
    v_sub_f32 v60, v60, v31
    v_mfma_f32_16x16x32_bf16 a[12:15], a[160:163], a[156:159], a[12:15]
    s_add_u32 s59, s59, 128
    ds_read_b64_tr_b16 a[176:177], v17 offset:0
    v_add_f32 v29, v29, v39
    v_mfma_f32_16x16x32_bf16 a[60:63], a[164:167], a[156:159], a[60:63]
    ds_read_b64_tr_b16 a[178:179], v17 offset:1792
    v_fmac_f32 v30, v39, v39
    v_mfma_f32_16x16x32_bf16 a[56:59], a[164:167], a[152:155], a[56:59]
    v_add_f32 v29, v29, v60
    v_fmac_f32 v30, v60, v60
    v_mfma_f32_16x16x32_bf16 a[8:11], a[160:163], a[152:155], a[8:11]
    ds_read_b64_tr_b16 a[180:181], v17 offset:7168
    v_lshlrev_b32 v39, 16, v45
    v_mfma_f32_16x16x32_bf16 a[4:7], a[160:163], a[148:151], a[4:7]
    ds_read_b64_tr_b16 a[182:183], v17 offset:8960
    v_and_b32 v45, 0xffff0000, v45
    v_mfma_f32_16x16x32_bf16 a[52:55], a[164:167], a[148:151], a[52:55]
    v_add_f32 v28, v28, v39
    v_add_f32 v28, v28, v45
    v_mfma_f32_16x16x32_bf16 a[48:51], a[164:167], a[144:147], a[48:51]
    buffer_load_dwordx4 v[32:35], v40, s[4:7], s84 offen
    v_mfma_f32_16x16x32_bf16 a[0:3], a[160:163], a[144:147], a[0:3]
    s_waitcnt vmcnt(9) lgkmcnt(4)
    s_barrier
    v_lshlrev_b32 v39, 16, v61
    v_mfma_f32_16x16x32_bf16 a[16:19], a[168:171], a[144:147], a[16:19]
    s_add_u32 s84, s84, 458752
    ds_read_b128 a[160:163], v14 offset:14336
    v_add_u32 v16, s15, v16
    v_mfma_f32_16x16x32_bf16 a[64:67], a[172:175], a[144:147], a[64:67]
    v_add_u32 v17, s15, v17
    v_and_b32 v61, 0xffff0000, v61
    v_mfma_f32_16x16x32_bf16 a[68:71], a[172:175], a[148:151], a[68:71]
    buffer_load_dword v0, v2, s[24:27], s85 offen
    v_mfma_f32_16x16x32_bf16 a[20:23], a[168:171], a[148:151], a[20:23]
    s_add_u32 s85, s85, 1048576
    ds_read_b128 a[164:167], v14 offset:18432
    v_sub_f32 v39, v39, v31
    v_mfma_f32_16x16x32_bf16 a[24:27], a[168:171], a[152:155], a[24:27]
    v_sub_f32 v61, v61, v31
    v_add_f32 v29, v29, v39
    v_mfma_f32_16x16x32_bf16 a[72:75], a[172:175], a[152:155], a[72:75]
    v_fmac_f32 v30, v39, v39
    v_add_f32 v29, v29, v61
    v_mfma_f32_16x16x32_bf16 a[76:79], a[172:175], a[156:159], a[76:79]
    v_fmac_f32 v30, v61, v61
    v_mfma_f32_16x16x32_bf16 a[28:31], a[168:171], a[156:159], a[28:31]
    s_waitcnt lgkmcnt(2)
    buffer_load_dword v0, v41, s[36:39], s82 offen sc1
    v_mfma_f32_16x16x32_bf16 a[44:47], a[176:179], a[156:159], a[44:47]
    ds_read_b128 a[168:171], v14 offset:16384
    v_mfma_f32_16x16x32_bf16 a[92:95], a[180:183], a[156:159], a[92:95]
    buffer_load_dword v0, v41, s[36:39], s83 offen sc1
    v_mfma_f32_16x16x32_bf16 a[88:91], a[180:183], a[152:155], a[88:91]
    v_lshlrev_b32 v39, 16, v50
    v_and_b32 v50, 0xffff0000, v50
    v_mfma_f32_16x16x32_bf16 a[40:43], a[176:179], a[152:155], a[40:43]
    ds_read_b128 a[172:175], v14 offset:20480
    v_add_f32 v28, v28, v39
    v_mfma_f32_16x16x32_bf16 a[36:39], a[176:179], a[148:151], a[36:39]
    v_add_f32 v28, v28, v50
    v_lshlrev_b32 v39, 16, v54
    v_mfma_f32_16x16x32_bf16 a[84:87], a[180:183], a[148:151], a[84:87]
    v_and_b32 v54, 0xffff0000, v54
    v_sub_f32 v39, v39, v31
    v_mfma_f32_16x16x32_bf16 a[80:83], a[180:183], a[144:147], a[80:83]
    v_sub_f32 v54, v54, v31
    v_add_f32 v29, v29, v39
    v_mfma_f32_16x16x32_bf16 a[32:35], a[176:179], a[144:147], a[32:35]
    s_waitcnt lgkmcnt(2)
    v_fmac_f32 v30, v39, v39
    v_add_f32 v29, v29, v54
    v_mfma_f32_16x16x32_bf16 v[64:67], a[96:99], a[160:163], v[64:67]
    ds_read_b64_tr_b16 a[176:177], v12 offset:0
    v_fmac_f32 v30, v54, v54
    v_mfma_f32_16x16x32_bf16 v[68:71], a[96:99], a[164:167], v[68:71]
    s_mov_b32 m0, s63
    ds_read_b64_tr_b16 a[178:179], v12 offset:1792
    v_lshlrev_b32 v39, 16, v51
    v_mfma_f32_16x16x32_bf16 v[84:87], a[100:103], a[164:167], v[84:87]
    buffer_load_dwordx4 v3, s[4:7], s56 offen offset:0  lds
    v_mfma_f32_16x16x32_bf16 v[80:83], a[100:103], a[160:163], v[80:83]
    ds_read_b64_tr_b16 a[180:181], v12 offset:7168
    v_and_b32 v51, 0xffff0000, v51
    v_mfma_f32_16x16x32_bf16 v[96:99], a[104:107], a[160:163], v[96:99]
    ds_read_b64_tr_b16 a[182:183], v12 offset:8960
    v_add_f32 v28, v28, v39
    v_mfma_f32_16x16x32_bf16 v[100:103], a[104:107], a[164:167], v[100:103]
    v_add_f32 v28, v28, v51
    v_lshlrev_b32 v39, 16, v55
    v_mfma_f32_16x16x32_bf16 v[116:119], a[108:111], a[164:167], v[116:119]
    v_and_b32 v55, 0xffff0000, v55
    v_sub_f32 v39, v39, v31
    v_mfma_f32_16x16x32_bf16 v[112:115], a[108:111], a[160:163], v[112:115]
    s_waitcnt lgkmcnt(4)
    v_sub_f32 v55, v55, v31
    v_add_f32 v29, v29, v39
    v_mfma_f32_16x16x32_bf16 v[120:123], a[108:111], a[168:171], v[120:123]
    ds_read_b64_tr_b16 a[160:161], v12 offset:32
    v_fmac_f32 v30, v39, v39
    v_mfma_f32_16x16x32_bf16 v[124:127], a[108:111], a[172:175], v[124:127]
    ds_read_b64_tr_b16 a[162:163], v12 offset:1824
    v_add_f32 v29, v29, v55
    v_mfma_f32_16x16x32_bf16 v[108:111], a[104:107], a[172:175], v[108:111]
    buffer_load_dwordx4 v4, s[4:7], s56 offen offset:1024  lds
    v_mfma_f32_16x16x32_bf16 v[104:107], a[104:107], a[168:171], v[104:107]
    ds_read_b64_tr_b16 a[164:165], v12 offset:7200
    v_fmac_f32 v30, v55, v55
    v_mfma_f32_16x16x32_bf16 v[88:91], a[100:103], a[168:171], v[88:91]
    ds_read_b64_tr_b16 a[166:167], v12 offset:8992
    v_lshlrev_b32 v39, 16, v52
    v_mfma_f32_16x16x32_bf16 v[92:95], a[100:103], a[172:175], v[92:95]
    v_and_b32 v52, 0xffff0000, v52
    v_add_f32 v28, v28, v39
    v_mfma_f32_16x16x32_bf16 v[76:79], a[96:99], a[172:175], v[76:79]
    v_add_f32 v28, v28, v52
    v_lshlrev_b32 v39, 16, v56
    v_mfma_f32_16x16x32_bf16 v[72:75], a[96:99], a[168:171], v[72:75]
    s_waitcnt lgkmcnt(4)
    v_and_b32 v56, 0xffff0000, v56
    v_sub_f32 v39, v39, v31
    v_mfma_f32_16x16x32_bf16 v[128:131], a[176:179], a[96:99], v[128:131]
    ds_read_b64_tr_b16 a[168:169], v12 offset:64
    v_sub_f32 v56, v56, v31
    v_mfma_f32_16x16x32_bf16 v[192:195], a[180:183], a[96:99], v[192:195]
    ds_read_b64_tr_b16 a[170:171], v12 offset:1856
    v_add_f32 v29, v29, v39
    v_mfma_f32_16x16x32_bf16 v[196:199], a[180:183], a[100:103], v[196:199]
    buffer_load_dwordx4 v5, s[4:7], s56 offen offset:2048  lds
    v_mfma_f32_16x16x32_bf16 v[132:135], a[176:179], a[100:103], v[132:135]
    ds_read_b64_tr_b16 a[172:173], v12 offset:7232
    v_fmac_f32 v30, v39, v39
    v_mfma_f32_16x16x32_bf16 v[136:139], a[176:179], a[104:107], v[136:139]
    ds_read_b64_tr_b16 a[174:175], v12 offset:9024
    v_add_f32 v29, v29, v56
    v_mfma_f32_16x16x32_bf16 v[200:203], a[180:183], a[104:107], v[200:203]
    v_fmac_f32 v30, v56, v56
    v_lshlrev_b32 v39, 16, v53
    v_mfma_f32_16x16x32_bf16 v[204:207], a[180:183], a[108:111], v[204:207]
    v_and_b32 v53, 0xffff0000, v53
    v_add_f32 v28, v28, v39
    v_mfma_f32_16x16x32_bf16 v[140:143], a[176:179], a[108:111], v[140:143]
    s_waitcnt lgkmcnt(4)
    v_add_f32 v28, v28, v53
    v_lshlrev_b32 v39, 16, v57
    v_mfma_f32_16x16x32_bf16 v[156:159], a[160:163], a[108:111], v[156:159]
    ds_read_b64_tr_b16 a[176:177], v12 offset:96
    v_and_b32 v57, 0xffff0000, v57
    v_mfma_f32_16x16x32_bf16 v[220:223], a[164:167], a[108:111], v[220:223]
    ds_read_b64_tr_b16 a[178:179], v12 offset:1888
    v_sub_f32 v39, v39, v31
    v_mfma_f32_16x16x32_bf16 v[216:219], a[164:167], a[104:107], v[216:219]
    buffer_load_dwordx4 v6, s[4:7], s56 offen offset:3072  lds
    v_mfma_f32_16x16x32_bf16 v[152:155], a[160:163], a[104:107], v[152:155]
    ds_read_b64_tr_b16 a[180:181], v12 offset:7264
    v_sub_f32 v57, v57, v31
    v_mfma_f32_16x16x32_bf16 v[148:151], a[160:163], a[100:103], v[148:151]
    ds_read_b64_tr_b16 a[182:183], v12 offset:9056
    v_add_f32 v29, v29, v39
    v_mfma_f32_16x16x32_bf16 v[212:215], a[164:167], a[100:103], v[212:215]
    v_fmac_f32 v30, v39, v39
    v_add_f32 v29, v29, v57
    v_mfma_f32_16x16x32_bf16 v[208:211], a[164:167], a[96:99], v[208:211]
    v_fmac_f32 v30, v57, v57
    v_mov_b32 v46, -1
    v_mfma_f32_16x16x32_bf16 v[144:147], a[160:163], a[96:99], v[144:147]
    s_waitcnt lgkmcnt(4)
    v_mov_b32 v47, -1
    v_mov_b32 v48, -1
    v_mfma_f32_16x16x32_bf16 v[160:163], a[168:171], a[96:99], v[160:163]
    ds_read_b64_tr_b16 a[160:161], v12 offset:128
    v_mov_b32 v49, -1
    v_mfma_f32_16x16x32_bf16 v[224:227], a[172:175], a[96:99], v[224:227]
    s_add_u32 m0, s63, 4096
    ds_read_b64_tr_b16 a[162:163], v12 offset:1920
    v_and_b32 v42, 0xff, v2
    v_mfma_f32_16x16x32_bf16 v[228:231], a[172:175], a[100:103], v[228:231]
    buffer_load_dwordx4 v7, s[4:7], s56 offen offset:0  lds
    v_mfma_f32_16x16x32_bf16 v[164:167], a[168:171], a[100:103], v[164:167]
    ds_read_b64_tr_b16 a[164:165], v12 offset:7296
    v_mfma_f32_16x16x32_bf16 v[168:171], a[168:171], a[104:107], v[168:171]
    ds_read_b64_tr_b16 a[166:167], v12 offset:9088
    v_mfma_f32_16x16x32_bf16 v[232:235], a[172:175], a[104:107], v[232:235]
    buffer_store_dwordx4 v[46:49], v42, s[36:39], s81 offen sc1
    v_mfma_f32_16x16x32_bf16 v[236:239], a[172:175], a[108:111], v[236:239]
    s_sub_u32 s81, 31, s49
    v_mfma_f32_16x16x32_bf16 v[172:175], a[168:171], a[108:111], v[172:175]
    s_waitcnt lgkmcnt(4)
    v_mfma_f32_16x16x32_bf16 v[188:191], a[176:179], a[108:111], v[188:191]
    s_lshl_b32 s81, s81, 8
    ds_read_b64_tr_b16 a[168:169], v12 offset:160
    v_mfma_f32_16x16x32_bf16 v[252:255], a[180:183], a[108:111], v[252:255]
    ds_read_b64_tr_b16 a[170:171], v12 offset:1952
    v_mfma_f32_16x16x32_bf16 v[248:251], a[180:183], a[104:107], v[248:251]
    buffer_load_dwordx4 v8, s[4:7], s56 offen offset:1024  lds
    v_mfma_f32_16x16x32_bf16 v[184:187], a[176:179], a[104:107], v[184:187]
    ds_read_b64_tr_b16 a[172:173], v12 offset:7328
    v_mfma_f32_16x16x32_bf16 v[180:183], a[176:179], a[100:103], v[180:183]
    ds_read_b64_tr_b16 a[174:175], v12 offset:9120
    v_mfma_f32_16x16x32_bf16 v[244:247], a[180:183], a[100:103], v[244:247]
    buffer_store_dwordx4 v[46:49], v42, s[20:23], s81 offen sc1
    v_mfma_f32_16x16x32_bf16 v[240:243], a[180:183], a[96:99], v[240:243]
    v_fmamk_f32 v42, v31, 0x42000000, v29
    v_mfma_f32_16x16x32_bf16 v[176:179], a[176:179], a[96:99], v[176:179]
    s_waitcnt lgkmcnt(4)
    v_mfma_f32_16x16x32_bf16 a[0:3], a[160:163], a[96:99], a[0:3]
    ds_read_b64_tr_b16 a[176:177], v13 offset:0
    v_add_f32_dpp v42, v42, v42 quad_perm:[1,0,3,2] row_mask:0xf bank_mask:0xf
    v_mfma_f32_16x16x32_bf16 a[48:51], a[164:167], a[96:99], a[48:51]
    ds_read_b64_tr_b16 a[178:179], v13 offset:1792
    v_add_f32_dpp v28, v28, v28 quad_perm:[1,0,3,2] row_mask:0xf bank_mask:0xf
    v_mfma_f32_16x16x32_bf16 a[52:55], a[164:167], a[100:103], a[52:55]
    buffer_load_dwordx4 v9, s[4:7], s56 offen offset:2048  lds
    v_mfma_f32_16x16x32_bf16 a[4:7], a[160:163], a[100:103], a[4:7]
    ds_read_b64_tr_b16 a[180:181], v13 offset:7168
    v_add_f32_dpp v42, v42, v42 quad_perm:[2,3,0,1] row_mask:0xf bank_mask:0xf
    v_mfma_f32_16x16x32_bf16 a[8:11], a[160:163], a[104:107], a[8:11]
    ds_read_b64_tr_b16 a[182:183], v13 offset:8960
    v_add_f32_dpp v28, v28, v28 quad_perm:[2,3,0,1] row_mask:0xf bank_mask:0xf
    v_mfma_f32_16x16x32_bf16 a[56:59], a[164:167], a[104:107], a[56:59]
    v_add_f32_dpp v42, v42, v42 row_half_mirror row_mask:0xf bank_mask:0xf
    v_add_f32_dpp v28, v28, v28 row_half_mirror row_mask:0xf bank_mask:0xf
    v_mfma_f32_16x16x32_bf16 a[60:63], a[164:167], a[108:111], a[60:63]
    s_waitcnt vmcnt(17)
    ds_read_b128 a[128:131], v18 offset:0
    v_add_f32_dpp v42, v42, v42 row_mirror row_mask:0xf bank_mask:0xf
    v_mfma_f32_16x16x32_bf16 a[12:15], a[160:163], a[108:111], a[12:15]
    s_waitcnt lgkmcnt(5)
    v_add_f32_dpp v28, v28, v28 row_mirror row_mask:0xf bank_mask:0xf
    v_mov_b32 v44, v42
    v_mfma_f32_16x16x32_bf16 a[28:31], a[168:171], a[108:111], a[28:31]
    s_mov_b32 m0, s64
    ds_read_b128 a[160:163], v15 offset:14336
    v_mov_b32 v45, v28
    v_mfma_f32_16x16x32_bf16 a[76:79], a[172:175], a[108:111], a[76:79]
    buffer_load_dwordx4 v10, s[8:11], s57 offen offset:0  lds
    v_mfma_f32_16x16x32_bf16 a[72:75], a[172:175], a[104:107], a[72:75]
    ds_read_b128 a[144:147], v19 offset:0
    v_permlane16_swap_b32 v42, v44
    v_mfma_f32_16x16x32_bf16 a[24:27], a[168:171], a[104:107], a[24:27]
    ds_read_b128 a[164:167], v15 offset:18432
    v_permlane16_swap_b32 v28, v45
    v_mfma_f32_16x16x32_bf16 a[20:23], a[168:171], a[100:103], a[20:23]
    ds_read_b128 a[132:135], v18 offset:2048
    v_add_f32 v42, v42, v44
    v_mfma_f32_16x16x32_bf16 a[68:71], a[172:175], a[100:103], a[68:71]
    v_add_f32 v28, v28, v45
    v_mul_f32 v42, 0x3a800000, v42
    v_mfma_f32_16x16x32_bf16 a[64:67], a[172:175], a[96:99], a[64:67]
    ds_read_b128 a[148:151], v19 offset:2048
    v_sub_f32 v31, v42, v31
    v_mfma_f32_16x16x32_bf16 a[16:19], a[168:171], a[96:99], a[16:19]
    s_waitcnt lgkmcnt(6)
    buffer_load_dwordx4 v11, s[8:11], s57 offen offset:1024  lds
    v_mfma_f32_16x16x32_bf16 a[32:35], a[176:179], a[96:99], a[32:35]
    s_add_u32 s56, s56, 458752
    ds_read_b128 a[168:171], v15 offset:16384
    v_mul_f32 v29, -2.0, v29
    v_mfma_f32_16x16x32_bf16 a[80:83], a[180:183], a[96:99], a[80:83]
    s_add_u32 s57, s57, 128
    v_fmamk_f32 v29, v31, 0x42000000, v29
    v_fmac_f32 v30, v31, v29
    v_mfma_f32_16x16x32_bf16 a[84:87], a[180:183], a[100:103], a[84:87]
    s_add_u32 s62, s62, 22528
    v_mfma_f32_16x16x32_bf16 a[36:39], a[176:179], a[100:103], a[36:39]
    s_cmp_eq_u32 s62, 45056
    s_cselect_b32 s62, 102400, s62
    ds_read_b128 a[172:175], v15 offset:20480
    v_mfma_f32_16x16x32_bf16 a[40:43], a[176:179], a[104:107], a[40:43]
    s_cmp_eq_u32 s62, 124928
    s_cselect_b32 s62, 0, s62
    v_add_f32_dpp v30, v30, v30 quad_perm:[1,0,3,2] row_mask:0xf bank_mask:0xf
    v_mfma_f32_16x16x32_bf16 a[88:91], a[180:183], a[104:107], a[88:91]
    s_add_u32 s12, s12, 14336
    v_lshrrev_b32 v29, 5, v1
    v_add_f32_dpp v30, v30, v30 quad_perm:[2,3,0,1] row_mask:0xf bank_mask:0xf
    v_mfma_f32_16x16x32_bf16 a[92:95], a[180:183], a[108:111], a[92:95]
    s_cmp_eq_u32 s12, 102400
    s_cselect_b32 s12, 45056, s12
    v_lshlrev_b32 v31, 3, v29
    v_mfma_f32_16x16x32_bf16 a[44:47], a[176:179], a[108:111], a[44:47]
    s_waitcnt lgkmcnt(4)
    v_add_f32_dpp v30, v30, v30 row_half_mirror row_mask:0xf bank_mask:0xf
    v_lshlrev_b32 v29, 2, v29
    v_mfma_f32_16x16x32_bf16 v[112:115], a[124:127], a[160:163], v[112:115]
    s_bitcmp1_b32 s48, 0
    s_cselect_b32 s63, s12, s62
    ds_read_b64_tr_b16 a[176:177], v16 offset:0
    v_mfma_f32_16x16x32_bf16 v[116:119], a[124:127], a[164:167], v[116:119]
    s_add_u32 s63, s63, s60
    s_mov_b32 m0, s78
    ds_read_b64_tr_b16 a[178:179], v16 offset:1792
    v_mfma_f32_16x16x32_bf16 v[100:103], a[120:123], a[164:167], v[100:103]
LF_pad2:
    s_cbranch_execz LF_pad6
    s_add_u32 s64, s61, s62
    s_waitcnt lgkmcnt(4)
    buffer_load_dwordx4 v62, s[44:47], s58 offen offset:0 lds
    v_mfma_f32_16x16x32_bf16 v[96:99], a[120:123], a[160:163], v[96:99]
    ds_read_b64_tr_b16 a[180:181], v16 offset:7168
    v_add_f32_dpp v30, v30, v30 row_mirror row_mask:0xf bank_mask:0xf
    v_mfma_f32_16x16x32_bf16 v[80:83], a[116:119], a[160:163], v[80:83]
    s_add_u32 s14, s65, 22528
    ds_read_b64_tr_b16 a[182:183], v16 offset:8960
    v_mov_b32 v44, v30
    v_mfma_f32_16x16x32_bf16 v[84:87], a[116:119], a[164:167], v[84:87]
    s_cmp_eq_u32 s14, 45056
    s_cselect_b32 s14, 102400, s14
    v_mfma_f32_16x16x32_bf16 v[68:71], a[112:115], a[164:167], v[68:71]
    s_cmp_eq_u32 s14, 124928
    s_cselect_b32 s14, 0, s14
    v_permlane16_swap_b32 v30, v44
    v_mfma_f32_16x16x32_bf16 v[64:67], a[112:115], a[160:163], v[64:67]
    s_waitcnt lgkmcnt(4)
    buffer_load_dwordx4 v63, s[44:47], s58 offen offset:1024 lds
    v_mfma_f32_16x16x32_bf16 v[72:75], a[112:115], a[168:171], v[72:75]
    s_sub_u32 s65, s14, s65
    ds_read_b64_tr_b16 a[160:161], v16 offset:32
    v_add_u32 v12, s65, v12
    v_mfma_f32_16x16x32_bf16 v[76:79], a[112:115], a[172:175], v[76:79]
    ds_read_b64_tr_b16 a[162:163], v16 offset:1824
    v_add_u32 v13, s65, v13
    v_mfma_f32_16x16x32_bf16 v[92:95], a[116:119], a[172:175], v[92:95]
    v_add_u32 v14, s65, v14
    v_add_u32 v15, s65, v15
    v_mfma_f32_16x16x32_bf16 v[88:91], a[116:119], a[168:171], v[88:91]
    s_mov_b32 s65, s14
    ds_read_b64_tr_b16 a[164:165], v16 offset:7200
    v_add_f32 v30, v30, v44
    v_mfma_f32_16x16x32_bf16 v[104:107], a[120:123], a[168:171], v[104:107]
    s_add_u32 s14, s13, 14336
    ds_read_b64_tr_b16 a[166:167], v16 offset:8992
    v_mul_f32 v43, 0x3a800000, v30
    v_mfma_f32_16x16x32_bf16 v[108:111], a[120:123], a[172:175], v[108:111]
    s_cmp_eq_u32 s14, 102400
    s_cselect_b32 s14, 45056, s14
    v_cvt_pk_bf16_f32 v43, v43, v43
    v_mfma_f32_16x16x32_bf16 v[124:127], a[124:127], a[172:175], v[124:127]
    s_sub_u32 s15, s14, s13
    s_waitcnt vmcnt(17)
    ds_read_b128 a[136:139], v18 offset:4096
    v_mfma_f32_16x16x32_bf16 v[120:123], a[124:127], a[168:171], v[120:123]
    s_waitcnt lgkmcnt(5)
    buffer_load_dwordx4 v62, s[44:47], s58 offen offset:2048 lds
    v_mfma_f32_16x16x32_bf16 v[140:143], a[176:179], a[124:127], v[140:143]
    s_mov_b32 s13, s14
    ds_read_b64_tr_b16 a[168:169], v16 offset:64
    v_lshlrev_b32 v43, 16, v43
    v_mfma_f32_16x16x32_bf16 v[204:207], a[180:183], a[124:127], v[204:207]
    ds_read_b64_tr_b16 a[170:171], v16 offset:1856
    v_add_f32 v43, 0x3727c5ac, v43
    v_mfma_f32_16x16x32_bf16 v[200:203], a[180:183], a[120:123], v[200:203]
    ds_read_b128 a[152:155], v19 offset:4096
    v_cvt_pk_bf16_f32 v43, v43, v43
    v_mfma_f32_16x16x32_bf16 v[136:139], a[176:179], a[120:123], v[136:139]
    ds_read_b64_tr_b16 a[172:173], v16 offset:7232
    v_lshlrev_b32 v43, 16, v43
    v_mfma_f32_16x16x32_bf16 v[132:135], a[176:179], a[116:119], v[132:135]
    ds_read_b64_tr_b16 a[174:175], v16 offset:9024
    v_mfma_f32_16x16x32_bf16 v[196:199], a[180:183], a[116:119], v[196:199]
    ds_read_b128 a[140:143], v18 offset:6144
    v_mfma_f32_16x16x32_bf16 v[192:195], a[180:183], a[112:115], v[192:195]
    buffer_load_dwordx4 v63, s[44:47], s58 offen offset:3072 lds
    v_mfma_f32_16x16x32_bf16 v[128:131], a[176:179], a[112:115], v[128:131]
    s_waitcnt lgkmcnt(7)
    ds_read_b128 a[156:159], v19 offset:6144
    v_mfma_f32_16x16x32_bf16 v[144:147], a[160:163], a[112:115], v[144:147]
    s_add_u32 s58, s58, 128
    ds_read_b64_tr_b16 a[176:177], v16 offset:96
    v_mfma_f32_16x16x32_bf16 v[208:211], a[164:167], a[112:115], v[208:211]
    ds_read_b64_tr_b16 a[178:179], v16 offset:1888
    v_mfma_f32_16x16x32_bf16 v[212:215], a[164:167], a[116:119], v[212:215]
    v_sqrt_f32 v43, v43
    v_mfma_f32_16x16x32_bf16 v[148:151], a[160:163], a[116:119], v[148:151]
    ds_read_b64_tr_b16 a[180:181], v16 offset:7264
    v_cvt_pk_bf16_f32 v42, v42, v42
    v_mfma_f32_16x16x32_bf16 v[152:155], a[160:163], a[120:123], v[152:155]
    ds_read_b64_tr_b16 a[182:183], v16 offset:9056
    v_lshlrev_b32 v42, 16, v42
    v_mfma_f32_16x16x32_bf16 v[216:219], a[164:167], a[120:123], v[216:219]
    v_cvt_pk_bf16_f32 v43, v43, v43
    v_lshlrev_b32 v43, 16, v43
    v_mfma_f32_16x16x32_bf16 v[220:223], a[164:167], a[124:127], v[220:223]
    s_waitcnt vmcnt(18)
    v_lshlrev_b32 v38, 16, v32
    v_and_b32 v32, 0xffff0000, v32
    v_mfma_f32_16x16x32_bf16 v[156:159], a[160:163], a[124:127], v[156:159]
    s_waitcnt lgkmcnt(6)
    v_add_f32 v20, v20, v38
    v_add_f32 v21, v21, v32
    v_mfma_f32_16x16x32_bf16 v[172:175], a[168:171], a[124:127], v[172:175]
    ds_read_b64_tr_b16 a[160:161], v16 offset:128
    v_lshlrev_b32 v38, 16, v33
    v_mfma_f32_16x16x32_bf16 v[236:239], a[172:175], a[124:127], v[236:239]
    s_add_u32 m0, s78, 4096
    ds_read_b64_tr_b16 a[162:163], v16 offset:1920
    v_and_b32 v33, 0xffff0000, v33
    v_mfma_f32_16x16x32_bf16 v[232:235], a[172:175], a[120:123], v[232:235]
    s_waitcnt lgkmcnt(6)
    buffer_load_dwordx4 v62, s[44:47], s59 offen offset:0 lds
    v_mfma_f32_16x16x32_bf16 v[168:171], a[168:171], a[120:123], v[168:171]
    ds_read_b64_tr_b16 a[164:165], v16 offset:7296
    v_add_f32 v22, v22, v38
    v_mfma_f32_16x16x32_bf16 v[164:167], a[168:171], a[116:119], v[164:167]
    ds_read_b64_tr_b16 a[166:167], v16 offset:9088
    v_add_f32 v23, v23, v33
    v_mfma_f32_16x16x32_bf16 v[228:231], a[172:175], a[116:119], v[228:231]
    v_lshlrev_b32 v38, 16, v34
    v_and_b32 v34, 0xffff0000, v34
    v_mfma_f32_16x16x32_bf16 v[224:227], a[172:175], a[112:115], v[224:227]
    buffer_load_dwordx4 v63, s[44:47], s59 offen offset:1024 lds
    v_mfma_f32_16x16x32_bf16 v[160:163], a[168:171], a[112:115], v[160:163]
    s_waitcnt lgkmcnt(4)
    v_add_f32 v24, v24, v38
    v_add_f32 v25, v25, v34
    v_mfma_f32_16x16x32_bf16 v[176:179], a[176:179], a[112:115], v[176:179]
    ds_read_b64_tr_b16 a[168:169], v16 offset:160
    v_lshlrev_b32 v38, 16, v35
    v_mfma_f32_16x16x32_bf16 v[240:243], a[180:183], a[112:115], v[240:243]
    ds_read_b64_tr_b16 a[170:171], v16 offset:1952
    v_and_b32 v35, 0xffff0000, v35
    v_mfma_f32_16x16x32_bf16 v[244:247], a[180:183], a[116:119], v[244:247]
    buffer_load_dwordx4 v62, s[44:47], s59 offen offset:2048 lds
    v_mfma_f32_16x16x32_bf16 v[180:183], a[176:179], a[116:119], v[180:183]
    ds_read_b64_tr_b16 a[172:173], v16 offset:7328
    v_add_f32 v26, v26, v38
    v_mfma_f32_16x16x32_bf16 v[184:187], a[176:179], a[120:123], v[184:187]
    ds_read_b64_tr_b16 a[174:175], v16 offset:9120
    v_add_f32 v27, v27, v35
    v_mfma_f32_16x16x32_bf16 v[248:251], a[180:183], a[120:123], v[248:251]
    v_rcp_f32 v43, v43
    v_mfma_f32_16x16x32_bf16 v[252:255], a[180:183], a[124:127], v[252:255]
    buffer_load_dwordx4 v63, s[44:47], s59 offen offset:3072 lds
    v_mfma_f32_16x16x32_bf16 v[188:191], a[176:179], a[124:127], v[188:191]
    s_waitcnt lgkmcnt(4)
    buffer_store_dword v28, v29, s[36:39], s82 offen sc1
    v_mfma_f32_16x16x32_bf16 a[12:15], a[160:163], a[124:127], a[12:15]
    s_add_u32 s59, s59, 128
    ds_read_b64_tr_b16 a[176:177], v17 offset:0
    v_mfma_f32_16x16x32_bf16 a[60:63], a[164:167], a[124:127], a[60:63]
    ds_read_b64_tr_b16 a[178:179], v17 offset:1792
    v_mfma_f32_16x16x32_bf16 a[56:59], a[164:167], a[120:123], a[56:59]
    buffer_store_dwordx2 v[42:43], v31, s[36:39], s83 offen sc1
    v_mfma_f32_16x16x32_bf16 a[8:11], a[160:163], a[120:123], a[8:11]
    ds_read_b64_tr_b16 a[180:181], v17 offset:7168
    v_mfma_f32_16x16x32_bf16 a[4:7], a[160:163], a[116:119], a[4:7]
    ds_read_b64_tr_b16 a[182:183], v17 offset:8960
    v_mfma_f32_16x16x32_bf16 a[52:55], a[164:167], a[116:119], a[52:55]
    v_mfma_f32_16x16x32_bf16 a[48:51], a[164:167], a[112:115], a[48:51]
    buffer_load_dwordx4 v[32:35], v40, s[4:7], s84 offen
    v_mfma_f32_16x16x32_bf16 a[0:3], a[160:163], a[112:115], a[0:3]
    s_waitcnt vmcnt(11) lgkmcnt(4)
    s_barrier
    v_mfma_f32_16x16x32_bf16 a[16:19], a[168:171], a[112:115], a[16:19]
    s_add_u32 s84, s84, 458752
    ds_read_b128 a[160:163], v14 offset:14336
    v_add_u32 v16, s15, v16
    v_mfma_f32_16x16x32_bf16 a[64:67], a[172:175], a[112:115], a[64:67]
    v_add_u32 v17, s15, v17
    v_mfma_f32_16x16x32_bf16 a[68:71], a[172:175], a[116:119], a[68:71]
    buffer_load_dword v0, v2, s[28:31], s86 offen
    v_mfma_f32_16x16x32_bf16 a[20:23], a[168:171], a[116:119], a[20:23]
    s_add_u32 s86, s86, 524288
    ds_read_b128 a[164:167], v14 offset:18432
    v_mfma_f32_16x16x32_bf16 a[24:27], a[168:171], a[120:123], a[24:27]
    buffer_load_dword v0, v41, s[36:39], s79 offen sc1
    v_mfma_f32_16x16x32_bf16 a[72:75], a[172:175], a[120:123], a[72:75]
    v_mfma_f32_16x16x32_bf16 a[76:79], a[172:175], a[124:127], a[76:79]
    v_mfma_f32_16x16x32_bf16 a[28:31], a[168:171], a[124:127], a[28:31]
    s_waitcnt lgkmcnt(2)
    v_mfma_f32_16x16x32_bf16 a[44:47], a[176:179], a[124:127], a[44:47]
    ds_read_b128 a[168:171], v14 offset:16384
    v_mfma_f32_16x16x32_bf16 a[92:95], a[180:183], a[124:127], a[92:95]
    v_mfma_f32_16x16x32_bf16 a[88:91], a[180:183], a[120:123], a[88:91]
    v_mfma_f32_16x16x32_bf16 a[40:43], a[176:179], a[120:123], a[40:43]
    ds_read_b128 a[172:175], v14 offset:20480
    v_mfma_f32_16x16x32_bf16 a[36:39], a[176:179], a[116:119], a[36:39]
    v_mfma_f32_16x16x32_bf16 a[84:87], a[180:183], a[116:119], a[84:87]
    v_mfma_f32_16x16x32_bf16 a[80:83], a[180:183], a[112:115], a[80:83]
    v_mfma_f32_16x16x32_bf16 a[32:35], a[176:179], a[112:115], a[32:35]
    s_waitcnt lgkmcnt(2)
.p2align 5
LF_loop:
    v_mfma_f32_16x16x32_bf16 v[64:67], a[128:131], a[160:163], v[64:67]
    ds_read_b64_tr_b16 a[176:177], v12 offset:0
    v_mfma_f32_16x16x32_bf16 v[68:71], a[128:131], a[164:167], v[68:71]
    s_mov_b32 m0, s63
    ds_read_b64_tr_b16 a[178:179], v12 offset:1792
    v_mfma_f32_16x16x32_bf16 v[84:87], a[132:135], a[164:167], v[84:87]
    buffer_load_dwordx4 v3, s[4:7], s56 offen offset:0  lds
    v_mfma_f32_16x16x32_bf16 v[80:83], a[132:135], a[160:163], v[80:83]
    ds_read_b64_tr_b16 a[180:181], v12 offset:7168
    v_mfma_f32_16x16x32_bf16 v[96:99], a[136:139], a[160:163], v[96:99]
    ds_read_b64_tr_b16 a[182:183], v12 offset:8960
    v_mfma_f32_16x16x32_bf16 v[100:103], a[136:139], a[164:167], v[100:103]
    v_mfma_f32_16x16x32_bf16 v[116:119], a[140:143], a[164:167], v[116:119]
    v_mfma_f32_16x16x32_bf16 v[112:115], a[140:143], a[160:163], v[112:115]
    s_waitcnt lgkmcnt(4)
    v_mfma_f32_16x16x32_bf16 v[120:123], a[140:143], a[168:171], v[120:123]
    ds_read_b64_tr_b16 a[160:161], v12 offset:32
    v_mfma_f32_16x16x32_bf16 v[124:127], a[140:143], a[172:175], v[124:127]
    ds_read_b64_tr_b16 a[162:163], v12 offset:1824
    v_mfma_f32_16x16x32_bf16 v[108:111], a[136:139], a[172:175], v[108:111]
    buffer_load_dwordx4 v4, s[4:7], s56 offen offset:1024  lds
    v_mfma_f32_16x16x32_bf16 v[104:107], a[136:139], a[168:171], v[104:107]
    ds_read_b64_tr_b16 a[164:165], v12 offset:7200
    v_mfma_f32_16x16x32_bf16 v[88:91], a[132:135], a[168:171], v[88:91]
    ds_read_b64_tr_b16 a[166:167], v12 offset:8992
    v_mfma_f32_16x16x32_bf16 v[92:95], a[132:135], a[172:175], v[92:95]
    v_mfma_f32_16x16x32_bf16 v[76:79], a[128:131], a[172:175], v[76:79]
    v_mfma_f32_16x16x32_bf16 v[72:75], a[128:131], a[168:171], v[72:75]
    s_waitcnt lgkmcnt(4)
    v_mfma_f32_16x16x32_bf16 v[128:131], a[176:179], a[128:131], v[128:131]
    ds_read_b64_tr_b16 a[168:169], v12 offset:64
    v_mfma_f32_16x16x32_bf16 v[192:195], a[180:183], a[128:131], v[192:195]
    ds_read_b64_tr_b16 a[170:171], v12 offset:1856
    v_mfma_f32_16x16x32_bf16 v[196:199], a[180:183], a[132:135], v[196:199]
    buffer_load_dwordx4 v5, s[4:7], s56 offen offset:2048  lds
    v_mfma_f32_16x16x32_bf16 v[132:135], a[176:179], a[132:135], v[132:135]
    ds_read_b64_tr_b16 a[172:173], v12 offset:7232
    v_mfma_f32_16x16x32_bf16 v[136:139], a[176:179], a[136:139], v[136:139]
    ds_read_b64_tr_b16 a[174:175], v12 offset:9024
    v_mfma_f32_16x16x32_bf16 v[200:203], a[180:183], a[136:139], v[200:203]
    v_mfma_f32_16x16x32_bf16 v[204:207], a[180:183], a[140:143], v[204:207]
    v_mfma_f32_16x16x32_bf16 v[140:143], a[176:179], a[140:143], v[140:143]
    s_waitcnt lgkmcnt(4)
    v_mfma_f32_16x16x32_bf16 v[156:159], a[160:163], a[140:143], v[156:159]
    ds_read_b64_tr_b16 a[176:177], v12 offset:96
    v_mfma_f32_16x16x32_bf16 v[220:223], a[164:167], a[140:143], v[220:223]
    ds_read_b64_tr_b16 a[178:179], v12 offset:1888
    v_mfma_f32_16x16x32_bf16 v[216:219], a[164:167], a[136:139], v[216:219]
    buffer_load_dwordx4 v6, s[4:7], s56 offen offset:3072  lds
    v_mfma_f32_16x16x32_bf16 v[152:155], a[160:163], a[136:139], v[152:155]
    ds_read_b64_tr_b16 a[180:181], v12 offset:7264
    v_mfma_f32_16x16x32_bf16 v[148:151], a[160:163], a[132:135], v[148:151]
    ds_read_b64_tr_b16 a[182:183], v12 offset:9056
    v_mfma_f32_16x16x32_bf16 v[212:215], a[164:167], a[132:135], v[212:215]
    v_mfma_f32_16x16x32_bf16 v[208:211], a[164:167], a[128:131], v[208:211]
    v_mfma_f32_16x16x32_bf16 v[144:147], a[160:163], a[128:131], v[144:147]
    s_waitcnt lgkmcnt(4)
    v_mfma_f32_16x16x32_bf16 v[160:163], a[168:171], a[128:131], v[160:163]
    ds_read_b64_tr_b16 a[160:161], v12 offset:128
    v_mfma_f32_16x16x32_bf16 v[224:227], a[172:175], a[128:131], v[224:227]
    s_add_u32 m0, s63, 4096
    ds_read_b64_tr_b16 a[162:163], v12 offset:1920
    v_mfma_f32_16x16x32_bf16 v[228:231], a[172:175], a[132:135], v[228:231]
    buffer_load_dwordx4 v7, s[4:7], s56 offen offset:0  lds
    v_mfma_f32_16x16x32_bf16 v[164:167], a[168:171], a[132:135], v[164:167]
    ds_read_b64_tr_b16 a[164:165], v12 offset:7296
    v_mfma_f32_16x16x32_bf16 v[168:171], a[168:171], a[136:139], v[168:171]
    ds_read_b64_tr_b16 a[166:167], v12 offset:9088
    v_mfma_f32_16x16x32_bf16 v[232:235], a[172:175], a[136:139], v[232:235]
    v_mfma_f32_16x16x32_bf16 v[236:239], a[172:175], a[140:143], v[236:239]
    v_mfma_f32_16x16x32_bf16 v[172:175], a[168:171], a[140:143], v[172:175]
    s_waitcnt lgkmcnt(4)
    v_mfma_f32_16x16x32_bf16 v[188:191], a[176:179], a[140:143], v[188:191]
    ds_read_b64_tr_b16 a[168:169], v12 offset:160
    v_mfma_f32_16x16x32_bf16 v[252:255], a[180:183], a[140:143], v[252:255]
    ds_read_b64_tr_b16 a[170:171], v12 offset:1952
    v_mfma_f32_16x16x32_bf16 v[248:251], a[180:183], a[136:139], v[248:251]
    buffer_load_dwordx4 v8, s[4:7], s56 offen offset:1024  lds
    v_mfma_f32_16x16x32_bf16 v[184:187], a[176:179], a[136:139], v[184:187]
    ds_read_b64_tr_b16 a[172:173], v12 offset:7328
    v_mfma_f32_16x16x32_bf16 v[180:183], a[176:179], a[132:135], v[180:183]
    ds_read_b64_tr_b16 a[174:175], v12 offset:9120
    v_mfma_f32_16x16x32_bf16 v[244:247], a[180:183], a[132:135], v[244:247]
    v_mfma_f32_16x16x32_bf16 v[240:243], a[180:183], a[128:131], v[240:243]
    v_mfma_f32_16x16x32_bf16 v[176:179], a[176:179], a[128:131], v[176:179]
    s_waitcnt lgkmcnt(4)
    v_mfma_f32_16x16x32_bf16 a[0:3], a[160:163], a[128:131], a[0:3]
    ds_read_b64_tr_b16 a[176:177], v13 offset:0
    v_mfma_f32_16x16x32_bf16 a[48:51], a[164:167], a[128:131], a[48:51]
    ds_read_b64_tr_b16 a[178:179], v13 offset:1792
    v_mfma_f32_16x16x32_bf16 a[52:55], a[164:167], a[132:135], a[52:55]
    buffer_load_dwordx4 v9, s[4:7], s56 offen offset:2048  lds
    v_mfma_f32_16x16x32_bf16 a[4:7], a[160:163], a[132:135], a[4:7]
    ds_read_b64_tr_b16 a[180:181], v13 offset:7168
    v_mfma_f32_16x16x32_bf16 a[8:11], a[160:163], a[136:139], a[8:11]
    ds_read_b64_tr_b16 a[182:183], v13 offset:8960
    v_mfma_f32_16x16x32_bf16 a[56:59], a[164:167], a[136:139], a[56:59]
    v_mfma_f32_16x16x32_bf16 a[60:63], a[164:167], a[140:143], a[60:63]
    s_waitcnt vmcnt(14)
    ds_read_b128 a[96:99], v18 offset:0
    v_mfma_f32_16x16x32_bf16 a[12:15], a[160:163], a[140:143], a[12:15]
    s_waitcnt lgkmcnt(5)
    v_mfma_f32_16x16x32_bf16 a[28:31], a[168:171], a[140:143], a[28:31]
    s_mov_b32 m0, s64
    ds_read_b128 a[160:163], v15 offset:14336
    v_mfma_f32_16x16x32_bf16 a[76:79], a[172:175], a[140:143], a[76:79]
    buffer_load_dwordx4 v10, s[8:11], s57 offen offset:0  lds
    v_mfma_f32_16x16x32_bf16 a[72:75], a[172:175], a[136:139], a[72:75]
    ds_read_b128 a[112:115], v19 offset:0
    v_mfma_f32_16x16x32_bf16 a[24:27], a[168:171], a[136:139], a[24:27]
    ds_read_b128 a[164:167], v15 offset:18432
    v_mfma_f32_16x16x32_bf16 a[20:23], a[168:171], a[132:135], a[20:23]
    ds_read_b128 a[100:103], v18 offset:2048
    v_mfma_f32_16x16x32_bf16 a[68:71], a[172:175], a[132:135], a[68:71]
    v_mfma_f32_16x16x32_bf16 a[64:67], a[172:175], a[128:131], a[64:67]
    ds_read_b128 a[116:119], v19 offset:2048
    v_mfma_f32_16x16x32_bf16 a[16:19], a[168:171], a[128:131], a[16:19]
    s_waitcnt lgkmcnt(6)
    buffer_load_dwordx4 v11, s[8:11], s57 offen offset:1024  lds
    v_mfma_f32_16x16x32_bf16 a[32:35], a[176:179], a[128:131], a[32:35]
    s_add_u32 s56, s56, 458752
    ds_read_b128 a[168:171], v15 offset:16384
    v_mfma_f32_16x16x32_bf16 a[80:83], a[180:183], a[128:131], a[80:83]
    s_add_u32 s57, s57, 128
    v_mfma_f32_16x16x32_bf16 a[84:87], a[180:183], a[132:135], a[84:87]
    s_add_u32 s62, s62, 22528
    v_mfma_f32_16x16x32_bf16 a[36:39], a[176:179], a[132:135], a[36:39]
    s_cmp_eq_u32 s62, 45056
    s_cselect_b32 s62, 102400, s62
    ds_read_b128 a[172:175], v15 offset:20480
    v_mfma_f32_16x16x32_bf16 a[40:43], a[176:179], a[136:139], a[40:43]
    s_cmp_eq_u32 s62, 124928
    s_cselect_b32 s62, 0, s62
    v_mfma_f32_16x16x32_bf16 a[88:91], a[180:183], a[136:139], a[88:91]
    s_add_u32 s12, s12, 14336
    v_mfma_f32_16x16x32_bf16 a[92:95], a[180:183], a[140:143], a[92:95]
    s_cmp_eq_u32 s12, 102400
    s_cselect_b32 s12, 45056, s12
    v_mfma_f32_16x16x32_bf16 a[44:47], a[176:179], a[140:143], a[44:47]
    s_waitcnt lgkmcnt(4)
    v_mfma_f32_16x16x32_bf16 v[112:115], a[156:159], a[160:163], v[112:115]
    s_bitcmp1_b32 s48, 0
    s_cselect_b32 s63, s12, s62
    ds_read_b64_tr_b16 a[176:177], v16 offset:0
    v_mfma_f32_16x16x32_bf16 v[116:119], a[156:159], a[164:167], v[116:119]
    s_add_u32 s63, s63, s60
    s_mov_b32 m0, s78
    ds_read_b64_tr_b16 a[178:179], v16 offset:1792
    v_mfma_f32_16x16x32_bf16 v[100:103], a[152:155], a[164:167], v[100:103]
    s_add_u32 s64, s61, s62
    s_waitcnt lgkmcnt(4)
    buffer_load_dwordx4 v62, s[44:47], s58 offen offset:0 lds
    v_mfma_f32_16x16x32_bf16 v[96:99], a[152:155], a[160:163], v[96:99]
    ds_read_b64_tr_b16 a[180:181], v16 offset:7168
    v_mfma_f32_16x16x32_bf16 v[80:83], a[148:151], a[160:163], v[80:83]
    s_add_u32 s14, s65, 22528
    ds_read_b64_tr_b16 a[182:183], v16 offset:8960
    v_mfma_f32_16x16x32_bf16 v[84:87], a[148:151], a[164:167], v[84:87]
    s_cmp_eq_u32 s14, 45056
    s_cselect_b32 s14, 102400, s14
    v_mfma_f32_16x16x32_bf16 v[68:71], a[144:147], a[164:167], v[68:71]
    s_cmp_eq_u32 s14, 124928
    s_cselect_b32 s14, 0, s14
    v_mfma_f32_16x16x32_bf16 v[64:67], a[144:147], a[160:163], v[64:67]
    s_waitcnt lgkmcnt(4)
    buffer_load_dwordx4 v63, s[44:47], s58 offen offset:1024 lds
    v_mfma_f32_16x16x32_bf16 v[72:75], a[144:147], a[168:171], v[72:75]
    s_sub_u32 s65, s14, s65
    ds_read_b64_tr_b16 a[160:161], v16 offset:32
    v_add_u32 v12, s65, v12
    v_mfma_f32_16x16x32_bf16 v[76:79], a[144:147], a[172:175], v[76:79]
    ds_read_b64_tr_b16 a[162:163], v16 offset:1824
    v_add_u32 v13, s65, v13
    v_mfma_f32_16x16x32_bf16 v[92:95], a[148:151], a[172:175], v[92:95]
    v_add_u32 v14, s65, v14
    v_add_u32 v15, s65, v15
    v_mfma_f32_16x16x32_bf16 v[88:91], a[148:151], a[168:171], v[88:91]
    s_mov_b32 s65, s14
    ds_read_b64_tr_b16 a[164:165], v16 offset:7200
    v_mfma_f32_16x16x32_bf16 v[104:107], a[152:155], a[168:171], v[104:107]
    s_add_u32 s14, s13, 14336
    ds_read_b64_tr_b16 a[166:167], v16 offset:8992
    v_mfma_f32_16x16x32_bf16 v[108:111], a[152:155], a[172:175], v[108:111]
    s_cmp_eq_u32 s14, 102400
    s_cselect_b32 s14, 45056, s14
    v_mfma_f32_16x16x32_bf16 v[124:127], a[156:159], a[172:175], v[124:127]
    s_sub_u32 s15, s14, s13
    s_waitcnt vmcnt(14)
    ds_read_b128 a[104:107], v18 offset:4096
    v_mfma_f32_16x16x32_bf16 v[120:123], a[156:159], a[168:171], v[120:123]
    s_waitcnt lgkmcnt(5)
    buffer_load_dwordx4 v62, s[44:47], s58 offen offset:2048 lds
    v_mfma_f32_16x16x32_bf16 v[140:143], a[176:179], a[156:159], v[140:143]
    s_mov_b32 s13, s14
    ds_read_b64_tr_b16 a[168:169], v16 offset:64
    v_mfma_f32_16x16x32_bf16 v[204:207], a[180:183], a[156:159], v[204:207]
    ds_read_b64_tr_b16 a[170:171], v16 offset:1856
    v_mfma_f32_16x16x32_bf16 v[200:203], a[180:183], a[152:155], v[200:203]
    ds_read_b128 a[120:123], v19 offset:4096
    v_mfma_f32_16x16x32_bf16 v[136:139], a[176:179], a[152:155], v[136:139]
    ds_read_b64_tr_b16 a[172:173], v16 offset:7232
    v_mfma_f32_16x16x32_bf16 v[132:135], a[176:179], a[148:151], v[132:135]
    ds_read_b64_tr_b16 a[174:175], v16 offset:9024
    v_mfma_f32_16x16x32_bf16 v[196:199], a[180:183], a[148:151], v[196:199]
    ds_read_b128 a[108:111], v18 offset:6144
    v_mfma_f32_16x16x32_bf16 v[192:195], a[180:183], a[144:147], v[192:195]
    buffer_load_dwordx4 v63, s[44:47], s58 offen offset:3072 lds
    v_mfma_f32_16x16x32_bf16 v[128:131], a[176:179], a[144:147], v[128:131]
    s_waitcnt lgkmcnt(7)
    ds_read_b128 a[124:127], v19 offset:6144
    v_mfma_f32_16x16x32_bf16 v[144:147], a[160:163], a[144:147], v[144:147]
    s_add_u32 s58, s58, 128
    ds_read_b64_tr_b16 a[176:177], v16 offset:96
    v_mfma_f32_16x16x32_bf16 v[208:211], a[164:167], a[144:147], v[208:211]
    ds_read_b64_tr_b16 a[178:179], v16 offset:1888
    v_mfma_f32_16x16x32_bf16 v[212:215], a[164:167], a[148:151], v[212:215]
    v_mfma_f32_16x16x32_bf16 v[148:151], a[160:163], a[148:151], v[148:151]
    ds_read_b64_tr_b16 a[180:181], v16 offset:7264
    v_mfma_f32_16x16x32_bf16 v[152:155], a[160:163], a[152:155], v[152:155]
    ds_read_b64_tr_b16 a[182:183], v16 offset:9056
    v_mfma_f32_16x16x32_bf16 v[216:219], a[164:167], a[152:155], v[216:219]
    v_mfma_f32_16x16x32_bf16 v[220:223], a[164:167], a[156:159], v[220:223]
    s_waitcnt vmcnt(15)
    v_lshlrev_b32 v38, 16, v32
    v_and_b32 v32, 0xffff0000, v32
    v_mfma_f32_16x16x32_bf16 v[156:159], a[160:163], a[156:159], v[156:159]
    s_waitcnt lgkmcnt(6)
    v_add_f32 v20, v20, v38
    v_add_f32 v21, v21, v32
    v_mfma_f32_16x16x32_bf16 v[172:175], a[168:171], a[156:159], v[172:175]
    ds_read_b64_tr_b16 a[160:161], v16 offset:128
    v_lshlrev_b32 v38, 16, v33
    v_mfma_f32_16x16x32_bf16 v[236:239], a[172:175], a[156:159], v[236:239]
    s_add_u32 m0, s78, 4096
    ds_read_b64_tr_b16 a[162:163], v16 offset:1920
    v_and_b32 v33, 0xffff0000, v33
    v_mfma_f32_16x16x32_bf16 v[232:235], a[172:175], a[152:155], v[232:235]
    s_waitcnt lgkmcnt(6)
    buffer_load_dwordx4 v62, s[44:47], s59 offen offset:0 lds
    v_mfma_f32_16x16x32_bf16 v[168:171], a[168:171], a[152:155], v[168:171]
    ds_read_b64_tr_b16 a[164:165], v16 offset:7296
    v_add_f32 v22, v22, v38
    v_mfma_f32_16x16x32_bf16 v[164:167], a[168:171], a[148:151], v[164:167]
    ds_read_b64_tr_b16 a[166:167], v16 offset:9088
    v_add_f32 v23, v23, v33
    v_mfma_f32_16x16x32_bf16 v[228:231], a[172:175], a[148:151], v[228:231]
    v_lshlrev_b32 v38, 16, v34
    v_and_b32 v34, 0xffff0000, v34
    v_mfma_f32_16x16x32_bf16 v[224:227], a[172:175], a[144:147], v[224:227]
    buffer_load_dwordx4 v63, s[44:47], s59 offen offset:1024 lds
    v_mfma_f32_16x16x32_bf16 v[160:163], a[168:171], a[144:147], v[160:163]
    s_waitcnt lgkmcnt(4)
    v_add_f32 v24, v24, v38
    v_add_f32 v25, v25, v34
    v_mfma_f32_16x16x32_bf16 v[176:179], a[176:179], a[144:147], v[176:179]
    ds_read_b64_tr_b16 a[168:169], v16 offset:160
    v_lshlrev_b32 v38, 16, v35
    v_mfma_f32_16x16x32_bf16 v[240:243], a[180:183], a[144:147], v[240:243]
    ds_read_b64_tr_b16 a[170:171], v16 offset:1952
    v_and_b32 v35, 0xffff0000, v35
    v_mfma_f32_16x16x32_bf16 v[244:247], a[180:183], a[148:151], v[244:247]
    buffer_load_dwordx4 v62, s[44:47], s59 offen offset:2048 lds
    v_mfma_f32_16x16x32_bf16 v[180:183], a[176:179], a[148:151], v[180:183]
    ds_read_b64_tr_b16 a[172:173], v16 offset:7328
    v_add_f32 v26, v26, v38
    v_mfma_f32_16x16x32_bf16 v[184:187], a[176:179], a[152:155], v[184:187]
    ds_read_b64_tr_b16 a[174:175], v16 offset:9120
    v_add_f32 v27, v27, v35
    v_mfma_f32_16x16x32_bf16 v[248:251], a[180:183], a[152:155], v[248:251]
    v_mfma_f32_16x16x32_bf16 v[252:255], a[180:183], a[156:159], v[252:255]
    buffer_load_dwordx4 v63, s[44:47], s59 offen offset:3072 lds
    v_mfma_f32_16x16x32_bf16 v[188:191], a[176:179], a[156:159], v[188:191]
    s_waitcnt lgkmcnt(4)
    v_mfma_f32_16x16x32_bf16 a[12:15], a[160:163], a[156:159], a[12:15]
    s_add_u32 s59, s59, 128
    ds_read_b64_tr_b16 a[176:177], v17 offset:0
    v_mfma_f32_16x16x32_bf16 a[60:63], a[164:167], a[156:159], a[60:63]
    ds_read_b64_tr_b16 a[178:179], v17 offset:1792
    v_mfma_f32_16x16x32_bf16 a[56:59], a[164:167], a[152:155], a[56:59]
    v_mfma_f32_16x16x32_bf16 a[8:11], a[160:163], a[152:155], a[8:11]
    ds_read_b64_tr_b16 a[180:181], v17 offset:7168
    v_mfma_f32_16x16x32_bf16 a[4:7], a[160:163], a[148:151], a[4:7]
    ds_read_b64_tr_b16 a[182:183], v17 offset:8960
    v_mfma_f32_16x16x32_bf16 a[52:55], a[164:167], a[148:151], a[52:55]
    v_mfma_f32_16x16x32_bf16 a[48:51], a[164:167], a[144:147], a[48:51]
    buffer_load_dwordx4 v[32:35], v40, s[4:7], s84 offen
    v_mfma_f32_16x16x32_bf16 a[0:3], a[160:163], a[144:147], a[0:3]
    s_waitcnt vmcnt(9) lgkmcnt(4)
    s_barrier
    v_mfma_f32_16x16x32_bf16 a[16:19], a[168:171], a[144:147], a[16:19]
    s_add_u32 s84, s84, 458752
    ds_read_b128 a[160:163], v14 offset:14336
    v_add_u32 v16, s15, v16
    v_mfma_f32_16x16x32_bf16 a[64:67], a[172:175], a[144:147], a[64:67]
    v_add_u32 v17, s15, v17
    v_mfma_f32_16x16x32_bf16 a[68:71], a[172:175], a[148:151], a[68:71]
    buffer_load_dword v0, v2, s[24:27], s85 offen
    v_mfma_f32_16x16x32_bf16 a[20:23], a[168:171], a[148:151], a[20:23]
    s_add_u32 s85, s85, 1048576
    ds_read_b128 a[164:167], v14 offset:18432
    v_mfma_f32_16x16x32_bf16 a[24:27], a[168:171], a[152:155], a[24:27]
    v_mfma_f32_16x16x32_bf16 a[72:75], a[172:175], a[152:155], a[72:75]
    v_mfma_f32_16x16x32_bf16 a[76:79], a[172:175], a[156:159], a[76:79]
    v_mfma_f32_16x16x32_bf16 a[28:31], a[168:171], a[156:159], a[28:31]
    s_waitcnt lgkmcnt(2)
    v_mfma_f32_16x16x32_bf16 a[44:47], a[176:179], a[156:159], a[44:47]
    ds_read_b128 a[168:171], v14 offset:16384
    v_mfma_f32_16x16x32_bf16 a[92:95], a[180:183], a[156:159], a[92:95]
    v_mfma_f32_16x16x32_bf16 a[88:91], a[180:183], a[152:155], a[88:91]
    v_mfma_f32_16x16x32_bf16 a[40:43], a[176:179], a[152:155], a[40:43]
    ds_read_b128 a[172:175], v14 offset:20480
    v_mfma_f32_16x16x32_bf16 a[36:39], a[176:179], a[148:151], a[36:39]
    v_mfma_f32_16x16x32_bf16 a[84:87], a[180:183], a[148:151], a[84:87]
    v_mfma_f32_16x16x32_bf16 a[80:83], a[180:183], a[144:147], a[80:83]
    v_mfma_f32_16x16x32_bf16 a[32:35], a[176:179], a[144:147], a[32:35]
    s_waitcnt lgkmcnt(2)
    v_mfma_f32_16x16x32_bf16 v[64:67], a[96:99], a[160:163], v[64:67]
    ds_read_b64_tr_b16 a[176:177], v12 offset:0
    v_mfma_f32_16x16x32_bf16 v[68:71], a[96:99], a[164:167], v[68:71]
    s_mov_b32 m0, s63
    ds_read_b64_tr_b16 a[178:179], v12 offset:1792
    v_mfma_f32_16x16x32_bf16 v[84:87], a[100:103], a[164:167], v[84:87]
    buffer_load_dwordx4 v3, s[4:7], s56 offen offset:0  lds
    v_mfma_f32_16x16x32_bf16 v[80:83], a[100:103], a[160:163], v[80:83]
    ds_read_b64_tr_b16 a[180:181], v12 offset:7168
    v_mfma_f32_16x16x32_bf16 v[96:99], a[104:107], a[160:163], v[96:99]
    s_add_u32 s66, s66, 1
    ds_read_b64_tr_b16 a[182:183], v12 offset:8960
    v_mfma_f32_16x16x32_bf16 v[100:103], a[104:107], a[164:167], v[100:103]
    v_mfma_f32_16x16x32_bf16 v[116:119], a[108:111], a[164:167], v[116:119]
    v_mfma_f32_16x16x32_bf16 v[112:115], a[108:111], a[160:163], v[112:115]
    s_waitcnt lgkmcnt(4)
    v_mfma_f32_16x16x32_bf16 v[120:123], a[108:111], a[168:171], v[120:123]
    ds_read_b64_tr_b16 a[160:161], v12 offset:32
    v_mfma_f32_16x16x32_bf16 v[124:127], a[108:111], a[172:175], v[124:127]
    ds_read_b64_tr_b16 a[162:163], v12 offset:1824
    v_mfma_f32_16x16x32_bf16 v[108:111], a[104:107], a[172:175], v[108:111]
    buffer_load_dwordx4 v4, s[4:7], s56 offen offset:1024  lds
    v_mfma_f32_16x16x32_bf16 v[104:107], a[104:107], a[168:171], v[104:107]
    ds_read_b64_tr_b16 a[164:165], v12 offset:7200
    v_mfma_f32_16x16x32_bf16 v[88:91], a[100:103], a[168:171], v[88:91]
    ds_read_b64_tr_b16 a[166:167], v12 offset:8992
    v_mfma_f32_16x16x32_bf16 v[92:95], a[100:103], a[172:175], v[92:95]
    v_mfma_f32_16x16x32_bf16 v[76:79], a[96:99], a[172:175], v[76:79]
    v_mfma_f32_16x16x32_bf16 v[72:75], a[96:99], a[168:171], v[72:75]
    s_waitcnt lgkmcnt(4)
    v_mfma_f32_16x16x32_bf16 v[128:131], a[176:179], a[96:99], v[128:131]
    ds_read_b64_tr_b16 a[168:169], v12 offset:64
    v_mfma_f32_16x16x32_bf16 v[192:195], a[180:183], a[96:99], v[192:195]
    ds_read_b64_tr_b16 a[170:171], v12 offset:1856
    v_mfma_f32_16x16x32_bf16 v[196:199], a[180:183], a[100:103], v[196:199]
    buffer_load_dwordx4 v5, s[4:7], s56 offen offset:2048  lds
    v_mfma_f32_16x16x32_bf16 v[132:135], a[176:179], a[100:103], v[132:135]
    ds_read_b64_tr_b16 a[172:173], v12 offset:7232
    v_mfma_f32_16x16x32_bf16 v[136:139], a[176:179], a[104:107], v[136:139]
    ds_read_b64_tr_b16 a[174:175], v12 offset:9024
    v_mfma_f32_16x16x32_bf16 v[200:203], a[180:183], a[104:107], v[200:203]
    v_mfma_f32_16x16x32_bf16 v[204:207], a[180:183], a[108:111], v[204:207]
    v_mfma_f32_16x16x32_bf16 v[140:143], a[176:179], a[108:111], v[140:143]
    s_waitcnt lgkmcnt(4)
    v_mfma_f32_16x16x32_bf16 v[156:159], a[160:163], a[108:111], v[156:159]
    ds_read_b64_tr_b16 a[176:177], v12 offset:96
    v_mfma_f32_16x16x32_bf16 v[220:223], a[164:167], a[108:111], v[220:223]
    ds_read_b64_tr_b16 a[178:179], v12 offset:1888
    v_mfma_f32_16x16x32_bf16 v[216:219], a[164:167], a[104:107], v[216:219]
    buffer_load_dwordx4 v6, s[4:7], s56 offen offset:3072  lds
    v_mfma_f32_16x16x32_bf16 v[152:155], a[160:163], a[104:107], v[152:155]
    ds_read_b64_tr_b16 a[180:181], v12 offset:7264
    v_mfma_f32_16x16x32_bf16 v[148:151], a[160:163], a[100:103], v[148:151]
    ds_read_b64_tr_b16 a[182:183], v12 offset:9056
    v_mfma_f32_16x16x32_bf16 v[212:215], a[164:167], a[100:103], v[212:215]
    v_mfma_f32_16x16x32_bf16 v[208:211], a[164:167], a[96:99], v[208:211]
    v_mfma_f32_16x16x32_bf16 v[144:147], a[160:163], a[96:99], v[144:147]
    s_waitcnt lgkmcnt(4)
    v_mfma_f32_16x16x32_bf16 v[160:163], a[168:171], a[96:99], v[160:163]
    ds_read_b64_tr_b16 a[160:161], v12 offset:128
    v_mfma_f32_16x16x32_bf16 v[224:227], a[172:175], a[96:99], v[224:227]
    s_add_u32 m0, s63, 4096
    ds_read_b64_tr_b16 a[162:163], v12 offset:1920
    v_mfma_f32_16x16x32_bf16 v[228:231], a[172:175], a[100:103], v[228:231]
LF_pad3:
    s_cbranch_execz LF_pad7
    buffer_load_dwordx4 v7, s[4:7], s56 offen offset:0  lds
    v_mfma_f32_16x16x32_bf16 v[164:167], a[168:171], a[100:103], v[164:167]
    ds_read_b64_tr_b16 a[164:165], v12 offset:7296
    v_mfma_f32_16x16x32_bf16 v[168:171], a[168:171], a[104:107], v[168:171]
    ds_read_b64_tr_b16 a[166:167], v12 offset:9088
    v_mfma_f32_16x16x32_bf16 v[232:235], a[172:175], a[104:107], v[232:235]
    v_mfma_f32_16x16x32_bf16 v[236:239], a[172:175], a[108:111], v[236:239]
    v_mfma_f32_16x16x32_bf16 v[172:175], a[168:171], a[108:111], v[172:175]
    s_waitcnt lgkmcnt(4)
    v_mfma_f32_16x16x32_bf16 v[188:191], a[176:179], a[108:111], v[188:191]
    ds_read_b64_tr_b16 a[168:169], v12 offset:160
    v_mfma_f32_16x16x32_bf16 v[252:255], a[180:183], a[108:111], v[252:255]
    ds_read_b64_tr_b16 a[170:171], v12 offset:1952
    v_mfma_f32_16x16x32_bf16 v[248:251], a[180:183], a[104:107], v[248:251]
    buffer_load_dwordx4 v8, s[4:7], s56 offen offset:1024  lds
    v_mfma_f32_16x16x32_bf16 v[184:187], a[176:179], a[104:107], v[184:187]
    ds_read_b64_tr_b16 a[172:173], v12 offset:7328
    v_mfma_f32_16x16x32_bf16 v[180:183], a[176:179], a[100:103], v[180:183]
    ds_read_b64_tr_b16 a[174:175], v12 offset:9120
    v_mfma_f32_16x16x32_bf16 v[244:247], a[180:183], a[100:103], v[244:247]
    v_mfma_f32_16x16x32_bf16 v[240:243], a[180:183], a[96:99], v[240:243]
    v_mfma_f32_16x16x32_bf16 v[176:179], a[176:179], a[96:99], v[176:179]
    s_waitcnt lgkmcnt(4)
    v_mfma_f32_16x16x32_bf16 a[0:3], a[160:163], a[96:99], a[0:3]
    ds_read_b64_tr_b16 a[176:177], v13 offset:0
    v_mfma_f32_16x16x32_bf16 a[48:51], a[164:167], a[96:99], a[48:51]
    ds_read_b64_tr_b16 a[178:179], v13 offset:1792
    v_mfma_f32_16x16x32_bf16 a[52:55], a[164:167], a[100:103], a[52:55]
    buffer_load_dwordx4 v9, s[4:7], s56 offen offset:2048  lds
    v_mfma_f32_16x16x32_bf16 a[4:7], a[160:163], a[100:103], a[4:7]
    ds_read_b64_tr_b16 a[180:181], v13 offset:7168
    v_mfma_f32_16x16x32_bf16 a[8:11], a[160:163], a[104:107], a[8:11]
    ds_read_b64_tr_b16 a[182:183], v13 offset:8960
    v_mfma_f32_16x16x32_bf16 a[56:59], a[164:167], a[104:107], a[56:59]
    v_mfma_f32_16x16x32_bf16 a[60:63], a[164:167], a[108:111], a[60:63]
    s_waitcnt vmcnt(13)
    ds_read_b128 a[128:131], v18 offset:0
    v_mfma_f32_16x16x32_bf16 a[12:15], a[160:163], a[108:111], a[12:15]
    s_waitcnt lgkmcnt(5)
    v_mfma_f32_16x16x32_bf16 a[28:31], a[168:171], a[108:111], a[28:31]
    s_mov_b32 m0, s64
    ds_read_b128 a[160:163], v15 offset:14336
    v_mfma_f32_16x16x32_bf16 a[76:79], a[172:175], a[108:111], a[76:79]
    buffer_load_dwordx4 v10, s[8:11], s57 offen offset:0  lds
    v_mfma_f32_16x16x32_bf16 a[72:75], a[172:175], a[104:107], a[72:75]
    ds_read_b128 a[144:147], v19 offset:0
    v_mfma_f32_16x16x32_bf16 a[24:27], a[168:171], a[104:107], a[24:27]
    ds_read_b128 a[164:167], v15 offset:18432
    v_mfma_f32_16x16x32_bf16 a[20:23], a[168:171], a[100:103], a[20:23]
    ds_read_b128 a[132:135], v18 offset:2048
    v_mfma_f32_16x16x32_bf16 a[68:71], a[172:175], a[100:103], a[68:71]
    v_mfma_f32_16x16x32_bf16 a[64:67], a[172:175], a[96:99], a[64:67]
    ds_read_b128 a[148:151], v19 offset:2048
    v_mfma_f32_16x16x32_bf16 a[16:19], a[168:171], a[96:99], a[16:19]
    s_waitcnt lgkmcnt(6)
    buffer_load_dwordx4 v11, s[8:11], s57 offen offset:1024  lds
    v_mfma_f32_16x16x32_bf16 a[32:35], a[176:179], a[96:99], a[32:35]
    s_add_u32 s56, s56, 458752
    ds_read_b128 a[168:171], v15 offset:16384
    v_mfma_f32_16x16x32_bf16 a[80:83], a[180:183], a[96:99], a[80:83]
    s_add_u32 s57, s57, 128
    v_mfma_f32_16x16x32_bf16 a[84:87], a[180:183], a[100:103], a[84:87]
    s_add_u32 s62, s62, 22528
    v_mfma_f32_16x16x32_bf16 a[36:39], a[176:179], a[100:103], a[36:39]
    s_cmp_eq_u32 s62, 45056
    s_cselect_b32 s62, 102400, s62
    ds_read_b128 a[172:175], v15 offset:20480
    v_mfma_f32_16x16x32_bf16 a[40:43], a[176:179], a[104:107], a[40:43]
    s_cmp_eq_u32 s62, 124928
    s_cselect_b32 s62, 0, s62
    v_mfma_f32_16x16x32_bf16 a[88:91], a[180:183], a[104:107], a[88:91]
    s_add_u32 s12, s12, 14336
    v_mfma_f32_16x16x32_bf16 a[92:95], a[180:183], a[108:111], a[92:95]
    s_cmp_eq_u32 s12, 102400
    s_cselect_b32 s12, 45056, s12
    v_mfma_f32_16x16x32_bf16 a[44:47], a[176:179], a[108:111], a[44:47]
    s_waitcnt lgkmcnt(4)
    v_mfma_f32_16x16x32_bf16 v[112:115], a[124:127], a[160:163], v[112:115]
    s_bitcmp1_b32 s48, 0
    s_cselect_b32 s63, s12, s62
    ds_read_b64_tr_b16 a[176:177], v16 offset:0
    v_mfma_f32_16x16x32_bf16 v[116:119], a[124:127], a[164:167], v[116:119]
    s_add_u32 s63, s63, s60
    s_mov_b32 m0, s78
    ds_read_b64_tr_b16 a[178:179], v16 offset:1792
    v_mfma_f32_16x16x32_bf16 v[100:103], a[120:123], a[164:167], v[100:103]
    s_add_u32 s64, s61, s62
    s_waitcnt lgkmcnt(4)
    buffer_load_dwordx4 v62, s[44:47], s58 offen offset:0 lds
    v_mfma_f32_16x16x32_bf16 v[96:99], a[120:123], a[160:163], v[96:99]
    ds_read_b64_tr_b16 a[180:181], v16 offset:7168
    v_mfma_f32_16x16x32_bf16 v[80:83], a[116:119], a[160:163], v[80:83]
    s_add_u32 s14, s65, 22528
    ds_read_b64_tr_b16 a[182:183], v16 offset:8960
    v_mfma_f32_16x16x32_bf16 v[84:87], a[116:119], a[164:167], v[84:87]
    s_cmp_eq_u32 s14, 45056
    s_cselect_b32 s14, 102400, s14
    v_mfma_f32_16x16x32_bf16 v[68:71], a[112:115], a[164:167], v[68:71]
    s_cmp_eq_u32 s14, 124928
    s_cselect_b32 s14, 0, s14
    v_mfma_f32_16x16x32_bf16 v[64:67], a[112:115], a[160:163], v[64:67]
    s_waitcnt lgkmcnt(4)
    buffer_load_dwordx4 v63, s[44:47], s58 offen offset:1024 lds
    v_mfma_f32_16x16x32_bf16 v[72:75], a[112:115], a[168:171], v[72:75]
    s_sub_u32 s65, s14, s65
    ds_read_b64_tr_b16 a[160:161], v16 offset:32
    v_add_u32 v12, s65, v12
    v_mfma_f32_16x16x32_bf16 v[76:79], a[112:115], a[172:175], v[76:79]
    ds_read_b64_tr_b16 a[162:163], v16 offset:1824
    v_add_u32 v13, s65, v13
    v_mfma_f32_16x16x32_bf16 v[92:95], a[116:119], a[172:175], v[92:95]
    v_add_u32 v14, s65, v14
    v_add_u32 v15, s65, v15
    v_mfma_f32_16x16x32_bf16 v[88:91], a[116:119], a[168:171], v[88:91]
    s_mov_b32 s65, s14
    ds_read_b64_tr_b16 a[164:165], v16 offset:7200
    v_mfma_f32_16x16x32_bf16 v[104:107], a[120:123], a[168:171], v[104:107]
    s_add_u32 s14, s13, 14336
    ds_read_b64_tr_b16 a[166:167], v16 offset:8992
    v_mfma_f32_16x16x32_bf16 v[108:111], a[120:123], a[172:175], v[108:111]
    s_cmp_eq_u32 s14, 102400
    s_cselect_b32 s14, 45056, s14
    v_mfma_f32_16x16x32_bf16 v[124:127], a[124:127], a[172:175], v[124:127]
    s_sub_u32 s15, s14, s13
    s_waitcnt vmcnt(13)
    ds_read_b128 a[136:139], v18 offset:4096
    v_mfma_f32_16x16x32_bf16 v[120:123], a[124:127], a[168:171], v[120:123]
    s_waitcnt lgkmcnt(5)
    buffer_load_dwordx4 v62, s[44:47], s58 offen offset:2048 lds
    v_mfma_f32_16x16x32_bf16 v[140:143], a[176:179], a[124:127], v[140:143]
    s_mov_b32 s13, s14
    ds_read_b64_tr_b16 a[168:169], v16 offset:64
    v_mfma_f32_16x16x32_bf16 v[204:207], a[180:183], a[124:127], v[204:207]
    ds_read_b64_tr_b16 a[170:171], v16 offset:1856
    v_mfma_f32_16x16x32_bf16 v[200:203], a[180:183], a[120:123], v[200:203]
    ds_read_b128 a[152:155], v19 offset:4096
    v_mfma_f32_16x16x32_bf16 v[136:139], a[176:179], a[120:123], v[136:139]
    ds_read_b64_tr_b16 a[172:173], v16 offset:7232
    v_mfma_f32_16x16x32_bf16 v[132:135], a[176:179], a[116:119], v[132:135]
    ds_read_b64_tr_b16 a[174:175], v16 offset:9024
    v_mfma_f32_16x16x32_bf16 v[196:199], a[180:183], a[116:119], v[196:199]
    ds_read_b128 a[140:143], v18 offset:6144
    v_mfma_f32_16x16x32_bf16 v[192:195], a[180:183], a[112:115], v[192:195]
    buffer_load_dwordx4 v63, s[44:47], s58 offen offset:3072 lds
    v_mfma_f32_16x16x32_bf16 v[128:131], a[176:179], a[112:115], v[128:131]
    s_waitcnt lgkmcnt(7)
    ds_read_b128 a[156:159], v19 offset:6144
    v_mfma_f32_16x16x32_bf16 v[144:147], a[160:163], a[112:115], v[144:147]
    s_add_u32 s58, s58, 128
    ds_read_b64_tr_b16 a[176:177], v16 offset:96
    v_mfma_f32_16x16x32_bf16 v[208:211], a[164:167], a[112:115], v[208:211]
    ds_read_b64_tr_b16 a[178:179], v16 offset:1888
    v_mfma_f32_16x16x32_bf16 v[212:215], a[164:167], a[116:119], v[212:215]
    v_mfma_f32_16x16x32_bf16 v[148:151], a[160:163], a[116:119], v[148:151]
    ds_read_b64_tr_b16 a[180:181], v16 offset:7264
    v_mfma_f32_16x16x32_bf16 v[152:155], a[160:163], a[120:123], v[152:155]
    ds_read_b64_tr_b16 a[182:183], v16 offset:9056
    v_mfma_f32_16x16x32_bf16 v[216:219], a[164:167], a[120:123], v[216:219]
    v_mfma_f32_16x16x32_bf16 v[220:223], a[164:167], a[124:127], v[220:223]
    s_waitcnt vmcnt(14)
    v_lshlrev_b32 v38, 16, v32
    v_and_b32 v32, 0xffff0000, v32
    v_mfma_f32_16x16x32_bf16 v[156:159], a[160:163], a[124:127], v[156:159]
    s_waitcnt lgkmcnt(6)
    v_add_f32 v20, v20, v38
    v_add_f32 v21, v21, v32
    v_mfma_f32_16x16x32_bf16 v[172:175], a[168:171], a[124:127], v[172:175]
    ds_read_b64_tr_b16 a[160:161], v16 offset:128
    v_lshlrev_b32 v38, 16, v33
    v_mfma_f32_16x16x32_bf16 v[236:239], a[172:175], a[124:127], v[236:239]
    s_add_u32 m0, s78, 4096
    ds_read_b64_tr_b16 a[162:163], v16 offset:1920
    v_and_b32 v33, 0xffff0000, v33
    v_mfma_f32_16x16x32_bf16 v[232:235], a[172:175], a[120:123], v[232:235]
    s_waitcnt lgkmcnt(6)
    buffer_load_dwordx4 v62, s[44:47], s59 offen offset:0 lds
    v_mfma_f32_16x16x32_bf16 v[168:171], a[168:171], a[120:123], v[168:171]
    ds_read_b64_tr_b16 a[164:165], v16 offset:7296
    v_add_f32 v22, v22, v38
    v_mfma_f32_16x16x32_bf16 v[164:167], a[168:171], a[116:119], v[164:167]
    ds_read_b64_tr_b16 a[166:167], v16 offset:9088
    v_add_f32 v23, v23, v33
    v_mfma_f32_16x16x32_bf16 v[228:231], a[172:175], a[116:119], v[228:231]
    v_lshlrev_b32 v38, 16, v34
    v_and_b32 v34, 0xffff0000, v34
    v_mfma_f32_16x16x32_bf16 v[224:227], a[172:175], a[112:115], v[224:227]
    buffer_load_dwordx4 v63, s[44:47], s59 offen offset:1024 lds
    v_mfma_f32_16x16x32_bf16 v[160:163], a[168:171], a[112:115], v[160:163]
    s_waitcnt lgkmcnt(4)
    v_add_f32 v24, v24, v38
    v_add_f32 v25, v25, v34
    v_mfma_f32_16x16x32_bf16 v[176:179], a[176:179], a[112:115], v[176:179]
    ds_read_b64_tr_b16 a[168:169], v16 offset:160
    v_lshlrev_b32 v38, 16, v35
    v_mfma_f32_16x16x32_bf16 v[240:243], a[180:183], a[112:115], v[240:243]
    ds_read_b64_tr_b16 a[170:171], v16 offset:1952
    v_and_b32 v35, 0xffff0000, v35
    v_mfma_f32_16x16x32_bf16 v[244:247], a[180:183], a[116:119], v[244:247]
    buffer_load_dwordx4 v62, s[44:47], s59 offen offset:2048 lds
    v_mfma_f32_16x16x32_bf16 v[180:183], a[176:179], a[116:119], v[180:183]
    ds_read_b64_tr_b16 a[172:173], v16 offset:7328
    v_add_f32 v26, v26, v38
    v_mfma_f32_16x16x32_bf16 v[184:187], a[176:179], a[120:123], v[184:187]
    ds_read_b64_tr_b16 a[174:175], v16 offset:9120
    v_add_f32 v27, v27, v35
    v_mfma_f32_16x16x32_bf16 v[248:251], a[180:183], a[120:123], v[248:251]
    v_mfma_f32_16x16x32_bf16 v[252:255], a[180:183], a[124:127], v[252:255]
    buffer_load_dwordx4 v63, s[44:47], s59 offen offset:3072 lds
    v_mfma_f32_16x16x32_bf16 v[188:191], a[176:179], a[124:127], v[188:191]
    s_waitcnt lgkmcnt(4)
    v_mfma_f32_16x16x32_bf16 a[12:15], a[160:163], a[124:127], a[12:15]
    s_add_u32 s59, s59, 128
    ds_read_b64_tr_b16 a[176:177], v17 offset:0
    v_mfma_f32_16x16x32_bf16 a[60:63], a[164:167], a[124:127], a[60:63]
    ds_read_b64_tr_b16 a[178:179], v17 offset:1792
    v_mfma_f32_16x16x32_bf16 a[56:59], a[164:167], a[120:123], a[56:59]
    v_mfma_f32_16x16x32_bf16 a[8:11], a[160:163], a[120:123], a[8:11]
    ds_read_b64_tr_b16 a[180:181], v17 offset:7168
    v_mfma_f32_16x16x32_bf16 a[4:7], a[160:163], a[116:119], a[4:7]
    ds_read_b64_tr_b16 a[182:183], v17 offset:8960
    v_mfma_f32_16x16x32_bf16 a[52:55], a[164:167], a[116:119], a[52:55]
    v_mfma_f32_16x16x32_bf16 a[48:51], a[164:167], a[112:115], a[48:51]
    buffer_load_dwordx4 v[32:35], v40, s[4:7], s84 offen
    v_mfma_f32_16x16x32_bf16 a[0:3], a[160:163], a[112:115], a[0:3]
    s_waitcnt vmcnt(9) lgkmcnt(4)
    s_barrier
    v_mfma_f32_16x16x32_bf16 a[16:19], a[168:171], a[112:115], a[16:19]
    s_add_u32 s84, s84, 458752
    ds_read_b128 a[160:163], v14 offset:14336
    v_add_u32 v16, s15, v16
    v_mfma_f32_16x16x32_bf16 a[64:67], a[172:175], a[112:115], a[64:67]
    v_add_u32 v17, s15, v17
    v_mfma_f32_16x16x32_bf16 a[68:71], a[172:175], a[116:119], a[68:71]
    buffer_load_dword v0, v2, s[28:31], s86 offen
    v_mfma_f32_16x16x32_bf16 a[20:23], a[168:171], a[116:119], a[20:23]
    s_add_u32 s86, s86, 524288
    ds_read_b128 a[164:167], v14 offset:18432
    v_mfma_f32_16x16x32_bf16 a[24:27], a[168:171], a[120:123], a[24:27]
    buffer_store_dword v37, v41, s[36:39], s79 offen sc1
    v_mfma_f32_16x16x32_bf16 a[72:75], a[172:175], a[120:123], a[72:75]
    s_mov_b32 s79, 0x7ff00000
    v_mfma_f32_16x16x32_bf16 a[76:79], a[172:175], a[124:127], a[76:79]
    v_mfma_f32_16x16x32_bf16 a[28:31], a[168:171], a[124:127], a[28:31]
    s_waitcnt lgkmcnt(2)
    v_mfma_f32_16x16x32_bf16 a[44:47], a[176:179], a[124:127], a[44:47]
    ds_read_b128 a[168:171], v14 offset:16384
    v_mfma_f32_16x16x32_bf16 a[92:95], a[180:183], a[124:127], a[92:95]
    v_mfma_f32_16x16x32_bf16 a[88:91], a[180:183], a[120:123], a[88:91]
    v_mfma_f32_16x16x32_bf16 a[40:43], a[176:179], a[120:123], a[40:43]
    ds_read_b128 a[172:175], v14 offset:20480
    v_mfma_f32_16x16x32_bf16 a[36:39], a[176:179], a[116:119], a[36:39]
    v_mfma_f32_16x16x32_bf16 a[84:87], a[180:183], a[116:119], a[84:87]
    v_mfma_f32_16x16x32_bf16 a[80:83], a[180:183], a[112:115], a[80:83]
    v_mfma_f32_16x16x32_bf16 a[32:35], a[176:179], a[112:115], a[32:35]
    s_waitcnt lgkmcnt(2)
    s_cmp_lt_u32 s66, 5
    s_cbranch_scc1 LF_loop
    v_mfma_f32_16x16x32_bf16 v[64:67], a[128:131], a[160:163], v[64:67]
    s_mov_b32 s79, 507904
    ds_read_b64_tr_b16 a[176:177], v12 offset:0
    v_mfma_f32_16x16x32_bf16 v[68:71], a[128:131], a[164:167], v[68:71]
    s_mov_b32 m0, s63
    ds_read_b64_tr_b16 a[178:179], v12 offset:1792
    v_mfma_f32_16x16x32_bf16 v[84:87], a[132:135], a[164:167], v[84:87]
    buffer_load_dwordx4 v3, s[4:7], s56 offen offset:0  lds
    v_mfma_f32_16x16x32_bf16 v[80:83], a[132:135], a[160:163], v[80:83]
    ds_read_b64_tr_b16 a[180:181], v12 offset:7168
    v_mfma_f32_16x16x32_bf16 v[96:99], a[136:139], a[160:163], v[96:99]
    ds_read_b64_tr_b16 a[182:183], v12 offset:8960
    v_mfma_f32_16x16x32_bf16 v[100:103], a[136:139], a[164:167], v[100:103]
    buffer_load_dwordx4 v[28:31], v2, s[36:39], s79 offen sc1
    v_mfma_f32_16x16x32_bf16 v[116:119], a[140:143], a[164:167], v[116:119]
    s_bfe_u32 s82, s74, 0x7000c
    s_mul_i32 s83, s82, 4682
    s_lshr_b32 s83, s83, 16
    v_mfma_f32_16x16x32_bf16 v[112:115], a[140:143], a[160:163], v[112:115]
    s_mul_i32 s83, s83, 98
    s_mul_i32 s81, s53, 14
    s_waitcnt lgkmcnt(4)
    v_mfma_f32_16x16x32_bf16 v[120:123], a[140:143], a[168:171], v[120:123]
    s_add_u32 s81, s81, s83
    s_add_u32 s81, s81, s82
    ds_read_b64_tr_b16 a[160:161], v12 offset:32
    v_mfma_f32_16x16x32_bf16 v[124:127], a[140:143], a[172:175], v[124:127]
    s_lshr_b32 s88, s48, 1
    s_mul_i32 s83, s88, 56
    ds_read_b64_tr_b16 a[162:163], v12 offset:1824
    v_mfma_f32_16x16x32_bf16 v[108:111], a[136:139], a[172:175], v[108:111]
    s_add_u32 s81, s81, s83
    buffer_load_dwordx4 v4, s[4:7], s56 offen offset:1024  lds
    v_mfma_f32_16x16x32_bf16 v[104:107], a[136:139], a[168:171], v[104:107]
    s_lshl_b32 s81, s81, 8
    s_add_u32 s81, s81, 589824
    ds_read_b64_tr_b16 a[164:165], v12 offset:7200
    v_mfma_f32_16x16x32_bf16 v[88:91], a[132:135], a[168:171], v[88:91]
    s_cmp_ge_u32 s82, 112
    s_cselect_b32 s81, 0x7ff00000, s81
    ds_read_b64_tr_b16 a[166:167], v12 offset:8992
    v_mfma_f32_16x16x32_bf16 v[92:95], a[132:135], a[172:175], v[92:95]
    v_permlane32_swap_b32 v20, v24
    v_permlane32_swap_b32 v21, v25
    v_mfma_f32_16x16x32_bf16 v[76:79], a[128:131], a[172:175], v[76:79]
    v_permlane32_swap_b32 v22, v26
    v_permlane32_swap_b32 v23, v27
    v_mfma_f32_16x16x32_bf16 v[72:75], a[128:131], a[168:171], v[72:75]
    s_waitcnt lgkmcnt(4)
    v_add_f32 v20, v20, v24
    v_add_f32 v21, v21, v25
    v_mfma_f32_16x16x32_bf16 v[128:131], a[176:179], a[128:131], v[128:131]
    ds_read_b64_tr_b16 a[168:169], v12 offset:64
    v_add_f32 v22, v22, v26
    v_mfma_f32_16x16x32_bf16 v[192:195], a[180:183], a[128:131], v[192:195]
    ds_read_b64_tr_b16 a[170:171], v12 offset:1856
    v_add_f32 v23, v23, v27
    v_mfma_f32_16x16x32_bf16 v[196:199], a[180:183], a[132:135], v[196:199]
    buffer_load_dwordx4 v5, s[4:7], s56 offen offset:2048  lds
    v_mfma_f32_16x16x32_bf16 v[132:135], a[176:179], a[132:135], v[132:135]
    ds_read_b64_tr_b16 a[172:173], v12 offset:7232
    v_and_b32 v24, 7, v1
    v_mfma_f32_16x16x32_bf16 v[136:139], a[176:179], a[136:139], v[136:139]
    ds_read_b64_tr_b16 a[174:175], v12 offset:9024
    v_lshrrev_b32 v25, 4, v1
    v_mfma_f32_16x16x32_bf16 v[200:203], a[180:183], a[136:139], v[200:203]
    v_permlane16_swap_b32 v20, v22
    v_permlane16_swap_b32 v21, v23
    v_mfma_f32_16x16x32_bf16 v[204:207], a[180:183], a[140:143], v[204:207]
    v_add_f32 v20, v20, v22
    v_add_f32 v21, v21, v23
    v_mfma_f32_16x16x32_bf16 v[140:143], a[176:179], a[140:143], v[140:143]
    s_waitcnt lgkmcnt(4)
    v_lshlrev_b32 v24, 5, v24
    v_lshl_add_u32 v24, v25, 3, v24
    v_mfma_f32_16x16x32_bf16 v[156:159], a[160:163], a[140:143], v[156:159]
    ds_read_b64_tr_b16 a[176:177], v12 offset:96
    v_add_f32_dpp v20, v20, v20 row_ror:8 row_mask:0xf bank_mask:0xf
    v_mfma_f32_16x16x32_bf16 v[220:223], a[164:167], a[140:143], v[220:223]
    ds_read_b64_tr_b16 a[178:179], v12 offset:1888
    v_add_f32_dpp v21, v21, v21 row_ror:8 row_mask:0xf bank_mask:0xf
    v_mfma_f32_16x16x32_bf16 v[216:219], a[164:167], a[136:139], v[216:219]
    buffer_load_dwordx4 v6, s[4:7], s56 offen offset:3072  lds
    v_mfma_f32_16x16x32_bf16 v[152:155], a[160:163], a[136:139], v[152:155]
    ds_read_b64_tr_b16 a[180:181], v12 offset:7264
    v_mfma_f32_16x16x32_bf16 v[148:151], a[160:163], a[132:135], v[148:151]
    ds_read_b64_tr_b16 a[182:183], v12 offset:9056
    v_mfma_f32_16x16x32_bf16 v[212:215], a[164:167], a[132:135], v[212:215]
    buffer_store_dwordx2 v[20:21], v24, s[36:39], s81 offen sc1
    v_mfma_f32_16x16x32_bf16 v[208:211], a[164:167], a[128:131], v[208:211]
    v_accvgpr_read_b32 v56, a200
    v_accvgpr_read_b32 v57, a201
    v_mfma_f32_16x16x32_bf16 v[144:147], a[160:163], a[128:131], v[144:147]
    s_waitcnt lgkmcnt(4)
    v_accvgpr_read_b32 v58, a202
    v_accvgpr_read_b32 v59, a203
    v_mfma_f32_16x16x32_bf16 v[160:163], a[168:171], a[128:131], v[160:163]
    ds_read_b64_tr_b16 a[160:161], v12 offset:128
    v_accvgpr_read_b32 v60, a204
    v_mfma_f32_16x16x32_bf16 v[224:227], a[172:175], a[128:131], v[224:227]
    s_add_u32 m0, s63, 4096
    ds_read_b64_tr_b16 a[162:163], v12 offset:1920
    v_accvgpr_read_b32 v61, a205
    v_mfma_f32_16x16x32_bf16 v[228:231], a[172:175], a[132:135], v[228:231]
    buffer_load_dwordx4 v7, s[4:7], s56 offen offset:0  lds
    v_mfma_f32_16x16x32_bf16 v[164:167], a[168:171], a[132:135], v[164:167]
    ds_read_b64_tr_b16 a[164:165], v12 offset:7296
    v_lshlrev_b32 v56, 16, v56
    v_mfma_f32_16x16x32_bf16 v[168:171], a[168:171], a[136:139], v[168:171]
    ds_read_b64_tr_b16 a[166:167], v12 offset:9088
    v_lshlrev_b32 v57, 16, v57
    v_mfma_f32_16x16x32_bf16 v[232:235], a[172:175], a[136:139], v[232:235]
    v_lshlrev_b32 v58, 16, v58
    v_lshlrev_b32 v59, 16, v59
    v_mfma_f32_16x16x32_bf16 v[236:239], a[172:175], a[140:143], v[236:239]
    v_lshlrev_b32 v60, 16, v60
    v_lshlrev_b32 v61, 16, v61
    v_mfma_f32_16x16x32_bf16 v[172:175], a[168:171], a[140:143], v[172:175]
    s_waitcnt lgkmcnt(4)
    v_lshrrev_b32 v48, 4, v1
    v_cvt_f32_u32 v48, v48
    v_mfma_f32_16x16x32_bf16 v[188:191], a[176:179], a[140:143], v[188:191]
    ds_read_b64_tr_b16 a[168:169], v12 offset:160
    v_mul_f32 v60, 0x3fb8aa3b, v60
    v_mfma_f32_16x16x32_bf16 v[252:255], a[180:183], a[140:143], v[252:255]
    ds_read_b64_tr_b16 a[170:171], v12 offset:1952
    v_mul_f32 v61, 0x3fb8aa3b, v61
    v_mfma_f32_16x16x32_bf16 v[248:251], a[180:183], a[136:139], v[248:251]
    buffer_load_dwordx4 v8, s[4:7], s56 offen offset:1024  lds
    v_mfma_f32_16x16x32_bf16 v[184:187], a[176:179], a[136:139], v[184:187]
    ds_read_b64_tr_b16 a[172:173], v12 offset:7328
    v_mfma_f32_16x16x32_bf16 v[180:183], a[176:179], a[132:135], v[180:183]
    ds_read_b64_tr_b16 a[174:175], v12 offset:9120
    v_mfma_f32_16x16x32_bf16 v[244:247], a[180:183], a[132:135], v[244:247]
    v_exp_f32 v60, v60
    v_mfma_f32_16x16x32_bf16 v[240:243], a[180:183], a[128:131], v[240:243]
    v_exp_f32 v61, v61
    v_mfma_f32_16x16x32_bf16 v[176:179], a[176:179], a[128:131], v[176:179]
    s_waitcnt lgkmcnt(4)
    v_cvt_pk_bf16_f32 v49, v60, v61
    v_lshlrev_b32 v60, 16, v49
    v_mfma_f32_16x16x32_bf16 a[0:3], a[160:163], a[128:131], a[0:3]
    ds_read_b64_tr_b16 a[176:177], v13 offset:0
    v_and_b32 v61, 0xffff0000, v49
    v_mfma_f32_16x16x32_bf16 a[48:51], a[164:167], a[128:131], a[48:51]
    ds_read_b64_tr_b16 a[178:179], v13 offset:1792
    v_mul_f32 v44, v60, v56
    v_mfma_f32_16x16x32_bf16 a[52:55], a[164:167], a[132:135], a[52:55]
    buffer_load_dwordx4 v9, s[4:7], s56 offen offset:2048  lds
    v_mfma_f32_16x16x32_bf16 a[4:7], a[160:163], a[132:135], a[4:7]
    ds_read_b64_tr_b16 a[180:181], v13 offset:7168
    v_mul_f32 v46, v60, v58
    v_mfma_f32_16x16x32_bf16 a[8:11], a[160:163], a[136:139], a[8:11]
    ds_read_b64_tr_b16 a[182:183], v13 offset:8960
    v_mul_f32 v45, v61, v57
    v_mfma_f32_16x16x32_bf16 a[56:59], a[164:167], a[136:139], a[56:59]
    v_mul_f32 v47, v61, v59
    v_mul_f32 v44, 0x3fb8aa3b, v44
    v_mfma_f32_16x16x32_bf16 a[60:63], a[164:167], a[140:143], a[60:63]
    s_waitcnt vmcnt(16)
    ds_read_b128 a[96:99], v18 offset:0
    v_mul_f32 v46, 0x3e22f983, v46
    v_mfma_f32_16x16x32_bf16 a[12:15], a[160:163], a[140:143], a[12:15]
    s_waitcnt lgkmcnt(5)
    v_mul_f32 v45, 0x3fb8aa3b, v45
    v_mul_f32 v47, 0x3e22f983, v47
    v_mfma_f32_16x16x32_bf16 a[28:31], a[168:171], a[140:143], a[28:31]
    s_mov_b32 m0, s64
    ds_read_b128 a[160:163], v15 offset:14336
    v_mul_f32 v49, 0x3f800000, v44
    v_mfma_f32_16x16x32_bf16 a[76:79], a[172:175], a[140:143], a[76:79]
    buffer_load_dwordx4 v10, s[8:11], s57 offen offset:0  lds
    v_mfma_f32_16x16x32_bf16 a[72:75], a[172:175], a[136:139], a[72:75]
    ds_read_b128 a[112:115], v19 offset:0
    v_mul_f32 v51, 0x3f800000, v46
    v_mfma_f32_16x16x32_bf16 a[24:27], a[168:171], a[136:139], a[24:27]
    ds_read_b128 a[164:167], v15 offset:18432
    v_mul_f32 v50, 0x3f800000, v45
    v_mfma_f32_16x16x32_bf16 a[20:23], a[168:171], a[132:135], a[20:23]
    ds_read_b128 a[100:103], v18 offset:2048
    v_mul_f32 v52, 0x3f800000, v47
    v_mfma_f32_16x16x32_bf16 a[68:71], a[172:175], a[132:135], a[68:71]
    v_rndne_f32 v53, v51
    v_rndne_f32 v54, v52
    v_mfma_f32_16x16x32_bf16 a[64:67], a[172:175], a[128:131], a[64:67]
    ds_read_b128 a[116:119], v19 offset:2048
    v_sub_f32 v51, v51, v53
    v_mfma_f32_16x16x32_bf16 a[16:19], a[168:171], a[128:131], a[16:19]
    s_waitcnt lgkmcnt(6)
    buffer_load_dwordx4 v11, s[8:11], s57 offen offset:1024  lds
    v_mfma_f32_16x16x32_bf16 a[32:35], a[176:179], a[128:131], a[32:35]
    s_add_u32 s56, s56, 458752
    ds_read_b128 a[168:171], v15 offset:16384
    v_sub_f32 v52, v52, v54
    v_mfma_f32_16x16x32_bf16 a[80:83], a[180:183], a[128:131], a[80:83]
    s_add_u32 s57, s57, 128
    v_exp_f32 v49, v49
    v_mfma_f32_16x16x32_bf16 a[84:87], a[180:183], a[132:135], a[84:87]
    s_add_u32 s62, s62, 22528
    v_exp_f32 v50, v50
    v_mfma_f32_16x16x32_bf16 a[36:39], a[176:179], a[132:135], a[36:39]
    s_cmp_eq_u32 s62, 45056
    s_cselect_b32 s62, 102400, s62
    ds_read_b128 a[172:175], v15 offset:20480
    v_mfma_f32_16x16x32_bf16 a[40:43], a[176:179], a[136:139], a[40:43]
    s_cmp_eq_u32 s62, 124928
    s_cselect_b32 s62, 0, s62
    v_mfma_f32_16x16x32_bf16 a[88:91], a[180:183], a[136:139], a[88:91]
    s_add_u32 s12, s12, 14336
    s_waitcnt vmcnt(13)
    v_cos_f32 v20, v51
    v_mfma_f32_16x16x32_bf16 a[92:95], a[180:183], a[140:143], a[92:95]
    s_cmp_eq_u32 s12, 102400
    s_cselect_b32 s12, 45056, s12
    v_mfma_f32_16x16x32_bf16 a[44:47], a[176:179], a[140:143], a[44:47]
    s_waitcnt lgkmcnt(4)
    s_waitcnt vmcnt(9)
    v_min3_u32 v42, v28, v29, v30
    v_mfma_f32_16x16x32_bf16 v[112:115], a[156:159], a[160:163], v[112:115]
    s_bitcmp1_b32 s48, 0
    s_cselect_b32 s63, s12, s62
    ds_read_b64_tr_b16 a[176:177], v16 offset:0
    v_mfma_f32_16x16x32_bf16 v[116:119], a[156:159], a[164:167], v[116:119]
    s_add_u32 s63, s63, s60
    s_mov_b32 m0, s78
    ds_read_b64_tr_b16 a[178:179], v16 offset:1792
    v_mfma_f32_16x16x32_bf16 v[100:103], a[152:155], a[164:167], v[100:103]
    s_add_u32 s64, s61, s62
    s_waitcnt lgkmcnt(4)
    buffer_load_dwordx4 v62, s[44:47], s58 offen offset:0 lds
    v_mfma_f32_16x16x32_bf16 v[96:99], a[152:155], a[160:163], v[96:99]
    ds_read_b64_tr_b16 a[180:181], v16 offset:7168
    v_max3_u32 v43, v28, v29, v30
    v_mfma_f32_16x16x32_bf16 v[80:83], a[148:151], a[160:163], v[80:83]
    s_add_u32 s14, s65, 22528
    ds_read_b64_tr_b16 a[182:183], v16 offset:8960
    v_min_u32 v42, v42, v31
    v_mfma_f32_16x16x32_bf16 v[84:87], a[148:151], a[164:167], v[84:87]
    s_cmp_eq_u32 s14, 45056
    s_cselect_b32 s14, 102400, s14
    v_max_u32 v43, v43, v31
    v_mfma_f32_16x16x32_bf16 v[68:71], a[144:147], a[164:167], v[68:71]
    s_cmp_eq_u32 s14, 124928
    s_cselect_b32 s14, 0, s14
    v_cmp_ne_u32 s[84:85], s80, v42
    v_mfma_f32_16x16x32_bf16 v[64:67], a[144:147], a[160:163], v[64:67]
    s_waitcnt lgkmcnt(4)
    buffer_load_dwordx4 v63, s[44:47], s58 offen offset:1024 lds
    v_mfma_f32_16x16x32_bf16 v[72:75], a[144:147], a[168:171], v[72:75]
    s_sub_u32 s65, s14, s65
    ds_read_b64_tr_b16 a[160:161], v16 offset:32
    v_add_u32 v12, s65, v12
    v_mfma_f32_16x16x32_bf16 v[76:79], a[144:147], a[172:175], v[76:79]
    ds_read_b64_tr_b16 a[162:163], v16 offset:1824
    v_add_u32 v13, s65, v13
    v_mfma_f32_16x16x32_bf16 v[92:95], a[148:151], a[172:175], v[92:95]
    v_add_u32 v14, s65, v14
    v_add_u32 v15, s65, v15
    v_mfma_f32_16x16x32_bf16 v[88:91], a[148:151], a[168:171], v[88:91]
    s_mov_b32 s65, s14
    ds_read_b64_tr_b16 a[164:165], v16 offset:7200
    v_cmp_ne_u32 vcc, s80, v43
    v_mfma_f32_16x16x32_bf16 v[104:107], a[152:155], a[168:171], v[104:107]
    s_add_u32 s14, s13, 14336
    s_or_b64 vcc, vcc, s[84:85]
    ds_read_b64_tr_b16 a[166:167], v16 offset:8992
    v_mfma_f32_16x16x32_bf16 v[108:111], a[152:155], a[172:175], v[108:111]
    s_cmp_eq_u32 s14, 102400
    s_cselect_b32 s14, 45056, s14
    s_cbranch_vccnz LF_c_spin
LF_c_back:
    v_mfma_f32_16x16x32_bf16 v[124:127], a[156:159], a[172:175], v[124:127]
    s_sub_u32 s15, s14, s13
    ds_read_b128 a[104:107], v18 offset:4096
    v_mfma_f32_16x16x32_bf16 v[120:123], a[156:159], a[168:171], v[120:123]
    s_waitcnt lgkmcnt(5)
    buffer_load_dwordx4 v62, s[44:47], s58 offen offset:2048 lds
    v_mfma_f32_16x16x32_bf16 v[140:143], a[176:179], a[156:159], v[140:143]
    s_mov_b32 s13, s14
    s_lshl_b32 s81, s2, 2
    ds_read_b64_tr_b16 a[168:169], v16 offset:64
    v_mfma_f32_16x16x32_bf16 v[204:207], a[180:183], a[156:159], v[204:207]
    s_add_u32 s81, s81, s48
    s_mov_b32 s82, 32768
    ds_read_b64_tr_b16 a[170:171], v16 offset:1856
    v_mfma_f32_16x16x32_bf16 v[200:203], a[180:183], a[152:155], v[200:203]
    s_cmp_eq_u32 s81, 0
    s_cselect_b32 s81, s82, 0x7ff00000
    ds_read_b128 a[120:123], v19 offset:4096
    v_mfma_f32_16x16x32_bf16 v[136:139], a[176:179], a[152:155], v[136:139]
    ds_read_b64_tr_b16 a[172:173], v16 offset:7232
    v_mov_b32 v40, 0
    v_mfma_f32_16x16x32_bf16 v[132:135], a[176:179], a[148:151], v[132:135]
    ds_read_b64_tr_b16 a[174:175], v16 offset:9024
    v_mov_b32 v41, s80
    v_mfma_f32_16x16x32_bf16 v[196:199], a[180:183], a[148:151], v[196:199]
    ds_read_b128 a[108:111], v18 offset:6144
    v_mfma_f32_16x16x32_bf16 v[192:195], a[180:183], a[144:147], v[192:195]
    buffer_load_dwordx4 v63, s[44:47], s58 offen offset:3072 lds
    v_mfma_f32_16x16x32_bf16 v[128:131], a[176:179], a[144:147], v[128:131]
    s_waitcnt lgkmcnt(7)
    ds_read_b128 a[124:127], v19 offset:6144
    v_mfma_f32_16x16x32_bf16 v[144:147], a[160:163], a[144:147], v[144:147]
    s_add_u32 s58, s58, 128
    ds_read_b64_tr_b16 a[176:177], v16 offset:96
    v_mfma_f32_16x16x32_bf16 v[208:211], a[164:167], a[144:147], v[208:211]
    ds_read_b64_tr_b16 a[178:179], v16 offset:1888
    v_mfma_f32_16x16x32_bf16 v[212:215], a[164:167], a[148:151], v[212:215]
    buffer_store_dword v41, v40, s[36:39], s81 offen sc1
    v_mfma_f32_16x16x32_bf16 v[148:151], a[160:163], a[148:151], v[148:151]
    s_lshl_b32 s81, s50, 7
    s_add_u32 s81, s81, 819200
    ds_read_b64_tr_b16 a[180:181], v16 offset:7264
    v_mfma_f32_16x16x32_bf16 v[152:155], a[160:163], a[152:155], v[152:155]
    s_add_u32 s82, s81, 4096
    s_lshl_b32 s83, s49, 9
    ds_read_b64_tr_b16 a[182:183], v16 offset:9056
    v_mfma_f32_16x16x32_bf16 v[216:219], a[164:167], a[152:155], v[216:219]
    v_and_b32 v40, 15, v1
    v_lshlrev_b32 v40, 2, v40
    v_mfma_f32_16x16x32_bf16 v[220:223], a[164:167], a[156:159], v[220:223]
    v_lshlrev_b32 v41, 3, v1
    v_mfma_f32_16x16x32_bf16 v[156:159], a[160:163], a[156:159], v[156:159]
    s_waitcnt lgkmcnt(6)
    buffer_load_dword a208, v40, s[36:39], s81 offen offset:0 sc1
    v_mfma_f32_16x16x32_bf16 v[172:175], a[168:171], a[156:159], v[172:175]
    ds_read_b64_tr_b16 a[160:161], v16 offset:128
    v_mfma_f32_16x16x32_bf16 v[236:239], a[172:175], a[156:159], v[236:239]
    s_add_u32 m0, s78, 4096
    ds_read_b64_tr_b16 a[162:163], v16 offset:1920
    v_mfma_f32_16x16x32_bf16 v[232:235], a[172:175], a[152:155], v[232:235]
LF_pad4:
    s_cbranch_execz LF_pad8
    s_waitcnt lgkmcnt(6)
    buffer_load_dwordx4 v62, s[44:47], s59 offen offset:0 lds
    v_mfma_f32_16x16x32_bf16 v[168:171], a[168:171], a[152:155], v[168:171]
    ds_read_b64_tr_b16 a[164:165], v16 offset:7296
    v_mfma_f32_16x16x32_bf16 v[164:167], a[168:171], a[148:151], v[164:167]
    ds_read_b64_tr_b16 a[166:167], v16 offset:9088
    v_mfma_f32_16x16x32_bf16 v[228:231], a[172:175], a[148:151], v[228:231]
    buffer_load_dword a209, v40, s[36:39], s82 offen offset:0 sc1
    v_mfma_f32_16x16x32_bf16 v[224:227], a[172:175], a[144:147], v[224:227]
    buffer_load_dwordx4 v63, s[44:47], s59 offen offset:1024 lds
    v_mfma_f32_16x16x32_bf16 v[160:163], a[168:171], a[144:147], v[160:163]
    s_waitcnt lgkmcnt(4)
    buffer_load_dword a210, v40, s[36:39], s81 offen offset:64 sc1
    v_mfma_f32_16x16x32_bf16 v[176:179], a[176:179], a[144:147], v[176:179]
    ds_read_b64_tr_b16 a[168:169], v16 offset:160
    v_mfma_f32_16x16x32_bf16 v[240:243], a[180:183], a[144:147], v[240:243]
    ds_read_b64_tr_b16 a[170:171], v16 offset:1952
    v_mfma_f32_16x16x32_bf16 v[244:247], a[180:183], a[148:151], v[244:247]
    buffer_load_dwordx4 v62, s[44:47], s59 offen offset:2048 lds
    v_mfma_f32_16x16x32_bf16 v[180:183], a[176:179], a[148:151], v[180:183]
    ds_read_b64_tr_b16 a[172:173], v16 offset:7328
    v_mfma_f32_16x16x32_bf16 v[184:187], a[176:179], a[152:155], v[184:187]
    ds_read_b64_tr_b16 a[174:175], v16 offset:9120
    v_mfma_f32_16x16x32_bf16 v[248:251], a[180:183], a[152:155], v[248:251]
    buffer_load_dword a211, v40, s[36:39], s82 offen offset:64 sc1
    v_mfma_f32_16x16x32_bf16 v[252:255], a[180:183], a[156:159], v[252:255]
    buffer_load_dwordx4 v63, s[44:47], s59 offen offset:3072 lds
    v_mfma_f32_16x16x32_bf16 v[188:191], a[176:179], a[156:159], v[188:191]
    s_waitcnt lgkmcnt(4)
    buffer_load_dwordx2 a[206:207], v41, s[36:39], s83 offen sc1
    v_mfma_f32_16x16x32_bf16 a[12:15], a[160:163], a[156:159], a[12:15]
    s_add_u32 s59, s59, 128
    ds_read_b64_tr_b16 a[176:177], v17 offset:0
    v_mfma_f32_16x16x32_bf16 a[60:63], a[164:167], a[156:159], a[60:63]
    ds_read_b64_tr_b16 a[178:179], v17 offset:1792
    v_mfma_f32_16x16x32_bf16 a[56:59], a[164:167], a[152:155], a[56:59]
    v_sin_f32 v21, v51
    v_mfma_f32_16x16x32_bf16 a[8:11], a[160:163], a[152:155], a[8:11]
    ds_read_b64_tr_b16 a[180:181], v17 offset:7168
    v_mfma_f32_16x16x32_bf16 a[4:7], a[160:163], a[148:151], a[4:7]
    ds_read_b64_tr_b16 a[182:183], v17 offset:8960
    v_mfma_f32_16x16x32_bf16 a[52:55], a[164:167], a[148:151], a[52:55]
    v_cos_f32 v32, v52
    v_mfma_f32_16x16x32_bf16 a[48:51], a[164:167], a[144:147], a[48:51]
    v_sin_f32 v33, v52
    v_mfma_f32_16x16x32_bf16 a[0:3], a[160:163], a[144:147], a[0:3]
    s_waitcnt vmcnt(14) lgkmcnt(4)
    s_barrier
    v_mul_f32 v20, v20, v49
    v_mfma_f32_16x16x32_bf16 a[16:19], a[168:171], a[144:147], a[16:19]
    ds_read_b128 a[160:163], v14 offset:14336
    v_add_u32 v16, s15, v16
    v_mfma_f32_16x16x32_bf16 a[64:67], a[172:175], a[144:147], a[64:67]
    v_add_u32 v17, s15, v17
    v_mul_f32 v21, v21, v49
    v_mfma_f32_16x16x32_bf16 a[68:71], a[172:175], a[148:151], a[68:71]
    v_mul_f32 v32, v32, v50
    v_mul_f32 v33, v33, v50
    v_mfma_f32_16x16x32_bf16 a[20:23], a[168:171], a[148:151], a[20:23]
    ds_read_b128 a[164:167], v14 offset:18432
    v_mul_f32 v49, 0x41800000, v44
    v_mfma_f32_16x16x32_bf16 a[24:27], a[168:171], a[152:155], a[24:27]
    v_mul_f32 v51, 0x41800000, v46
    v_mul_f32 v50, 0x41800000, v45
    v_mfma_f32_16x16x32_bf16 a[72:75], a[172:175], a[152:155], a[72:75]
    v_mul_f32 v52, 0x41800000, v47
    v_rndne_f32 v53, v51
    v_mfma_f32_16x16x32_bf16 a[76:79], a[172:175], a[156:159], a[76:79]
    v_rndne_f32 v54, v52
    v_sub_f32 v51, v51, v53
    v_mfma_f32_16x16x32_bf16 a[28:31], a[168:171], a[156:159], a[28:31]
    s_waitcnt lgkmcnt(2)
    v_sub_f32 v52, v52, v54
    v_mfma_f32_16x16x32_bf16 a[44:47], a[176:179], a[156:159], a[44:47]
    ds_read_b128 a[168:171], v14 offset:16384
    v_mfma_f32_16x16x32_bf16 a[92:95], a[180:183], a[156:159], a[92:95]
    v_exp_f32 v49, v49
    v_mfma_f32_16x16x32_bf16 a[88:91], a[180:183], a[152:155], a[88:91]
    v_exp_f32 v50, v50
    v_mfma_f32_16x16x32_bf16 a[40:43], a[176:179], a[152:155], a[40:43]
    ds_read_b128 a[172:175], v14 offset:20480
    v_mfma_f32_16x16x32_bf16 a[36:39], a[176:179], a[148:151], a[36:39]
    v_cos_f32 v22, v51
    v_mfma_f32_16x16x32_bf16 a[84:87], a[180:183], a[148:151], a[84:87]
    v_sin_f32 v23, v51
    v_mfma_f32_16x16x32_bf16 a[80:83], a[180:183], a[144:147], a[80:83]
    v_cos_f32 v34, v52
    v_mfma_f32_16x16x32_bf16 a[32:35], a[176:179], a[144:147], a[32:35]
    s_waitcnt lgkmcnt(2)
    v_sin_f32 v35, v52
    v_mfma_f32_16x16x32_bf16 v[64:67], a[96:99], a[160:163], v[64:67]
    s_getpc_b64 s[84:85]
LF_pc:
    s_lshr_b32 s81, s2, 3
    ds_read_b64_tr_b16 a[176:177], v12 offset:0
    v_mfma_f32_16x16x32_bf16 v[68:71], a[96:99], a[164:167], v[68:71]
    s_mov_b32 m0, s63
    s_lshl_b32 s81, s81, 2
    ds_read_b64_tr_b16 a[178:179], v12 offset:1792
    v_mfma_f32_16x16x32_bf16 v[84:87], a[100:103], a[164:167], v[84:87]
    s_add_u32 s81, s81, s48
    buffer_load_dwordx4 v3, s[4:7], s56 offen offset:0  lds
    v_mfma_f32_16x16x32_bf16 v[80:83], a[100:103], a[160:163], v[80:83]
    s_lshl_b32 s81, s81, 9
    ds_read_b64_tr_b16 a[180:181], v12 offset:7168
    v_lshrrev_b32 v62, 4, v1
    v_mfma_f32_16x16x32_bf16 v[96:99], a[104:107], a[160:163], v[96:99]
    ds_read_b64_tr_b16 a[182:183], v12 offset:8960
    v_lshl_add_u32 v62, v62, 7, s81
    v_mfma_f32_16x16x32_bf16 v[100:103], a[104:107], a[164:167], v[100:103]
    v_min_u32 v62, LF_end-LF_pc, v62
    v_mov_b32 v63, s85
    v_mfma_f32_16x16x32_bf16 v[116:119], a[108:111], a[164:167], v[116:119]
    v_add_co_u32 v62, vcc, s84, v62
    v_mul_f32 v22, v22, v49
    v_mfma_f32_16x16x32_bf16 v[112:115], a[108:111], a[160:163], v[112:115]
    s_nop 0
    s_waitcnt lgkmcnt(4)
    v_addc_co_u32 v63, vcc, 0, v63, vcc
    v_mfma_f32_16x16x32_bf16 v[120:123], a[108:111], a[168:171], v[120:123]
    ds_read_b64_tr_b16 a[160:161], v12 offset:32
    v_mul_f32 v23, v23, v49
    v_mfma_f32_16x16x32_bf16 v[124:127], a[108:111], a[172:175], v[124:127]
    ds_read_b64_tr_b16 a[162:163], v12 offset:1824
    v_mul_f32 v34, v34, v50
    v_mfma_f32_16x16x32_bf16 v[108:111], a[104:107], a[172:175], v[108:111]
    buffer_load_dwordx4 v4, s[4:7], s56 offen offset:1024  lds
    v_mfma_f32_16x16x32_bf16 v[104:107], a[104:107], a[168:171], v[104:107]
    ds_read_b64_tr_b16 a[164:165], v12 offset:7200
    v_mul_f32 v35, v35, v50
    v_mfma_f32_16x16x32_bf16 v[88:91], a[100:103], a[168:171], v[88:91]
    ds_read_b64_tr_b16 a[166:167], v12 offset:8992
    v_mul_f32 v49, 0x42800000, v44
    v_mfma_f32_16x16x32_bf16 v[92:95], a[100:103], a[172:175], v[92:95]
    global_load_dword v0, v[62:63], off
    v_mul_f32 v51, 0x42800000, v46
    v_mfma_f32_16x16x32_bf16 v[76:79], a[96:99], a[172:175], v[76:79]
    v_mul_f32 v50, 0x42800000, v45
    v_mul_f32 v52, 0x42800000, v47
    v_mfma_f32_16x16x32_bf16 v[72:75], a[96:99], a[168:171], v[72:75]
    s_waitcnt lgkmcnt(4)
    v_rndne_f32 v53, v51
    v_rndne_f32 v54, v52
    v_mfma_f32_16x16x32_bf16 v[128:131], a[176:179], a[96:99], v[128:131]
    ds_read_b64_tr_b16 a[168:169], v12 offset:64
    v_sub_f32 v51, v51, v53
    v_mfma_f32_16x16x32_bf16 v[192:195], a[180:183], a[96:99], v[192:195]
    ds_read_b64_tr_b16 a[170:171], v12 offset:1856
    v_sub_f32 v52, v52, v54
    v_mfma_f32_16x16x32_bf16 v[196:199], a[180:183], a[100:103], v[196:199]
    buffer_load_dwordx4 v5, s[4:7], s56 offen offset:2048  lds
    v_mfma_f32_16x16x32_bf16 v[132:135], a[176:179], a[100:103], v[132:135]
    ds_read_b64_tr_b16 a[172:173], v12 offset:7232
    v_mfma_f32_16x16x32_bf16 v[136:139], a[176:179], a[104:107], v[136:139]
    ds_read_b64_tr_b16 a[174:175], v12 offset:9024
    v_mfma_f32_16x16x32_bf16 v[200:203], a[180:183], a[104:107], v[200:203]
    v_exp_f32 v49, v49
    v_mfma_f32_16x16x32_bf16 v[204:207], a[180:183], a[108:111], v[204:207]
    v_exp_f32 v50, v50
    v_mfma_f32_16x16x32_bf16 v[140:143], a[176:179], a[108:111], v[140:143]
    s_waitcnt lgkmcnt(4)
    v_cos_f32 v24, v51
    v_mfma_f32_16x16x32_bf16 v[156:159], a[160:163], a[108:111], v[156:159]
    ds_read_b64_tr_b16 a[176:177], v12 offset:96
    v_mfma_f32_16x16x32_bf16 v[220:223], a[164:167], a[108:111], v[220:223]
    ds_read_b64_tr_b16 a[178:179], v12 offset:1888
    v_mfma_f32_16x16x32_bf16 v[216:219], a[164:167], a[104:107], v[216:219]
    buffer_load_dwordx4 v6, s[4:7], s56 offen offset:3072  lds
    v_mfma_f32_16x16x32_bf16 v[152:155], a[160:163], a[104:107], v[152:155]
    ds_read_b64_tr_b16 a[180:181], v12 offset:7264
    v_mfma_f32_16x16x32_bf16 v[148:151], a[160:163], a[100:103], v[148:151]
    ds_read_b64_tr_b16 a[182:183], v12 offset:9056
    v_mfma_f32_16x16x32_bf16 v[212:215], a[164:167], a[100:103], v[212:215]
    v_sin_f32 v25, v51
    v_mfma_f32_16x16x32_bf16 v[208:211], a[164:167], a[96:99], v[208:211]
    v_cos_f32 v36, v52
    v_mfma_f32_16x16x32_bf16 v[144:147], a[160:163], a[96:99], v[144:147]
    s_waitcnt lgkmcnt(4)
    v_sin_f32 v37, v52
    v_mfma_f32_16x16x32_bf16 v[160:163], a[168:171], a[96:99], v[160:163]
    ds_read_b64_tr_b16 a[160:161], v12 offset:128
    v_mul_f32 v24, v24, v49
    v_mfma_f32_16x16x32_bf16 v[224:227], a[172:175], a[96:99], v[224:227]
    s_add_u32 m0, s63, 4096
    ds_read_b64_tr_b16 a[162:163], v12 offset:1920
    v_mul_f32 v25, v25, v49
    v_mfma_f32_16x16x32_bf16 v[228:231], a[172:175], a[100:103], v[228:231]
    buffer_load_dwordx4 v7, s[4:7], s56 offen offset:0  lds
    v_mfma_f32_16x16x32_bf16 v[164:167], a[168:171], a[100:103], v[164:167]
    ds_read_b64_tr_b16 a[164:165], v12 offset:7296
    v_mul_f32 v36, v36, v50
    v_mfma_f32_16x16x32_bf16 v[168:171], a[168:171], a[104:107], v[168:171]
    ds_read_b64_tr_b16 a[166:167], v12 offset:9088
    v_mul_f32 v37, v37, v50
    v_mfma_f32_16x16x32_bf16 v[232:235], a[172:175], a[104:107], v[232:235]
    v_mul_f32 v55, 0x41800000, v48
    v_mul_f32 v49, v55, v44
    v_mfma_f32_16x16x32_bf16 v[236:239], a[172:175], a[108:111], v[236:239]
    v_mul_f32 v51, v55, v46
    v_mul_f32 v50, v55, v45
    v_mfma_f32_16x16x32_bf16 v[172:175], a[168:171], a[108:111], v[172:175]
    s_waitcnt lgkmcnt(4)
    v_mul_f32 v52, v55, v47
    v_rndne_f32 v53, v51
    v_mfma_f32_16x16x32_bf16 v[188:191], a[176:179], a[108:111], v[188:191]
    ds_read_b64_tr_b16 a[168:169], v12 offset:160
    v_rndne_f32 v54, v52
    v_mfma_f32_16x16x32_bf16 v[252:255], a[180:183], a[108:111], v[252:255]
    ds_read_b64_tr_b16 a[170:171], v12 offset:1952
    v_sub_f32 v51, v51, v53
    v_mfma_f32_16x16x32_bf16 v[248:251], a[180:183], a[104:107], v[248:251]
    buffer_load_dwordx4 v8, s[4:7], s56 offen offset:1024  lds
    v_mfma_f32_16x16x32_bf16 v[184:187], a[176:179], a[104:107], v[184:187]
    ds_read_b64_tr_b16 a[172:173], v12 offset:7328
    v_sub_f32 v52, v52, v54
    v_mfma_f32_16x16x32_bf16 v[180:183], a[176:179], a[100:103], v[180:183]
    ds_read_b64_tr_b16 a[174:175], v12 offset:9120
    v_mfma_f32_16x16x32_bf16 v[244:247], a[180:183], a[100:103], v[244:247]
    v_exp_f32 v49, v49
    v_mfma_f32_16x16x32_bf16 v[240:243], a[180:183], a[96:99], v[240:243]
    v_exp_f32 v50, v50
    v_mfma_f32_16x16x32_bf16 v[176:179], a[176:179], a[96:99], v[176:179]
    s_waitcnt lgkmcnt(4)
    v_cos_f32 v26, v51
    v_mfma_f32_16x16x32_bf16 a[0:3], a[160:163], a[96:99], a[0:3]
    ds_read_b64_tr_b16 a[176:177], v13 offset:0
    v_mfma_f32_16x16x32_bf16 a[48:51], a[164:167], a[96:99], a[48:51]
    ds_read_b64_tr_b16 a[178:179], v13 offset:1792
    v_mfma_f32_16x16x32_bf16 a[52:55], a[164:167], a[100:103], a[52:55]
    buffer_load_dwordx4 v9, s[4:7], s56 offen offset:2048  lds
    v_mfma_f32_16x16x32_bf16 a[4:7], a[160:163], a[100:103], a[4:7]
    ds_read_b64_tr_b16 a[180:181], v13 offset:7168
    v_mfma_f32_16x16x32_bf16 a[8:11], a[160:163], a[104:107], a[8:11]
    ds_read_b64_tr_b16 a[182:183], v13 offset:8960
    v_mfma_f32_16x16x32_bf16 a[56:59], a[164:167], a[104:107], a[56:59]
    v_sin_f32 v27, v51
    v_mfma_f32_16x16x32_bf16 a[60:63], a[164:167], a[108:111], a[60:63]
    s_waitcnt vmcnt(18)
    ds_read_b128 a[128:131], v18 offset:0
    v_mfma_f32_16x16x32_bf16 a[12:15], a[160:163], a[108:111], a[12:15]
    s_waitcnt lgkmcnt(5)
    v_cos_f32 v38, v52
    v_mfma_f32_16x16x32_bf16 a[28:31], a[168:171], a[108:111], a[28:31]
    s_mov_b32 m0, s64
    ds_read_b128 a[160:163], v15 offset:14336
    v_mfma_f32_16x16x32_bf16 a[76:79], a[172:175], a[108:111], a[76:79]
    buffer_load_dwordx4 v10, s[8:11], s57 offen offset:0  lds
    v_mfma_f32_16x16x32_bf16 a[72:75], a[172:175], a[104:107], a[72:75]
    ds_read_b128 a[144:147], v19 offset:0
    v_mfma_f32_16x16x32_bf16 a[24:27], a[168:171], a[104:107], a[24:27]
    ds_read_b128 a[164:167], v15 offset:18432
    v_mfma_f32_16x16x32_bf16 a[20:23], a[168:171], a[100:103], a[20:23]
    ds_read_b128 a[132:135], v18 offset:2048
    v_mfma_f32_16x16x32_bf16 a[68:71], a[172:175], a[100:103], a[68:71]
    v_sin_f32 v39, v52
    v_mfma_f32_16x16x32_bf16 a[64:67], a[172:175], a[96:99], a[64:67]
    ds_read_b128 a[148:151], v19 offset:2048
    v_mul_f32 v26, v26, v49
    v_mfma_f32_16x16x32_bf16 a[16:19], a[168:171], a[96:99], a[16:19]
    s_waitcnt lgkmcnt(6)
    buffer_load_dwordx4 v11, s[8:11], s57 offen offset:1024  lds
    v_mfma_f32_16x16x32_bf16 a[32:35], a[176:179], a[96:99], a[32:35]
    s_add_u32 s56, s56, 458752
    ds_read_b128 a[168:171], v15 offset:16384
    v_mul_f32 v27, v27, v49
    v_mfma_f32_16x16x32_bf16 a[80:83], a[180:183], a[96:99], a[80:83]
    s_add_u32 s57, s57, 128
    v_mul_f32 v38, v38, v50
    v_mul_f32 v39, v39, v50
    v_mfma_f32_16x16x32_bf16 a[84:87], a[180:183], a[100:103], a[84:87]
    s_add_u32 s62, s62, 22528
    v_mul_f32 v55, 0x44000000, v48
    v_mul_f32 v49, v55, v44
    v_mfma_f32_16x16x32_bf16 a[36:39], a[176:179], a[100:103], a[36:39]
    s_cmp_eq_u32 s62, 45056
    s_cselect_b32 s62, 102400, s62
    ds_read_b128 a[172:175], v15 offset:20480
    v_mfma_f32_16x16x32_bf16 a[40:43], a[176:179], a[104:107], a[40:43]
    s_cmp_eq_u32 s62, 124928
    s_cselect_b32 s62, 0, s62
    v_mul_f32 v51, v55, v46
    v_mfma_f32_16x16x32_bf16 a[88:91], a[180:183], a[104:107], a[88:91]
    s_add_u32 s12, s12, 14336
    v_mul_f32 v50, v55, v45
    v_mul_f32 v52, v55, v47
    v_mfma_f32_16x16x32_bf16 a[92:95], a[180:183], a[108:111], a[92:95]
    s_cmp_eq_u32 s12, 102400
    s_cselect_b32 s12, 45056, s12
    v_rndne_f32 v53, v51
    v_mfma_f32_16x16x32_bf16 a[44:47], a[176:179], a[108:111], a[44:47]
    s_waitcnt lgkmcnt(4)
    v_rndne_f32 v54, v52
    v_sub_f32 v51, v51, v53
    v_mfma_f32_16x16x32_bf16 v[112:115], a[124:127], a[160:163], v[112:115]
    s_bitcmp1_b32 s48, 0
    s_cselect_b32 s63, s12, s62
    ds_read_b64_tr_b16 a[176:177], v16 offset:0
    v_mfma_f32_16x16x32_bf16 v[116:119], a[124:127], a[164:167], v[116:119]
    s_add_u32 s63, s63, s60
    ds_read_b64_tr_b16 a[178:179], v16 offset:1792
    v_sub_f32 v52, v52, v54
    v_mfma_f32_16x16x32_bf16 v[100:103], a[120:123], a[164:167], v[100:103]
    s_add_u32 s64, s61, s62
    v_exp_f32 v49, v49
    v_mfma_f32_16x16x32_bf16 v[96:99], a[120:123], a[160:163], v[96:99]
    s_lshl_b32 s81, s53, 2
    s_lshl_b32 s60, s48, 13
    ds_read_b64_tr_b16 a[180:181], v16 offset:7168
    v_mfma_f32_16x16x32_bf16 v[80:83], a[116:119], a[160:163], v[80:83]
    s_add_u32 s14, s65, 22528
    ds_read_b64_tr_b16 a[182:183], v16 offset:8960
    v_lshrrev_b32 v62, 4, v1
    v_mfma_f32_16x16x32_bf16 v[84:87], a[116:119], a[164:167], v[84:87]
    s_cmp_eq_u32 s14, 45056
    s_cselect_b32 s14, 102400, s14
    v_and_b32 v63, 15, v1
    v_mfma_f32_16x16x32_bf16 v[68:71], a[112:115], a[164:167], v[68:71]
    s_cmp_eq_u32 s14, 124928
    s_cselect_b32 s14, 0, s14
    v_add_u32 v11, 0, v62
    v_mfma_f32_16x16x32_bf16 v[64:67], a[112:115], a[160:163], v[64:67]
    s_waitcnt lgkmcnt(4)
    v_lshlrev_b32 v10, 1, v11
    v_xor_b32 v10, v10, v63
    v_mfma_f32_16x16x32_bf16 v[72:75], a[112:115], a[168:171], v[72:75]
    s_sub_u32 s65, s14, s65
    ds_read_b64_tr_b16 a[160:161], v16 offset:32
    v_add_u32 v12, s65, v12
    v_mfma_f32_16x16x32_bf16 v[76:79], a[112:115], a[172:175], v[76:79]
    ds_read_b64_tr_b16 a[162:163], v16 offset:1824
    v_add_u32 v13, s65, v13
    v_mfma_f32_16x16x32_bf16 v[92:95], a[116:119], a[172:175], v[92:95]
    v_add_u32 v14, s65, v14
    v_add_u32 v15, s65, v15
    v_mfma_f32_16x16x32_bf16 v[88:91], a[116:119], a[168:171], v[88:91]
    s_mov_b32 s65, s14
    ds_read_b64_tr_b16 a[164:165], v16 offset:7200
    v_add_u32 v10, s81, v10
    v_mfma_f32_16x16x32_bf16 v[104:107], a[120:123], a[168:171], v[104:107]
    s_add_u32 s14, s13, 14336
    ds_read_b64_tr_b16 a[166:167], v16 offset:8992
    v_and_b32 v10, 15, v10
    v_mfma_f32_16x16x32_bf16 v[108:111], a[120:123], a[172:175], v[108:111]
    s_cmp_eq_u32 s14, 102400
    s_cselect_b32 s14, 45056, s14
    v_lshlrev_b32 v10, 4, v10
    v_mfma_f32_16x16x32_bf16 v[124:127], a[124:127], a[172:175], v[124:127]
    s_sub_u32 s15, s14, s13
    s_waitcnt vmcnt(11)
    ds_read_b128 a[136:139], v18 offset:4096
    v_mfma_f32_16x16x32_bf16 v[120:123], a[124:127], a[168:171], v[120:123]
    s_waitcnt lgkmcnt(5)
    v_lshl_add_u32 v3, v11, 11, v10
    v_add_u32 v11, 4, v62
    v_mfma_f32_16x16x32_bf16 v[140:143], a[176:179], a[124:127], v[140:143]
    s_mov_b32 s13, s14
    ds_read_b64_tr_b16 a[168:169], v16 offset:64
    v_lshlrev_b32 v10, 1, v11
    v_mfma_f32_16x16x32_bf16 v[204:207], a[180:183], a[124:127], v[204:207]
    ds_read_b64_tr_b16 a[170:171], v16 offset:1856
    v_xor_b32 v10, v10, v63
    v_mfma_f32_16x16x32_bf16 v[200:203], a[180:183], a[120:123], v[200:203]
    ds_read_b128 a[152:155], v19 offset:4096
    v_add_u32 v10, s81, v10
    v_mfma_f32_16x16x32_bf16 v[136:139], a[176:179], a[120:123], v[136:139]
    ds_read_b64_tr_b16 a[172:173], v16 offset:7232
    v_and_b32 v10, 15, v10
    v_mfma_f32_16x16x32_bf16 v[132:135], a[176:179], a[116:119], v[132:135]
    ds_read_b64_tr_b16 a[174:175], v16 offset:9024
    v_lshlrev_b32 v10, 4, v10
    v_mfma_f32_16x16x32_bf16 v[196:199], a[180:183], a[116:119], v[196:199]
    ds_read_b128 a[140:143], v18 offset:6144
    v_lshl_add_u32 v4, v11, 11, v10
    v_mfma_f32_16x16x32_bf16 v[192:195], a[180:183], a[112:115], v[192:195]
    v_add_u32 v10, 0xb400, v4
    v_add_u32 v9, 0xb800, v3
    v_mfma_f32_16x16x32_bf16 v[128:131], a[176:179], a[112:115], v[128:131]
    s_waitcnt lgkmcnt(7)
    ds_read_b128 a[156:159], v19 offset:6144
    v_add_u32 v8, 0x7c00, v4
    v_mfma_f32_16x16x32_bf16 v[144:147], a[160:163], a[112:115], v[144:147]
    ds_read_b64_tr_b16 a[176:177], v16 offset:96
    v_add_u32 v7, 0x8000, v3
    v_mfma_f32_16x16x32_bf16 v[208:211], a[164:167], a[112:115], v[208:211]
    ds_read_b64_tr_b16 a[178:179], v16 offset:1888
    v_add_u32 v6, 0x3400, v4
    v_mfma_f32_16x16x32_bf16 v[212:215], a[164:167], a[116:119], v[212:215]
    v_add_u32 v5, 0x3800, v3
    v_add_u32 v4, 0xfffffc00, v4
    v_mfma_f32_16x16x32_bf16 v[148:151], a[160:163], a[116:119], v[148:151]
    s_lshl_b32 s56, s54, 2
    s_add_u32 s56, s56, s53
    ds_read_b64_tr_b16 a[180:181], v16 offset:7264
    v_mfma_f32_16x16x32_bf16 v[152:155], a[160:163], a[120:123], v[152:155]
    s_lshl_b32 s82, s56, 6
    s_lshl_b32 s81, s49, 17
    ds_read_b64_tr_b16 a[182:183], v16 offset:9056
    v_mfma_f32_16x16x32_bf16 v[216:219], a[164:167], a[120:123], v[216:219]
    s_add_u32 s81, s81, s82
    s_add_u32 m0, s78, 4096
    v_lshrrev_b32 v62, 2, v1
    v_mfma_f32_16x16x32_bf16 v[220:223], a[164:167], a[124:127], v[220:223]
    v_and_b32 v63, 3, v1
    v_lshlrev_b32 v63, 4, v63
    v_mfma_f32_16x16x32_bf16 v[156:159], a[160:163], a[124:127], v[156:159]
    s_waitcnt lgkmcnt(6)
    v_lshl_add_u32 v62, v62, 13, v63
    v_mfma_f32_16x16x32_bf16 v[172:175], a[168:171], a[124:127], v[172:175]
    ds_read_b64_tr_b16 a[160:161], v16 offset:128
    v_mfma_f32_16x16x32_bf16 v[236:239], a[172:175], a[124:127], v[236:239]
    ds_read_b64_tr_b16 a[162:163], v16 offset:1920
    v_mfma_f32_16x16x32_bf16 v[232:235], a[172:175], a[120:123], v[232:235]
    s_waitcnt lgkmcnt(6)
    buffer_load_dwordx4 v62, s[44:47], s81 offen offset:0 lds
    v_mfma_f32_16x16x32_bf16 v[168:171], a[168:171], a[120:123], v[168:171]
    s_add_u32 s81, s81, 1024
    ds_read_b64_tr_b16 a[164:165], v16 offset:7296
    v_mfma_f32_16x16x32_bf16 v[164:167], a[168:171], a[116:119], v[164:167]
    ds_read_b64_tr_b16 a[166:167], v16 offset:9088
    v_mfma_f32_16x16x32_bf16 v[228:231], a[172:175], a[116:119], v[228:231]
    buffer_load_dwordx4 v62, s[44:47], s81 offen offset:1024 lds
    v_mfma_f32_16x16x32_bf16 v[224:227], a[172:175], a[112:115], v[224:227]
    s_add_u32 s81, s81, 1024
    buffer_load_dwordx4 v62, s[44:47], s81 offen offset:2048 lds
    v_mfma_f32_16x16x32_bf16 v[160:163], a[168:171], a[112:115], v[160:163]
    s_add_u32 s81, s81, 1024
    s_waitcnt lgkmcnt(4)
    v_mfma_f32_16x16x32_bf16 v[176:179], a[176:179], a[112:115], v[176:179]
    ds_read_b64_tr_b16 a[168:169], v16 offset:160
    v_mfma_f32_16x16x32_bf16 v[240:243], a[180:183], a[112:115], v[240:243]
    ds_read_b64_tr_b16 a[170:171], v16 offset:1952
    v_mfma_f32_16x16x32_bf16 v[244:247], a[180:183], a[116:119], v[244:247]
    buffer_load_dwordx4 v62, s[44:47], s81 offen offset:3072 lds
    v_mfma_f32_16x16x32_bf16 v[180:183], a[176:179], a[116:119], v[180:183]
    s_add_u32 s81, s81, 1024
    ds_read_b64_tr_b16 a[172:173], v16 offset:7328
    v_mfma_f32_16x16x32_bf16 v[184:187], a[176:179], a[120:123], v[184:187]
    s_mov_b32 s44, s0
    s_mov_b32 s45, s1
    ds_read_b64_tr_b16 a[174:175], v16 offset:9120
    v_mfma_f32_16x16x32_bf16 v[248:251], a[180:183], a[120:123], v[248:251]
    s_mov_b32 s46, 0x800
    s_mov_b32 s47, 0x20000
    s_lshl_b32 s82, s56, 6
    v_mfma_f32_16x16x32_bf16 v[252:255], a[180:183], a[124:127], v[252:255]
    v_lshrrev_b32 v63, 4, v1
    v_lshlrev_b32 v63, 3, v63
    v_mfma_f32_16x16x32_bf16 v[188:191], a[176:179], a[124:127], v[188:191]
    s_waitcnt lgkmcnt(4)
    buffer_load_dwordx2 a[224:225], v63, s[44:47], s82 offen offset:0
    v_mfma_f32_16x16x32_bf16 a[12:15], a[160:163], a[124:127], a[12:15]
    ds_read_b64_tr_b16 a[176:177], v17 offset:0
    v_mfma_f32_16x16x32_bf16 a[60:63], a[164:167], a[124:127], a[60:63]
    ds_read_b64_tr_b16 a[178:179], v17 offset:1792
    v_mfma_f32_16x16x32_bf16 a[56:59], a[164:167], a[120:123], a[56:59]
    buffer_load_dwordx2 a[226:227], v63, s[44:47], s82 offen offset:32
    v_mfma_f32_16x16x32_bf16 a[8:11], a[160:163], a[120:123], a[8:11]
    s_lshl_b32 s61, s49, 2
    s_add_u32 s61, s61, s53
    ds_read_b64_tr_b16 a[180:181], v17 offset:7168
    v_mfma_f32_16x16x32_bf16 a[4:7], a[160:163], a[116:119], a[4:7]
    s_lshl_b32 s61, s61, 7
    s_add_u32 s61, s61, 458752
    ds_read_b64_tr_b16 a[182:183], v17 offset:8960
    v_mfma_f32_16x16x32_bf16 a[52:55], a[164:167], a[116:119], a[52:55]
    s_lshl_b32 s81, s55, 2
    s_add_u32 s81, s81, s53
    s_lshl_b32 s81, s81, 2
    v_mfma_f32_16x16x32_bf16 a[48:51], a[164:167], a[112:115], a[48:51]
    s_add_u32 s81, s81, s48
    s_lshl_b32 s81, s81, 7
    s_add_u32 s81, s81, 327680
    v_mfma_f32_16x16x32_bf16 a[0:3], a[160:163], a[112:115], a[0:3]
    s_waitcnt vmcnt(6) lgkmcnt(4)
    s_barrier
    v_mfma_f32_16x16x32_bf16 a[16:19], a[168:171], a[112:115], a[16:19]
    ds_read_b128 a[160:163], v14 offset:14336
    v_add_u32 v16, s15, v16
    v_mfma_f32_16x16x32_bf16 a[64:67], a[172:175], a[112:115], a[64:67]
    v_add_u32 v17, s15, v17
    v_mfma_f32_16x16x32_bf16 a[68:71], a[172:175], a[116:119], a[68:71]
    buffer_load_dword v0, v63, s[36:39], s61 offen sc1
    v_mfma_f32_16x16x32_bf16 a[20:23], a[168:171], a[116:119], a[20:23]
    ds_read_b128 a[164:167], v14 offset:18432
    v_mfma_f32_16x16x32_bf16 a[24:27], a[168:171], a[120:123], a[24:27]
    buffer_load_dword v0, v63, s[36:39], s81 offen sc1
    v_mfma_f32_16x16x32_bf16 a[72:75], a[172:175], a[120:123], a[72:75]
    v_and_b32 v62, 3, v1
    v_bfe_u32 v63, v1, 2, 2
    v_mfma_f32_16x16x32_bf16 a[76:79], a[172:175], a[124:127], a[76:79]
    v_sub_u32 v62, v62, v63
    v_mul_i32_i24 v62, 24, v62
    v_mfma_f32_16x16x32_bf16 a[28:31], a[168:171], a[124:127], a[28:31]
    s_waitcnt lgkmcnt(2)
    v_lshl_add_u32 v63, v1, 3, s78
    v_add_u32 v62, v62, v63
    v_mfma_f32_16x16x32_bf16 a[44:47], a[176:179], a[124:127], a[44:47]
    ds_read_b128 a[168:171], v14 offset:16384
    v_mfma_f32_16x16x32_bf16 a[92:95], a[180:183], a[124:127], a[92:95]
    ds_write_b64 v63, a[206:207] offset:1024
    v_mfma_f32_16x16x32_bf16 a[88:91], a[180:183], a[120:123], a[88:91]
    ds_write_b64 v62, a[206:207] offset:1536
    v_mfma_f32_16x16x32_bf16 a[40:43], a[176:179], a[120:123], a[40:43]
    ds_read_b128 a[172:175], v14 offset:20480
    v_min_u32 v62, 55, v1
    v_mfma_f32_16x16x32_bf16 a[36:39], a[176:179], a[116:119], a[36:39]
    v_cmp_lt_u32 vcc, 27, v62
    v_lshlrev_b32 v62, 4, v62
    v_mfma_f32_16x16x32_bf16 a[84:87], a[180:183], a[116:119], a[84:87]
    v_mov_b32 v63, 13888
    v_cndmask_b32 v63, 0, v63, vcc
    v_mfma_f32_16x16x32_bf16 a[80:83], a[180:183], a[112:115], a[80:83]
    v_add_u32 v62, v62, v63
    v_add_u32 v63, s78, v2
    v_mfma_f32_16x16x32_bf16 a[32:35], a[176:179], a[112:115], a[32:35]
    s_mul_i32 s81, s50, 448
    s_add_u32 s81, s81, 589824
    s_waitcnt lgkmcnt(4)
    v_mfma_f32_16x16x32_bf16 v[64:67], a[128:131], a[160:163], v[64:67]
    ds_read_b64_tr_b16 a[176:177], v12 offset:0
    v_mfma_f32_16x16x32_bf16 v[68:71], a[128:131], a[164:167], v[68:71]
    ds_read_b64_tr_b16 a[178:179], v12 offset:1792
    v_mfma_f32_16x16x32_bf16 v[84:87], a[132:135], a[164:167], v[84:87]
    buffer_load_dwordx4 a[184:187], v62, s[36:39], s81 offen sc1
    v_mfma_f32_16x16x32_bf16 v[80:83], a[132:135], a[160:163], v[80:83]
    s_add_u32 s81, s81, 28672
    ds_read_b64_tr_b16 a[180:181], v12 offset:7168
    v_mfma_f32_16x16x32_bf16 v[96:99], a[136:139], a[160:163], v[96:99]
    s_add_u32 m0, s60, 0
    ds_read_b64_tr_b16 a[182:183], v12 offset:8960
    v_mfma_f32_16x16x32_bf16 v[100:103], a[136:139], a[164:167], v[100:103]
    buffer_load_dwordx4 v3, s[24:27], s71 offen offset:0  lds
    v_mfma_f32_16x16x32_bf16 v[116:119], a[140:143], a[164:167], v[116:119]
    buffer_load_dwordx4 a[188:191], v62, s[36:39], s81 offen sc1
    v_mfma_f32_16x16x32_bf16 v[112:115], a[140:143], a[160:163], v[112:115]
    s_add_u32 s81, s81, 28672
    s_waitcnt lgkmcnt(4)
    v_mfma_f32_16x16x32_bf16 v[120:123], a[140:143], a[168:171], v[120:123]
    ds_read_b64_tr_b16 a[160:161], v12 offset:32
    v_mfma_f32_16x16x32_bf16 v[124:127], a[140:143], a[172:175], v[124:127]
    ds_read_b64_tr_b16 a[162:163], v12 offset:1824
    v_mfma_f32_16x16x32_bf16 v[108:111], a[136:139], a[172:175], v[108:111]
    buffer_load_dwordx4 v4, s[24:27], s71 offen offset:1024  lds
    v_mfma_f32_16x16x32_bf16 v[104:107], a[136:139], a[168:171], v[104:107]
    ds_read_b64_tr_b16 a[164:165], v12 offset:7200
    v_mfma_f32_16x16x32_bf16 v[88:91], a[132:135], a[168:171], v[88:91]
    ds_read_b64_tr_b16 a[166:167], v12 offset:8992
    v_mfma_f32_16x16x32_bf16 v[92:95], a[132:135], a[172:175], v[92:95]
    buffer_load_dwordx4 a[192:195], v62, s[36:39], s81 offen sc1
    v_mfma_f32_16x16x32_bf16 v[76:79], a[128:131], a[172:175], v[76:79]
    s_add_u32 s81, s81, 28672
    buffer_load_dwordx4 a[196:199], v62, s[36:39], s81 offen sc1
    v_mfma_f32_16x16x32_bf16 v[72:75], a[128:131], a[168:171], v[72:75]
    s_waitcnt lgkmcnt(4)
    buffer_load_dwordx4 v5, s[24:27], s71 offen offset:2048  lds
    v_mfma_f32_16x16x32_bf16 v[128:131], a[176:179], a[128:131], v[128:131]
    s_add_u32 s81, s81, 28672
    ds_read_b64_tr_b16 a[168:169], v12 offset:64
    v_mfma_f32_16x16x32_bf16 v[192:195], a[180:183], a[128:131], v[192:195]
    ds_read_b64_tr_b16 a[170:171], v12 offset:1856
    v_mfma_f32_16x16x32_bf16 v[196:199], a[180:183], a[132:135], v[196:199]
    buffer_load_dwordx4 a[228:231], v62, s[36:39], s81 offen sc1
    v_mfma_f32_16x16x32_bf16 v[132:135], a[176:179], a[132:135], v[132:135]
    s_add_u32 s81, s81, 28672
    ds_read_b64_tr_b16 a[172:173], v12 offset:7232
    v_mfma_f32_16x16x32_bf16 v[136:139], a[176:179], a[136:139], v[136:139]
    ds_read_b64_tr_b16 a[174:175], v12 offset:9024
    v_mfma_f32_16x16x32_bf16 v[200:203], a[180:183], a[136:139], v[200:203]
    buffer_load_dwordx4 v6, s[24:27], s71 offen offset:3072  lds
    v_mfma_f32_16x16x32_bf16 v[204:207], a[180:183], a[140:143], v[204:207]
    buffer_load_dwordx4 a[232:235], v62, s[36:39], s81 offen sc1
    v_mfma_f32_16x16x32_bf16 v[140:143], a[176:179], a[140:143], v[140:143]
    s_add_u32 s81, s81, 28672
    s_waitcnt lgkmcnt(4)
    v_mfma_f32_16x16x32_bf16 v[156:159], a[160:163], a[140:143], v[156:159]
    ds_read_b64_tr_b16 a[176:177], v12 offset:96
    v_mfma_f32_16x16x32_bf16 v[220:223], a[164:167], a[140:143], v[220:223]
    s_add_u32 m0, s60, 4096
    ds_read_b64_tr_b16 a[178:179], v12 offset:1888
    v_mfma_f32_16x16x32_bf16 v[216:219], a[164:167], a[136:139], v[216:219]
    buffer_load_dwordx4 v7, s[24:27], s71 offen offset:0  lds
    v_mfma_f32_16x16x32_bf16 v[152:155], a[160:163], a[136:139], v[152:155]
    ds_read_b64_tr_b16 a[180:181], v12 offset:7264
    v_mfma_f32_16x16x32_bf16 v[148:151], a[160:163], a[132:135], v[148:151]
    ds_read_b64_tr_b16 a[182:183], v12 offset:9056
    v_mfma_f32_16x16x32_bf16 v[212:215], a[164:167], a[132:135], v[212:215]
    buffer_load_dwordx4 a[236:239], v62, s[36:39], s81 offen sc1
    v_mfma_f32_16x16x32_bf16 v[208:211], a[164:167], a[128:131], v[208:211]
    s_add_u32 s81, s81, 28672
    buffer_load_dwordx4 a[240:243], v62, s[36:39], s81 offen sc1
    v_mfma_f32_16x16x32_bf16 v[144:147], a[160:163], a[128:131], v[144:147]
    s_waitcnt lgkmcnt(4)
    buffer_load_dwordx4 v8, s[24:27], s71 offen offset:1024  lds
    v_mfma_f32_16x16x32_bf16 v[160:163], a[168:171], a[128:131], v[160:163]
    ds_read_b64_tr_b16 a[160:161], v12 offset:128
    v_mfma_f32_16x16x32_bf16 v[224:227], a[172:175], a[128:131], v[224:227]
    ds_read_b64_tr_b16 a[162:163], v12 offset:1920
    v_mfma_f32_16x16x32_bf16 v[228:231], a[172:175], a[132:135], v[228:231]
LF_pad5:
    s_cbranch_execz LF_pad9
    v_exp_f32 v50, v50
    v_mfma_f32_16x16x32_bf16 v[164:167], a[168:171], a[132:135], v[164:167]
    ds_read_b64_tr_b16 a[164:165], v12 offset:7296
    v_mfma_f32_16x16x32_bf16 v[168:171], a[168:171], a[136:139], v[168:171]
    ds_read_b64_tr_b16 a[166:167], v12 offset:9088
    v_mfma_f32_16x16x32_bf16 v[232:235], a[172:175], a[136:139], v[232:235]
    buffer_load_dwordx4 v9, s[24:27], s71 offen offset:2048  lds
    v_mfma_f32_16x16x32_bf16 v[236:239], a[172:175], a[140:143], v[236:239]
    v_cos_f32 v28, v51
    v_mfma_f32_16x16x32_bf16 v[172:175], a[168:171], a[140:143], v[172:175]
    s_waitcnt lgkmcnt(4)
    v_sin_f32 v29, v51
    v_mfma_f32_16x16x32_bf16 v[188:191], a[176:179], a[140:143], v[188:191]
    ds_read_b64_tr_b16 a[168:169], v12 offset:160
    v_mfma_f32_16x16x32_bf16 v[252:255], a[180:183], a[140:143], v[252:255]
    ds_read_b64_tr_b16 a[170:171], v12 offset:1952
    v_mfma_f32_16x16x32_bf16 v[248:251], a[180:183], a[136:139], v[248:251]
    buffer_load_dwordx4 v10, s[24:27], s71 offen offset:3072  lds
    v_mfma_f32_16x16x32_bf16 v[184:187], a[176:179], a[136:139], v[184:187]
    s_add_u32 s3, s3, 4
    s_add_u32 s88, s3, 3
    ds_read_b64_tr_b16 a[172:173], v12 offset:7328
    v_mfma_f32_16x16x32_bf16 v[180:183], a[176:179], a[132:135], v[180:183]
    s_cmp_ge_u32 s3, s72
    s_cselect_b32 s71, s88, s3
    ds_read_b64_tr_b16 a[174:175], v12 offset:9120
    v_mfma_f32_16x16x32_bf16 v[244:247], a[180:183], a[132:135], v[244:247]
    s_add_u32 s88, s71, 3
    s_mul_i32 s88, s88, 43
    s_lshr_b32 s88, s88, 8
    v_mfma_f32_16x16x32_bf16 v[240:243], a[180:183], a[128:131], v[240:243]
    s_add_u32 s71, s71, s88
    s_lshl_b32 s71, s71, 16
    s_add_u32 s71, s71, s89
    v_mfma_f32_16x16x32_bf16 v[176:179], a[176:179], a[128:131], v[176:179]
    s_waitcnt lgkmcnt(4)
    v_cos_f32 v40, v52
    v_mfma_f32_16x16x32_bf16 a[0:3], a[160:163], a[128:131], a[0:3]
    ds_read_b64_tr_b16 a[176:177], v13 offset:0
    v_mfma_f32_16x16x32_bf16 a[48:51], a[164:167], a[128:131], a[48:51]
    ds_read_b64_tr_b16 a[178:179], v13 offset:1792
    v_mfma_f32_16x16x32_bf16 a[52:55], a[164:167], a[132:135], a[52:55]
    v_sin_f32 v41, v52
    v_mfma_f32_16x16x32_bf16 a[4:7], a[160:163], a[132:135], a[4:7]
    ds_read_b64_tr_b16 a[180:181], v13 offset:7168
    v_mul_f32 v28, v28, v49
    v_mfma_f32_16x16x32_bf16 a[8:11], a[160:163], a[136:139], a[8:11]
    s_add_u32 m0, s60, 32768
    ds_read_b64_tr_b16 a[182:183], v13 offset:8960
    v_mul_f32 v29, v29, v49
    v_mfma_f32_16x16x32_bf16 a[56:59], a[164:167], a[136:139], a[56:59]
    buffer_load_dwordx4 v3, s[24:27], s71 offen offset:0  lds
    v_mfma_f32_16x16x32_bf16 a[60:63], a[164:167], a[140:143], a[60:63]
    v_mul_f32 v40, v40, v50
    v_mul_f32 v41, v41, v50
    v_mfma_f32_16x16x32_bf16 a[12:15], a[160:163], a[140:143], a[12:15]
    s_waitcnt lgkmcnt(4)
    v_mul_f32 v49, v56, v56
    v_fma_f32 v49, v58, v58, v49
    v_mfma_f32_16x16x32_bf16 a[28:31], a[168:171], a[140:143], a[28:31]
    ds_read_b128 a[160:163], v15 offset:14336
    v_mfma_f32_16x16x32_bf16 a[76:79], a[172:175], a[140:143], a[76:79]
    v_rcp_f32 v49, v49
    v_mfma_f32_16x16x32_bf16 a[72:75], a[172:175], a[136:139], a[72:75]
    buffer_load_dwordx4 v4, s[24:27], s71 offen offset:1024  lds
    v_mfma_f32_16x16x32_bf16 a[24:27], a[168:171], a[136:139], a[24:27]
    ds_read_b128 a[164:167], v15 offset:18432
    v_add_f32 v50, -1.0, v20
    v_mfma_f32_16x16x32_bf16 a[20:23], a[168:171], a[132:135], a[20:23]
    v_mul_f32 v30, v50, v56
    v_fma_f32 v30, v21, v58, v30
    v_mfma_f32_16x16x32_bf16 a[68:71], a[172:175], a[132:135], a[68:71]
    v_mul_f32 v31, v21, v56
    v_fma_f32 v31, -v50, v58, v31
    v_mfma_f32_16x16x32_bf16 a[64:67], a[172:175], a[128:131], a[64:67]
    v_add_f32 v49, v49, v49
    v_mul_f32 v30, v30, v49
    v_mfma_f32_16x16x32_bf16 a[16:19], a[168:171], a[128:131], a[16:19]
    s_waitcnt lgkmcnt(2)
    buffer_load_dwordx4 v5, s[24:27], s71 offen offset:2048  lds
    v_mfma_f32_16x16x32_bf16 a[32:35], a[176:179], a[128:131], a[32:35]
    ds_read_b128 a[168:171], v15 offset:16384
    v_mul_f32 v31, v31, v49
    v_mfma_f32_16x16x32_bf16 a[80:83], a[180:183], a[128:131], a[80:83]
    v_mul_f32 v49, v57, v57
    v_fma_f32 v49, v59, v59, v49
    v_mfma_f32_16x16x32_bf16 a[84:87], a[180:183], a[132:135], a[84:87]
    v_rcp_f32 v49, v49
    v_mfma_f32_16x16x32_bf16 a[36:39], a[176:179], a[132:135], a[36:39]
    ds_read_b128 a[172:175], v15 offset:20480
    v_add_f32 v50, -1.0, v32
    v_mfma_f32_16x16x32_bf16 a[40:43], a[176:179], a[136:139], a[40:43]
    buffer_load_dwordx4 v6, s[24:27], s71 offen offset:3072  lds
    v_mfma_f32_16x16x32_bf16 a[88:91], a[180:183], a[136:139], a[88:91]
    v_mul_f32 v42, v50, v57
    v_fma_f32 v42, v33, v59, v42
    v_mfma_f32_16x16x32_bf16 a[92:95], a[180:183], a[140:143], a[92:95]
    v_mul_f32 v43, v33, v57
    v_fma_f32 v43, -v50, v59, v43
    v_mfma_f32_16x16x32_bf16 a[44:47], a[176:179], a[140:143], a[44:47]
    s_waitcnt lgkmcnt(2)
    v_add_f32 v49, v49, v49
    v_mul_f32 v42, v42, v49
    v_mfma_f32_16x16x32_bf16 v[112:115], a[156:159], a[160:163], v[112:115]
    ds_read_b64_tr_b16 a[176:177], v16 offset:0
    v_mul_f32 v43, v43, v49
    v_mfma_f32_16x16x32_bf16 v[116:119], a[156:159], a[164:167], v[116:119]
    s_add_u32 m0, s60, 36864
    ds_read_b64_tr_b16 a[178:179], v16 offset:1792
    v_mfma_f32_16x16x32_bf16 v[100:103], a[152:155], a[164:167], v[100:103]
    buffer_load_dwordx4 v7, s[24:27], s71 offen offset:0  lds
    v_mfma_f32_16x16x32_bf16 v[96:99], a[152:155], a[160:163], v[96:99]
    ds_read_b64_tr_b16 a[180:181], v16 offset:7168
    v_mfma_f32_16x16x32_bf16 v[80:83], a[148:151], a[160:163], v[80:83]
    ds_read_b64_tr_b16 a[182:183], v16 offset:8960
    v_mfma_f32_16x16x32_bf16 v[84:87], a[148:151], a[164:167], v[84:87]
    v_accvgpr_read_b32 v56, a208
    v_accvgpr_read_b32 v57, a209
    v_mfma_f32_16x16x32_bf16 v[68:71], a[144:147], a[164:167], v[68:71]
    v_accvgpr_read_b32 v58, a210
    v_accvgpr_read_b32 v59, a211
    v_mfma_f32_16x16x32_bf16 v[64:67], a[144:147], a[160:163], v[64:67]
    s_waitcnt lgkmcnt(4)
    buffer_load_dwordx4 v8, s[24:27], s71 offen offset:1024  lds
    v_mfma_f32_16x16x32_bf16 v[72:75], a[144:147], a[168:171], v[72:75]
    ds_read_b64_tr_b16 a[160:161], v16 offset:32
    v_mul_f32 v52, v30, v56
    v_mfma_f32_16x16x32_bf16 v[76:79], a[144:147], a[172:175], v[76:79]
    ds_read_b64_tr_b16 a[162:163], v16 offset:1824
    v_mul_f32 v53, v30, v57
    v_mfma_f32_16x16x32_bf16 v[92:95], a[148:151], a[172:175], v[92:95]
    v_fma_f32 v52, -v31, v57, v52
    v_fmac_f32 v53, v31, v56
    v_mfma_f32_16x16x32_bf16 v[88:91], a[148:151], a[168:171], v[88:91]
    ds_read_b64_tr_b16 a[164:165], v16 offset:7200
    v_mul_f32 v54, v42, v58
    v_mfma_f32_16x16x32_bf16 v[104:107], a[152:155], a[168:171], v[104:107]
    ds_read_b64_tr_b16 a[166:167], v16 offset:8992
    v_mul_f32 v55, v42, v59
    v_mfma_f32_16x16x32_bf16 v[108:111], a[152:155], a[172:175], v[108:111]
    buffer_load_dwordx4 v9, s[24:27], s71 offen offset:2048  lds
    v_mfma_f32_16x16x32_bf16 v[124:127], a[156:159], a[172:175], v[124:127]
    v_fma_f32 v54, -v43, v59, v54
    v_fmac_f32 v55, v43, v58
    v_mfma_f32_16x16x32_bf16 v[120:123], a[156:159], a[168:171], v[120:123]
    s_waitcnt lgkmcnt(4)
    s_waitcnt vmcnt(10)
    v_accvgpr_read_b32 v44, a184
    v_mfma_f32_16x16x32_bf16 v[140:143], a[176:179], a[156:159], v[140:143]
    ds_read_b64_tr_b16 a[168:169], v16 offset:64
    v_accvgpr_read_b32 v45, a185
    v_mfma_f32_16x16x32_bf16 v[204:207], a[180:183], a[156:159], v[204:207]
    ds_read_b64_tr_b16 a[170:171], v16 offset:1856
    v_accvgpr_read_b32 v46, a186
    v_mfma_f32_16x16x32_bf16 v[200:203], a[180:183], a[152:155], v[200:203]
    buffer_load_dwordx4 v10, s[24:27], s71 offen offset:3072  lds
    v_mfma_f32_16x16x32_bf16 v[136:139], a[176:179], a[152:155], v[136:139]
    s_add_u32 s3, s3, 4
    s_add_u32 s88, s3, 3
    ds_read_b64_tr_b16 a[172:173], v16 offset:7232
    v_mfma_f32_16x16x32_bf16 v[132:135], a[176:179], a[148:151], v[132:135]
    s_cmp_ge_u32 s3, s72
    s_cselect_b32 s71, s88, s3
    ds_read_b64_tr_b16 a[174:175], v16 offset:9024
    v_mfma_f32_16x16x32_bf16 v[196:199], a[180:183], a[148:151], v[196:199]
    s_add_u32 s88, s71, 3
    s_mul_i32 s88, s88, 43
    s_lshr_b32 s88, s88, 8
    v_mfma_f32_16x16x32_bf16 v[192:195], a[180:183], a[144:147], v[192:195]
    s_add_u32 s71, s71, s88
    s_lshl_b32 s71, s71, 16
    s_add_u32 s71, s71, s89
    v_mfma_f32_16x16x32_bf16 v[128:131], a[176:179], a[144:147], v[128:131]
    s_waitcnt lgkmcnt(4)
    v_accvgpr_read_b32 v47, a187
    v_accvgpr_read_b32 v48, a188
    v_mfma_f32_16x16x32_bf16 v[144:147], a[160:163], a[144:147], v[144:147]
    ds_read_b64_tr_b16 a[176:177], v16 offset:96
    v_accvgpr_read_b32 v49, a189
    v_mfma_f32_16x16x32_bf16 v[208:211], a[164:167], a[144:147], v[208:211]
    ds_read_b64_tr_b16 a[178:179], v16 offset:1888
    v_accvgpr_read_b32 v50, a190
    v_mfma_f32_16x16x32_bf16 v[212:215], a[164:167], a[148:151], v[212:215]
    v_accvgpr_read_b32 v51, a191
    v_add_f32 v44, v44, v48
    v_mfma_f32_16x16x32_bf16 v[148:151], a[160:163], a[148:151], v[148:151]
    ds_read_b64_tr_b16 a[180:181], v16 offset:7264
    v_add_f32 v45, v45, v49
    v_mfma_f32_16x16x32_bf16 v[152:155], a[160:163], a[152:155], v[152:155]
    ds_read_b64_tr_b16 a[182:183], v16 offset:9056
    v_add_f32 v46, v46, v50
    v_mfma_f32_16x16x32_bf16 v[216:219], a[164:167], a[152:155], v[216:219]
    v_add_f32 v47, v47, v51
    v_accvgpr_read_b32 v48, a192
    v_mfma_f32_16x16x32_bf16 v[220:223], a[164:167], a[156:159], v[220:223]
    v_accvgpr_read_b32 v49, a193
    v_accvgpr_read_b32 v50, a194
    v_mfma_f32_16x16x32_bf16 v[156:159], a[160:163], a[156:159], v[156:159]
    s_waitcnt lgkmcnt(4)
    v_accvgpr_read_b32 v51, a195
    v_add_f32 v44, v44, v48
    v_mfma_f32_16x16x32_bf16 v[172:175], a[168:171], a[156:159], v[172:175]
    ds_read_b64_tr_b16 a[160:161], v16 offset:128
    v_add_f32 v45, v45, v49
    v_mfma_f32_16x16x32_bf16 v[236:239], a[172:175], a[156:159], v[236:239]
    ds_read_b64_tr_b16 a[162:163], v16 offset:1920
    v_add_f32 v46, v46, v50
    v_mfma_f32_16x16x32_bf16 v[232:235], a[172:175], a[152:155], v[232:235]
    v_add_f32 v47, v47, v51
    v_accvgpr_read_b32 v48, a196
    v_mfma_f32_16x16x32_bf16 v[168:171], a[168:171], a[152:155], v[168:171]
    ds_read_b64_tr_b16 a[164:165], v16 offset:7296
    v_accvgpr_read_b32 v49, a197
    v_mfma_f32_16x16x32_bf16 v[164:167], a[168:171], a[148:151], v[164:167]
    ds_read_b64_tr_b16 a[166:167], v16 offset:9088
    v_accvgpr_read_b32 v50, a198
    v_mfma_f32_16x16x32_bf16 v[228:231], a[172:175], a[148:151], v[228:231]
    v_accvgpr_read_b32 v51, a199
    v_add_f32 v44, v44, v48
    v_mfma_f32_16x16x32_bf16 v[224:227], a[172:175], a[144:147], v[224:227]
    v_add_f32 v45, v45, v49
    v_add_f32 v46, v46, v50
    v_mfma_f32_16x16x32_bf16 v[160:163], a[168:171], a[144:147], v[160:163]
    s_waitcnt lgkmcnt(4)
    v_add_f32 v47, v47, v51
    v_accvgpr_read_b32 v48, a228
    v_mfma_f32_16x16x32_bf16 v[176:179], a[176:179], a[144:147], v[176:179]
    ds_read_b64_tr_b16 a[168:169], v16 offset:160
    v_accvgpr_read_b32 v49, a229
    v_mfma_f32_16x16x32_bf16 v[240:243], a[180:183], a[144:147], v[240:243]
    ds_read_b64_tr_b16 a[170:171], v16 offset:1952
    v_accvgpr_read_b32 v50, a230
    v_mfma_f32_16x16x32_bf16 v[244:247], a[180:183], a[148:151], v[244:247]
    v_accvgpr_read_b32 v51, a231
    v_add_f32 v44, v44, v48
    v_mfma_f32_16x16x32_bf16 v[180:183], a[176:179], a[148:151], v[180:183]
    ds_read_b64_tr_b16 a[172:173], v16 offset:7328
    v_add_f32 v45, v45, v49
    v_mfma_f32_16x16x32_bf16 v[184:187], a[176:179], a[152:155], v[184:187]
    ds_read_b64_tr_b16 a[174:175], v16 offset:9120
    v_add_f32 v46, v46, v50
    v_mfma_f32_16x16x32_bf16 v[248:251], a[180:183], a[152:155], v[248:251]
    v_add_f32 v47, v47, v51
    v_accvgpr_read_b32 v48, a232
    v_mfma_f32_16x16x32_bf16 v[252:255], a[180:183], a[156:159], v[252:255]
    v_accvgpr_read_b32 v49, a233
    v_accvgpr_read_b32 v50, a234
    v_mfma_f32_16x16x32_bf16 v[188:191], a[176:179], a[156:159], v[188:191]
    s_waitcnt lgkmcnt(4)
    v_accvgpr_read_b32 v51, a235
    v_add_f32 v44, v44, v48
    v_mfma_f32_16x16x32_bf16 a[12:15], a[160:163], a[156:159], a[12:15]
    ds_read_b64_tr_b16 a[176:177], v17 offset:0
    v_add_f32 v45, v45, v49
    v_mfma_f32_16x16x32_bf16 a[60:63], a[164:167], a[156:159], a[60:63]
    ds_read_b64_tr_b16 a[178:179], v17 offset:1792
    v_add_f32 v46, v46, v50
    v_mfma_f32_16x16x32_bf16 a[56:59], a[164:167], a[152:155], a[56:59]
    v_add_f32 v47, v47, v51
    v_accvgpr_read_b32 v48, a236
    v_mfma_f32_16x16x32_bf16 a[8:11], a[160:163], a[152:155], a[8:11]
    ds_read_b64_tr_b16 a[180:181], v17 offset:7168
    v_accvgpr_read_b32 v49, a237
    v_mfma_f32_16x16x32_bf16 a[4:7], a[160:163], a[148:151], a[4:7]
    ds_read_b64_tr_b16 a[182:183], v17 offset:8960
    v_accvgpr_read_b32 v50, a238
    v_mfma_f32_16x16x32_bf16 a[52:55], a[164:167], a[148:151], a[52:55]
    v_accvgpr_read_b32 v51, a239
    v_add_f32 v44, v44, v48
    v_mfma_f32_16x16x32_bf16 a[48:51], a[164:167], a[144:147], a[48:51]
    v_add_f32 v45, v45, v49
    v_add_f32 v46, v46, v50
    v_mfma_f32_16x16x32_bf16 a[0:3], a[160:163], a[144:147], a[0:3]
    s_waitcnt lgkmcnt(4)
    v_add_f32 v47, v47, v51
    v_accvgpr_read_b32 v48, a240
    v_mfma_f32_16x16x32_bf16 a[16:19], a[168:171], a[144:147], a[16:19]
    v_accvgpr_read_b32 v49, a241
    v_accvgpr_read_b32 v50, a242
    v_mfma_f32_16x16x32_bf16 a[64:67], a[172:175], a[144:147], a[64:67]
    v_accvgpr_read_b32 v51, a243
    v_add_f32 v44, v44, v48
    v_mfma_f32_16x16x32_bf16 a[68:71], a[172:175], a[148:151], a[68:71]
    v_add_f32 v45, v45, v49
    v_add_f32 v46, v46, v50
    v_mfma_f32_16x16x32_bf16 a[20:23], a[168:171], a[148:151], a[20:23]
    v_add_f32 v47, v47, v51
    v_cmp_u_f32 s[82:83], v44, v45
    v_mfma_f32_16x16x32_bf16 a[24:27], a[168:171], a[152:155], a[24:27]
    v_cmp_u_f32 vcc, v46, v47
    v_mfma_f32_16x16x32_bf16 a[72:75], a[172:175], a[152:155], a[72:75]
    s_or_b64 vcc, vcc, s[82:83]
    s_cbranch_vccnz LF_cs_spin
LF_cs_back:
    ds_write_b128 v63, v[44:47] offset:0
    v_mfma_f32_16x16x32_bf16 a[76:79], a[172:175], a[156:159], a[76:79]
    v_and_b32 v0, 48, v1
    v_lshl_add_u32 v0, v0, 3, s78
    v_mfma_f32_16x16x32_bf16 a[28:31], a[168:171], a[156:159], a[28:31]
    s_waitcnt lgkmcnt(1)
    v_lshlrev_b32 v11, 3, v1
    v_mfma_f32_16x16x32_bf16 a[44:47], a[176:179], a[156:159], a[44:47]
    v_mfma_f32_16x16x32_bf16 a[92:95], a[180:183], a[156:159], a[92:95]
    v_mfma_f32_16x16x32_bf16 a[88:91], a[180:183], a[152:155], a[88:91]
    v_mfma_f32_16x16x32_bf16 a[40:43], a[176:179], a[152:155], a[40:43]
    v_mfma_f32_16x16x32_bf16 a[36:39], a[176:179], a[148:151], a[36:39]
    v_mfma_f32_16x16x32_bf16 a[84:87], a[180:183], a[148:151], a[84:87]
    v_mfma_f32_16x16x32_bf16 a[80:83], a[180:183], a[144:147], a[80:83]
    v_mfma_f32_16x16x32_bf16 a[32:35], a[176:179], a[144:147], a[32:35]
    s_nop 0
    ds_read_b128 v[44:47], v0 offset:1536
    ds_read_b128 v[48:51], v0 offset:1552
    ds_read_b128 v[12:15], v0 offset:1568
    ds_read_b128 v[16:19], v0 offset:1584
    v_pk_mul_f32 v[56:57], v[30:31], v[64:65] op_sel:[0,0] op_sel_hi:[1,0]
    v_pk_mul_f32 v[58:59], v[30:31], v[64:65] op_sel:[0,1] op_sel_hi:[1,1]
    v_pk_mul_f32 v[60:61], v[30:31], v[66:67] op_sel:[0,0] op_sel_hi:[1,0]
    v_pk_mul_f32 v[62:63], v[30:31], v[66:67] op_sel:[0,1] op_sel_hi:[1,1]
    v_pk_fma_f32 v[56:57], v[30:31], v[68:69], v[56:57] op_sel:[1,0,0] op_sel_hi:[0,0,1] neg_lo:[1,0,0]
    v_pk_fma_f32 v[58:59], v[30:31], v[68:69], v[58:59] op_sel:[1,1,0] op_sel_hi:[0,1,1] neg_lo:[1,0,0]
    v_pk_fma_f32 v[60:61], v[30:31], v[70:71], v[60:61] op_sel:[1,0,0] op_sel_hi:[0,0,1] neg_lo:[1,0,0]
    v_pk_fma_f32 v[62:63], v[30:31], v[70:71], v[62:63] op_sel:[1,1,0] op_sel_hi:[0,1,1] neg_lo:[1,0,0]
    s_waitcnt lgkmcnt(2)
    s_nop 0
    v_pk_fma_f32 v[56:57], v[52:53], v[44:45], v[56:57] op_sel_hi:[1,0,1] neg_lo:[0,1,0] neg_hi:[0,1,0]
    v_pk_fma_f32 v[58:59], v[52:53], v[46:47], v[58:59] op_sel_hi:[1,0,1] neg_lo:[0,1,0] neg_hi:[0,1,0]
    v_pk_fma_f32 v[60:61], v[52:53], v[48:49], v[60:61] op_sel_hi:[1,0,1] neg_lo:[0,1,0] neg_hi:[0,1,0]
    v_pk_fma_f32 v[62:63], v[52:53], v[50:51], v[62:63] op_sel_hi:[1,0,1] neg_lo:[0,1,0] neg_hi:[0,1,0]
    v_pk_mul_f32 v[56:57], v[56:57], v[44:45] op_sel:[0,1]
    v_pk_mul_f32 v[58:59], v[58:59], v[46:47] op_sel:[0,1]
    v_pk_mul_f32 v[60:61], v[60:61], v[48:49] op_sel:[0,1]
    v_pk_mul_f32 v[62:63], v[62:63], v[50:51] op_sel:[0,1]
    v_pk_mul_f32 v[64:65], v[42:43], v[72:73] op_sel:[0,0] op_sel_hi:[1,0]
    v_pk_mul_f32 v[66:67], v[42:43], v[72:73] op_sel:[0,1] op_sel_hi:[1,1]
    v_pk_mul_f32 v[68:69], v[42:43], v[74:75] op_sel:[0,0] op_sel_hi:[1,0]
    v_pk_mul_f32 v[70:71], v[42:43], v[74:75] op_sel:[0,1] op_sel_hi:[1,1]
    v_pk_fma_f32 v[64:65], v[42:43], v[76:77], v[64:65] op_sel:[1,0,0] op_sel_hi:[0,0,1] neg_lo:[1,0,0]
    v_pk_fma_f32 v[66:67], v[42:43], v[76:77], v[66:67] op_sel:[1,1,0] op_sel_hi:[0,1,1] neg_lo:[1,0,0]
    v_pk_fma_f32 v[68:69], v[42:43], v[78:79], v[68:69] op_sel:[1,0,0] op_sel_hi:[0,0,1] neg_lo:[1,0,0]
    v_pk_fma_f32 v[70:71], v[42:43], v[78:79], v[70:71] op_sel:[1,1,0] op_sel_hi:[0,1,1] neg_lo:[1,0,0]
    v_pk_fma_f32 v[64:65], v[54:55], v[44:45], v[64:65] op_sel_hi:[1,0,1] neg_lo:[0,1,0] neg_hi:[0,1,0]
    v_pk_fma_f32 v[66:67], v[54:55], v[46:47], v[66:67] op_sel_hi:[1,0,1] neg_lo:[0,1,0] neg_hi:[0,1,0]
    v_pk_fma_f32 v[68:69], v[54:55], v[48:49], v[68:69] op_sel_hi:[1,0,1] neg_lo:[0,1,0] neg_hi:[0,1,0]
    v_pk_fma_f32 v[70:71], v[54:55], v[50:51], v[70:71] op_sel_hi:[1,0,1] neg_lo:[0,1,0] neg_hi:[0,1,0]
    v_pk_mul_f32 v[64:65], v[64:65], v[44:45] op_sel:[0,1]
    v_pk_mul_f32 v[66:67], v[66:67], v[46:47] op_sel:[0,1]
    v_pk_mul_f32 v[68:69], v[68:69], v[48:49] op_sel:[0,1]
    v_pk_mul_f32 v[70:71], v[70:71], v[50:51] op_sel:[0,1]
    ds_read_b128 v[44:47], v0 offset:1600
    ds_read_b128 v[48:51], v0 offset:1616
    v_pk_mul_f32 v[72:73], v[30:31], v[80:81] op_sel:[0,0] op_sel_hi:[1,0]
    v_pk_mul_f32 v[74:75], v[30:31], v[80:81] op_sel:[0,1] op_sel_hi:[1,1]
    v_pk_mul_f32 v[76:77], v[30:31], v[82:83] op_sel:[0,0] op_sel_hi:[1,0]
    v_pk_mul_f32 v[78:79], v[30:31], v[82:83] op_sel:[0,1] op_sel_hi:[1,1]
    v_pk_fma_f32 v[72:73], v[30:31], v[84:85], v[72:73] op_sel:[1,0,0] op_sel_hi:[0,0,1] neg_lo:[1,0,0]
    v_pk_fma_f32 v[74:75], v[30:31], v[84:85], v[74:75] op_sel:[1,1,0] op_sel_hi:[0,1,1] neg_lo:[1,0,0]
    v_pk_fma_f32 v[76:77], v[30:31], v[86:87], v[76:77] op_sel:[1,0,0] op_sel_hi:[0,0,1] neg_lo:[1,0,0]
    v_pk_fma_f32 v[78:79], v[30:31], v[86:87], v[78:79] op_sel:[1,1,0] op_sel_hi:[0,1,1] neg_lo:[1,0,0]
    s_waitcnt lgkmcnt(2)
    s_nop 0
    v_pk_fma_f32 v[72:73], v[52:53], v[12:13], v[72:73] op_sel_hi:[1,0,1] neg_lo:[0,1,0] neg_hi:[0,1,0]
    v_pk_fma_f32 v[74:75], v[52:53], v[14:15], v[74:75] op_sel_hi:[1,0,1] neg_lo:[0,1,0] neg_hi:[0,1,0]
    v_pk_fma_f32 v[76:77], v[52:53], v[16:17], v[76:77] op_sel_hi:[1,0,1] neg_lo:[0,1,0] neg_hi:[0,1,0]
    v_pk_fma_f32 v[78:79], v[52:53], v[18:19], v[78:79] op_sel_hi:[1,0,1] neg_lo:[0,1,0] neg_hi:[0,1,0]
    v_pk_mul_f32 v[72:73], v[72:73], v[12:13] op_sel:[0,1]
    v_pk_mul_f32 v[74:75], v[74:75], v[14:15] op_sel:[0,1]
    v_pk_mul_f32 v[76:77], v[76:77], v[16:17] op_sel:[0,1]
    v_pk_mul_f32 v[78:79], v[78:79], v[18:19] op_sel:[0,1]
    v_pk_mul_f32 v[80:81], v[42:43], v[88:89] op_sel:[0,0] op_sel_hi:[1,0]
    v_pk_mul_f32 v[82:83], v[42:43], v[88:89] op_sel:[0,1] op_sel_hi:[1,1]
    v_pk_mul_f32 v[84:85], v[42:43], v[90:91] op_sel:[0,0] op_sel_hi:[1,0]
    v_pk_mul_f32 v[86:87], v[42:43], v[90:91] op_sel:[0,1] op_sel_hi:[1,1]
    v_pk_fma_f32 v[80:81], v[42:43], v[92:93], v[80:81] op_sel:[1,0,0] op_sel_hi:[0,0,1] neg_lo:[1,0,0]
    v_pk_fma_f32 v[82:83], v[42:43], v[92:93], v[82:83] op_sel:[1,1,0] op_sel_hi:[0,1,1] neg_lo:[1,0,0]
    v_pk_fma_f32 v[84:85], v[42:43], v[94:95], v[84:85] op_sel:[1,0,0] op_sel_hi:[0,0,1] neg_lo:[1,0,0]
    v_pk_fma_f32 v[86:87], v[42:43], v[94:95], v[86:87] op_sel:[1,1,0] op_sel_hi:[0,1,1] neg_lo:[1,0,0]
    v_pk_fma_f32 v[80:81], v[54:55], v[12:13], v[80:81] op_sel_hi:[1,0,1] neg_lo:[0,1,0] neg_hi:[0,1,0]
    v_pk_fma_f32 v[82:83], v[54:55], v[14:15], v[82:83] op_sel_hi:[1,0,1] neg_lo:[0,1,0] neg_hi:[0,1,0]
    v_pk_fma_f32 v[84:85], v[54:55], v[16:17], v[84:85] op_sel_hi:[1,0,1] neg_lo:[0,1,0] neg_hi:[0,1,0]
    v_pk_fma_f32 v[86:87], v[54:55], v[18:19], v[86:87] op_sel_hi:[1,0,1] neg_lo:[0,1,0] neg_hi:[0,1,0]
    v_pk_mul_f32 v[80:81], v[80:81], v[12:13] op_sel:[0,1]
    v_pk_mul_f32 v[82:83], v[82:83], v[14:15] op_sel:[0,1]
    v_pk_mul_f32 v[84:85], v[84:85], v[16:17] op_sel:[0,1]
    v_pk_mul_f32 v[86:87], v[86:87], v[18:19] op_sel:[0,1]
    ds_read_b128 v[12:15], v0 offset:1632
    ds_read_b128 v[16:19], v0 offset:1648
    v_pk_mul_f32 v[88:89], v[30:31], v[96:97] op_sel:[0,0] op_sel_hi:[1,0]
    v_pk_mul_f32 v[90:91], v[30:31], v[96:97] op_sel:[0,1] op_sel_hi:[1,1]
    v_pk_mul_f32 v[92:93], v[30:31], v[98:99] op_sel:[0,0] op_sel_hi:[1,0]
    v_pk_mul_f32 v[94:95], v[30:31], v[98:99] op_sel:[0,1] op_sel_hi:[1,1]
    v_pk_fma_f32 v[88:89], v[30:31], v[100:101], v[88:89] op_sel:[1,0,0] op_sel_hi:[0,0,1] neg_lo:[1,0,0]
    v_pk_fma_f32 v[90:91], v[30:31], v[100:101], v[90:91] op_sel:[1,1,0] op_sel_hi:[0,1,1] neg_lo:[1,0,0]
    v_pk_fma_f32 v[92:93], v[30:31], v[102:103], v[92:93] op_sel:[1,0,0] op_sel_hi:[0,0,1] neg_lo:[1,0,0]
    v_pk_fma_f32 v[94:95], v[30:31], v[102:103], v[94:95] op_sel:[1,1,0] op_sel_hi:[0,1,1] neg_lo:[1,0,0]
    s_waitcnt lgkmcnt(2)
    s_nop 0
    v_pk_fma_f32 v[88:89], v[52:53], v[44:45], v[88:89] op_sel_hi:[1,0,1] neg_lo:[0,1,0] neg_hi:[0,1,0]
    v_pk_fma_f32 v[90:91], v[52:53], v[46:47], v[90:91] op_sel_hi:[1,0,1] neg_lo:[0,1,0] neg_hi:[0,1,0]
    v_pk_fma_f32 v[92:93], v[52:53], v[48:49], v[92:93] op_sel_hi:[1,0,1] neg_lo:[0,1,0] neg_hi:[0,1,0]
    v_pk_fma_f32 v[94:95], v[52:53], v[50:51], v[94:95] op_sel_hi:[1,0,1] neg_lo:[0,1,0] neg_hi:[0,1,0]
    v_pk_mul_f32 v[88:89], v[88:89], v[44:45] op_sel:[0,1]
    v_pk_mul_f32 v[90:91], v[90:91], v[46:47] op_sel:[0,1]
    v_pk_mul_f32 v[92:93], v[92:93], v[48:49] op_sel:[0,1]
    v_pk_mul_f32 v[94:95], v[94:95], v[50:51] op_sel:[0,1]
    v_pk_mul_f32 v[96:97], v[42:43], v[104:105] op_sel:[0,0] op_sel_hi:[1,0]
    v_pk_mul_f32 v[98:99], v[42:43], v[104:105] op_sel:[0,1] op_sel_hi:[1,1]
    v_pk_mul_f32 v[100:101], v[42:43], v[106:107] op_sel:[0,0] op_sel_hi:[1,0]
    v_pk_mul_f32 v[102:103], v[42:43], v[106:107] op_sel:[0,1] op_sel_hi:[1,1]
    v_pk_fma_f32 v[96:97], v[42:43], v[108:109], v[96:97] op_sel:[1,0,0] op_sel_hi:[0,0,1] neg_lo:[1,0,0]
    v_pk_fma_f32 v[98:99], v[42:43], v[108:109], v[98:99] op_sel:[1,1,0] op_sel_hi:[0,1,1] neg_lo:[1,0,0]
    v_pk_fma_f32 v[100:101], v[42:43], v[110:111], v[100:101] op_sel:[1,0,0] op_sel_hi:[0,0,1] neg_lo:[1,0,0]
    v_pk_fma_f32 v[102:103], v[42:43], v[110:111], v[102:103] op_sel:[1,1,0] op_sel_hi:[0,1,1] neg_lo:[1,0,0]
    v_pk_fma_f32 v[96:97], v[54:55], v[44:45], v[96:97] op_sel_hi:[1,0,1] neg_lo:[0,1,0] neg_hi:[0,1,0]
    v_pk_fma_f32 v[98:99], v[54:55], v[46:47], v[98:99] op_sel_hi:[1,0,1] neg_lo:[0,1,0] neg_hi:[0,1,0]
    v_pk_fma_f32 v[100:101], v[54:55], v[48:49], v[100:101] op_sel_hi:[1,0,1] neg_lo:[0,1,0] neg_hi:[0,1,0]
    v_pk_fma_f32 v[102:103], v[54:55], v[50:51], v[102:103] op_sel_hi:[1,0,1] neg_lo:[0,1,0] neg_hi:[0,1,0]
    v_pk_mul_f32 v[96:97], v[96:97], v[44:45] op_sel:[0,1]
    v_pk_mul_f32 v[98:99], v[98:99], v[46:47] op_sel:[0,1]
    v_pk_mul_f32 v[100:101], v[100:101], v[48:49] op_sel:[0,1]
    v_pk_mul_f32 v[102:103], v[102:103], v[50:51] op_sel:[0,1]
    v_pk_mul_f32 v[104:105], v[30:31], v[112:113] op_sel:[0,0] op_sel_hi:[1,0]
    v_pk_mul_f32 v[106:107], v[30:31], v[112:113] op_sel:[0,1] op_sel_hi:[1,1]
    v_pk_mul_f32 v[108:109], v[30:31], v[114:115] op_sel:[0,0] op_sel_hi:[1,0]
    v_pk_mul_f32 v[110:111], v[30:31], v[114:115] op_sel:[0,1] op_sel_hi:[1,1]
    v_pk_fma_f32 v[104:105], v[30:31], v[116:117], v[104:105] op_sel:[1,0,0] op_sel_hi:[0,0,1] neg_lo:[1,0,0]
    v_pk_fma_f32 v[106:107], v[30:31], v[116:117], v[106:107] op_sel:[1,1,0] op_sel_hi:[0,1,1] neg_lo:[1,0,0]
    v_pk_fma_f32 v[108:109], v[30:31], v[118:119], v[108:109] op_sel:[1,0,0] op_sel_hi:[0,0,1] neg_lo:[1,0,0]
    v_pk_fma_f32 v[110:111], v[30:31], v[118:119], v[110:111] op_sel:[1,1,0] op_sel_hi:[0,1,1] neg_lo:[1,0,0]
    s_waitcnt lgkmcnt(0)
    s_nop 0
    v_pk_fma_f32 v[104:105], v[52:53], v[12:13], v[104:105] op_sel_hi:[1,0,1] neg_lo:[0,1,0] neg_hi:[0,1,0]
    v_pk_fma_f32 v[106:107], v[52:53], v[14:15], v[106:107] op_sel_hi:[1,0,1] neg_lo:[0,1,0] neg_hi:[0,1,0]
    v_pk_fma_f32 v[108:109], v[52:53], v[16:17], v[108:109] op_sel_hi:[1,0,1] neg_lo:[0,1,0] neg_hi:[0,1,0]
    v_pk_fma_f32 v[110:111], v[52:53], v[18:19], v[110:111] op_sel_hi:[1,0,1] neg_lo:[0,1,0] neg_hi:[0,1,0]
    v_pk_mul_f32 v[104:105], v[104:105], v[12:13] op_sel:[0,1]
    v_pk_mul_f32 v[106:107], v[106:107], v[14:15] op_sel:[0,1]
    v_pk_mul_f32 v[108:109], v[108:109], v[16:17] op_sel:[0,1]
    v_pk_mul_f32 v[110:111], v[110:111], v[18:19] op_sel:[0,1]
    v_pk_mul_f32 v[112:113], v[42:43], v[120:121] op_sel:[0,0] op_sel_hi:[1,0]
    v_pk_mul_f32 v[114:115], v[42:43], v[120:121] op_sel:[0,1] op_sel_hi:[1,1]
    v_pk_mul_f32 v[116:117], v[42:43], v[122:123] op_sel:[0,0] op_sel_hi:[1,0]
    v_pk_mul_f32 v[118:119], v[42:43], v[122:123] op_sel:[0,1] op_sel_hi:[1,1]
    v_pk_fma_f32 v[112:113], v[42:43], v[124:125], v[112:113] op_sel:[1,0,0] op_sel_hi:[0,0,1] neg_lo:[1,0,0]
    v_pk_fma_f32 v[114:115], v[42:43], v[124:125], v[114:115] op_sel:[1,1,0] op_sel_hi:[0,1,1] neg_lo:[1,0,0]
    v_pk_fma_f32 v[116:117], v[42:43], v[126:127], v[116:117] op_sel:[1,0,0] op_sel_hi:[0,0,1] neg_lo:[1,0,0]
    v_pk_fma_f32 v[118:119], v[42:43], v[126:127], v[118:119] op_sel:[1,1,0] op_sel_hi:[0,1,1] neg_lo:[1,0,0]
    v_pk_fma_f32 v[112:113], v[54:55], v[12:13], v[112:113] op_sel_hi:[1,0,1] neg_lo:[0,1,0] neg_hi:[0,1,0]
    v_pk_fma_f32 v[114:115], v[54:55], v[14:15], v[114:115] op_sel_hi:[1,0,1] neg_lo:[0,1,0] neg_hi:[0,1,0]
    v_pk_fma_f32 v[116:117], v[54:55], v[16:17], v[116:117] op_sel_hi:[1,0,1] neg_lo:[0,1,0] neg_hi:[0,1,0]
    v_pk_fma_f32 v[118:119], v[54:55], v[18:19], v[118:119] op_sel_hi:[1,0,1] neg_lo:[0,1,0] neg_hi:[0,1,0]
    v_pk_mul_f32 v[112:113], v[112:113], v[12:13] op_sel:[0,1]
    v_pk_mul_f32 v[114:115], v[114:115], v[14:15] op_sel:[0,1]
    v_pk_mul_f32 v[116:117], v[116:117], v[16:17] op_sel:[0,1]
    v_pk_mul_f32 v[118:119], v[118:119], v[18:19] op_sel:[0,1]
    v_and_b32 v0, 15, v1
    v_lshl_add_u32 v0, v0, 5, s78
    v_and_b32 v31, 48, v1
    s_lshl_b32 s81, s52, 6
    s_add_u32 s81, s81, s78
    s_mul_i32 s82, s52, 384
    s_sub_u32 s82, s78, s82
    v_add_u32 v30, s81, v31
    v_add_u32_e64 v31, s82, v31
    ds_read_b64 v[46:47], v0 offset:1024
    ds_read_b64 v[50:51], v0 offset:1032
    v_pk_fma_f32 v[120:121], v[20:21], v[56:57], v[72:73] op_sel_hi:[1,0,1]
    v_pk_fma_f32 v[122:123], v[32:33], v[64:65], v[80:81] op_sel_hi:[1,0,1]
    v_pk_fma_f32 v[120:121], v[20:21], v[56:57], v[120:121] op_sel:[1,1,0] op_sel_hi:[0,1,1] neg_lo:[1,0,0]
    v_pk_fma_f32 v[122:123], v[32:33], v[64:65], v[122:123] op_sel:[1,1,0] op_sel_hi:[0,1,1] neg_lo:[1,0,0]
    v_pk_fma_f32 v[124:125], v[20:21], v[120:121], v[88:89] op_sel_hi:[1,0,1]
    v_pk_fma_f32 v[126:127], v[32:33], v[122:123], v[96:97] op_sel_hi:[1,0,1]
    v_pk_fma_f32 v[124:125], v[20:21], v[120:121], v[124:125] op_sel:[1,1,0] op_sel_hi:[0,1,1] neg_lo:[1,0,0]
    v_pk_fma_f32 v[126:127], v[32:33], v[122:123], v[126:127] op_sel:[1,1,0] op_sel_hi:[0,1,1] neg_lo:[1,0,0]
    v_pk_fma_f32 v[120:121], v[20:21], v[124:125], v[104:105] op_sel_hi:[1,0,1]
    v_pk_fma_f32 v[122:123], v[32:33], v[126:127], v[112:113] op_sel_hi:[1,0,1]
    v_pk_fma_f32 v[120:121], v[20:21], v[124:125], v[120:121] op_sel:[1,1,0] op_sel_hi:[0,1,1] neg_lo:[1,0,0]
    v_pk_fma_f32 v[122:123], v[32:33], v[126:127], v[122:123] op_sel:[1,1,0] op_sel_hi:[0,1,1] neg_lo:[1,0,0]
    v_pk_fma_f32 v[124:125], v[20:21], v[120:121], v[58:59] op_sel_hi:[1,0,1]
    v_pk_fma_f32 v[126:127], v[32:33], v[122:123], v[66:67] op_sel_hi:[1,0,1]
    v_pk_fma_f32 v[124:125], v[20:21], v[120:121], v[124:125] op_sel:[1,1,0] op_sel_hi:[0,1,1] neg_lo:[1,0,0]
    v_pk_fma_f32 v[126:127], v[32:33], v[122:123], v[126:127] op_sel:[1,1,0] op_sel_hi:[0,1,1] neg_lo:[1,0,0]
    v_pk_fma_f32 v[120:121], v[20:21], v[124:125], v[74:75] op_sel_hi:[1,0,1]
    v_pk_fma_f32 v[122:123], v[32:33], v[126:127], v[82:83] op_sel_hi:[1,0,1]
    v_pk_fma_f32 v[120:121], v[20:21], v[124:125], v[120:121] op_sel:[1,1,0] op_sel_hi:[0,1,1] neg_lo:[1,0,0]
    v_pk_fma_f32 v[122:123], v[32:33], v[126:127], v[122:123] op_sel:[1,1,0] op_sel_hi:[0,1,1] neg_lo:[1,0,0]
    v_pk_fma_f32 v[124:125], v[20:21], v[120:121], v[90:91] op_sel_hi:[1,0,1]
    v_pk_fma_f32 v[126:127], v[32:33], v[122:123], v[98:99] op_sel_hi:[1,0,1]
    v_pk_fma_f32 v[124:125], v[20:21], v[120:121], v[124:125] op_sel:[1,1,0] op_sel_hi:[0,1,1] neg_lo:[1,0,0]
    v_pk_fma_f32 v[126:127], v[32:33], v[122:123], v[126:127] op_sel:[1,1,0] op_sel_hi:[0,1,1] neg_lo:[1,0,0]
    v_pk_fma_f32 v[120:121], v[20:21], v[124:125], v[106:107] op_sel_hi:[1,0,1]
    v_pk_fma_f32 v[122:123], v[32:33], v[126:127], v[114:115] op_sel_hi:[1,0,1]
    v_pk_fma_f32 v[120:121], v[20:21], v[124:125], v[120:121] op_sel:[1,1,0] op_sel_hi:[0,1,1] neg_lo:[1,0,0]
    v_pk_fma_f32 v[122:123], v[32:33], v[126:127], v[122:123] op_sel:[1,1,0] op_sel_hi:[0,1,1] neg_lo:[1,0,0]
    v_pk_fma_f32 v[124:125], v[20:21], v[120:121], v[60:61] op_sel_hi:[1,0,1]
    v_pk_fma_f32 v[126:127], v[32:33], v[122:123], v[68:69] op_sel_hi:[1,0,1]
    v_pk_fma_f32 v[124:125], v[20:21], v[120:121], v[124:125] op_sel:[1,1,0] op_sel_hi:[0,1,1] neg_lo:[1,0,0]
    v_pk_fma_f32 v[126:127], v[32:33], v[122:123], v[126:127] op_sel:[1,1,0] op_sel_hi:[0,1,1] neg_lo:[1,0,0]
    v_pk_fma_f32 v[120:121], v[20:21], v[124:125], v[76:77] op_sel_hi:[1,0,1]
    v_pk_fma_f32 v[122:123], v[32:33], v[126:127], v[84:85] op_sel_hi:[1,0,1]
    v_pk_fma_f32 v[120:121], v[20:21], v[124:125], v[120:121] op_sel:[1,1,0] op_sel_hi:[0,1,1] neg_lo:[1,0,0]
    v_pk_fma_f32 v[122:123], v[32:33], v[126:127], v[122:123] op_sel:[1,1,0] op_sel_hi:[0,1,1] neg_lo:[1,0,0]
    v_pk_fma_f32 v[124:125], v[20:21], v[120:121], v[92:93] op_sel_hi:[1,0,1]
    v_pk_fma_f32 v[126:127], v[32:33], v[122:123], v[100:101] op_sel_hi:[1,0,1]
    v_pk_fma_f32 v[124:125], v[20:21], v[120:121], v[124:125] op_sel:[1,1,0] op_sel_hi:[0,1,1] neg_lo:[1,0,0]
    v_pk_fma_f32 v[126:127], v[32:33], v[122:123], v[126:127] op_sel:[1,1,0] op_sel_hi:[0,1,1] neg_lo:[1,0,0]
    v_pk_fma_f32 v[120:121], v[20:21], v[124:125], v[108:109] op_sel_hi:[1,0,1]
    v_pk_fma_f32 v[122:123], v[32:33], v[126:127], v[116:117] op_sel_hi:[1,0,1]
    v_pk_fma_f32 v[120:121], v[20:21], v[124:125], v[120:121] op_sel:[1,1,0] op_sel_hi:[0,1,1] neg_lo:[1,0,0]
    v_pk_fma_f32 v[122:123], v[32:33], v[126:127], v[122:123] op_sel:[1,1,0] op_sel_hi:[0,1,1] neg_lo:[1,0,0]
    v_pk_fma_f32 v[124:125], v[20:21], v[120:121], v[62:63] op_sel_hi:[1,0,1]
    v_pk_fma_f32 v[126:127], v[32:33], v[122:123], v[70:71] op_sel_hi:[1,0,1]
    v_pk_fma_f32 v[124:125], v[20:21], v[120:121], v[124:125] op_sel:[1,1,0] op_sel_hi:[0,1,1] neg_lo:[1,0,0]
    v_pk_fma_f32 v[126:127], v[32:33], v[122:123], v[126:127] op_sel:[1,1,0] op_sel_hi:[0,1,1] neg_lo:[1,0,0]
    v_pk_fma_f32 v[120:121], v[20:21], v[124:125], v[78:79] op_sel_hi:[1,0,1]
    v_pk_fma_f32 v[122:123], v[32:33], v[126:127], v[86:87] op_sel_hi:[1,0,1]
    v_pk_fma_f32 v[120:121], v[20:21], v[124:125], v[120:121] op_sel:[1,1,0] op_sel_hi:[0,1,1] neg_lo:[1,0,0]
    v_pk_fma_f32 v[122:123], v[32:33], v[126:127], v[122:123] op_sel:[1,1,0] op_sel_hi:[0,1,1] neg_lo:[1,0,0]
    v_pk_fma_f32 v[124:125], v[20:21], v[120:121], v[94:95] op_sel_hi:[1,0,1]
    v_pk_fma_f32 v[126:127], v[32:33], v[122:123], v[102:103] op_sel_hi:[1,0,1]
    v_pk_fma_f32 v[124:125], v[20:21], v[120:121], v[124:125] op_sel:[1,1,0] op_sel_hi:[0,1,1] neg_lo:[1,0,0]
    v_pk_fma_f32 v[126:127], v[32:33], v[122:123], v[126:127] op_sel:[1,1,0] op_sel_hi:[0,1,1] neg_lo:[1,0,0]
    v_pk_fma_f32 v[120:121], v[20:21], v[124:125], v[110:111] op_sel_hi:[1,0,1]
    v_pk_fma_f32 v[122:123], v[32:33], v[126:127], v[118:119] op_sel_hi:[1,0,1]
    v_pk_fma_f32 v[120:121], v[20:21], v[124:125], v[120:121] op_sel:[1,1,0] op_sel_hi:[0,1,1] neg_lo:[1,0,0]
    v_pk_fma_f32 v[122:123], v[32:33], v[126:127], v[122:123] op_sel:[1,1,0] op_sel_hi:[0,1,1] neg_lo:[1,0,0]
    v_mov_b64 v[12:13], v[120:121]
    v_mov_b64 v[14:15], v[122:123]
    s_sub_u32 s81, 31, s49
    s_lshl_b32 s81, s81, 8
    v_permlane32_swap_b32 v120, v12
    v_permlane32_swap_b32 v121, v13
    v_permlane32_swap_b32 v122, v14
    v_permlane32_swap_b32 v123, v15
    v_mov_b64 v[124:125], v[120:121]
    v_mov_b64 v[126:127], v[122:123]
    v_mov_b64 v[16:17], v[12:13]
    v_mov_b64 v[18:19], v[14:15]
    v_permlane16_swap_b32 v120, v124
    v_permlane16_swap_b32 v121, v125
    v_permlane16_swap_b32 v122, v126
    v_permlane16_swap_b32 v123, v127
    v_permlane16_swap_b32 v12, v16
    v_permlane16_swap_b32 v13, v17
    v_permlane16_swap_b32 v14, v18
    v_permlane16_swap_b32 v15, v19
    v_pk_fma_f32 v[124:125], v[22:23], v[120:121], v[124:125] op_sel_hi:[1,0,1]
    v_pk_fma_f32 v[126:127], v[34:35], v[122:123], v[126:127] op_sel_hi:[1,0,1]
    v_pk_fma_f32 v[124:125], v[22:23], v[120:121], v[124:125] op_sel:[1,1,0] op_sel_hi:[0,1,1] neg_lo:[1,0,0]
    v_pk_fma_f32 v[126:127], v[34:35], v[122:123], v[126:127] op_sel:[1,1,0] op_sel_hi:[0,1,1] neg_lo:[1,0,0]
    v_pk_fma_f32 v[12:13], v[22:23], v[124:125], v[12:13] op_sel_hi:[1,0,1]
    v_pk_fma_f32 v[14:15], v[34:35], v[126:127], v[14:15] op_sel_hi:[1,0,1]
    v_pk_fma_f32 v[12:13], v[22:23], v[124:125], v[12:13] op_sel:[1,1,0] op_sel_hi:[0,1,1] neg_lo:[1,0,0]
    v_pk_fma_f32 v[14:15], v[34:35], v[126:127], v[14:15] op_sel:[1,1,0] op_sel_hi:[0,1,1] neg_lo:[1,0,0]
    v_pk_fma_f32 v[16:17], v[22:23], v[12:13], v[16:17] op_sel_hi:[1,0,1]
    v_pk_fma_f32 v[18:19], v[34:35], v[14:15], v[18:19] op_sel_hi:[1,0,1]
    v_pk_fma_f32 v[16:17], v[22:23], v[12:13], v[16:17] op_sel:[1,1,0] op_sel_hi:[0,1,1] neg_lo:[1,0,0]
    v_pk_fma_f32 v[18:19], v[34:35], v[14:15], v[18:19] op_sel:[1,1,0] op_sel_hi:[0,1,1] neg_lo:[1,0,0]
    s_mov_b64 exec, 0xffff
    buffer_store_dwordx4 v[16:19], v2, s[20:23], s81 offen sc1
    v_mov_b64 v[52:53], 0
    v_mov_b64 v[54:55], 0
    s_lshl_b64 exec, exec, 16
    v_mov_b64 v[52:53], v[120:121]
    v_mov_b64 v[54:55], v[122:123]
    s_lshl_b64 exec, exec, 16
    v_mov_b64 v[52:53], v[124:125]
    v_mov_b64 v[54:55], v[126:127]
    s_lshl_b64 exec, exec, 16
    v_mov_b64 v[52:53], v[12:13]
    v_mov_b64 v[54:55], v[14:15]
    s_mov_b64 exec, -1
    ds_read_b64 v[14:15], v0 offset:1040
    ds_read_b64 v[18:19], v0 offset:1048
    ds_read_b128 v[120:123], v30 offset:0
    ds_read_b128 v[124:127], v30 offset:64
    s_mov_b32 s81, s69
    s_lshr_b32 s83, s54, 1
    s_sub_u32 s83, s83, s72
    s_add_u32 s83, s83, 24
    s_lshl_b32 s83, s83, 3
    s_add_u32 s83, s83, s52
    s_lshl_b32 s83, s83, 9
    s_add_u32 s83, s83, s81
    s_waitcnt lgkmcnt(2)
    v_mul_f32 v44, v47, v47
    v_mul_f32 v48, v51, v51
    v_mul_f32 v12, v15, v15
    v_mul_f32_e64 v16, v19, v19
    v_mul_f32 v45, 0xc0135761, v47
    v_mul_f32 v49, 0xc0135761, v51
    v_mul_f32 v13, 0xc0135761, v15
LF_pad6:
    s_cbranch_execz LF_pad10
    v_mul_f32 v17, 0xc0135761, v19
    v_rcp_f32 v47, v44
    v_rcp_f32 v51, v48
    v_rcp_f32 v15, v12
    v_rcp_f32 v19, v16
    v_mul_f32 v44, v44, v45
    v_mul_f32 v48, v48, v49
    v_mul_f32 v12, v12, v13
    v_mul_f32_e64 v16, v16, v17
    v_mul_f32 v44, 0x3d372713, v44
    v_mul_f32 v48, 0x3d372713, v48
    v_mul_f32 v12, 0x3d372713, v12
    v_mul_f32 v16, 0x3d372713, v16
    s_waitcnt lgkmcnt(1)
    s_nop 0
    v_pk_fma_f32 v[128:129], v[120:121], v[46:47], v[128:129] op_sel_hi:[1,0,1] neg_lo:[0,1,0] neg_hi:[0,1,0]
    v_pk_fma_f32 v[130:131], v[122:123], v[46:47], v[130:131] op_sel_hi:[1,0,1] neg_lo:[0,1,0] neg_hi:[0,1,0]
    v_pk_fma_f32 v[132:133], v[120:121], v[50:51], v[132:133] op_sel_hi:[1,0,1] neg_lo:[0,1,0] neg_hi:[0,1,0]
    v_pk_fma_f32 v[134:135], v[122:123], v[50:51], v[134:135] op_sel_hi:[1,0,1] neg_lo:[0,1,0] neg_hi:[0,1,0]
    v_pk_fma_f32 v[136:137], v[120:121], v[14:15], v[136:137] op_sel_hi:[1,0,1] neg_lo:[0,1,0] neg_hi:[0,1,0]
    v_pk_fma_f32 v[138:139], v[122:123], v[14:15], v[138:139] op_sel_hi:[1,0,1] neg_lo:[0,1,0] neg_hi:[0,1,0]
    v_pk_fma_f32 v[140:141], v[120:121], v[18:19], v[140:141] op_sel_hi:[1,0,1] neg_lo:[0,1,0] neg_hi:[0,1,0]
    v_pk_fma_f32 v[142:143], v[122:123], v[18:19], v[142:143] op_sel_hi:[1,0,1] neg_lo:[0,1,0] neg_hi:[0,1,0]
    ds_read_b128 v[120:123], v30 offset:448
    s_waitcnt lgkmcnt(1)
    s_nop 0
    v_pk_fma_f32 v[144:145], v[124:125], v[46:47], v[144:145] op_sel_hi:[1,0,1] neg_lo:[0,1,0] neg_hi:[0,1,0]
    v_pk_fma_f32 v[146:147], v[126:127], v[46:47], v[146:147] op_sel_hi:[1,0,1] neg_lo:[0,1,0] neg_hi:[0,1,0]
    v_pk_fma_f32 v[148:149], v[124:125], v[50:51], v[148:149] op_sel_hi:[1,0,1] neg_lo:[0,1,0] neg_hi:[0,1,0]
    v_pk_fma_f32 v[150:151], v[126:127], v[50:51], v[150:151] op_sel_hi:[1,0,1] neg_lo:[0,1,0] neg_hi:[0,1,0]
    v_pk_fma_f32 v[152:153], v[124:125], v[14:15], v[152:153] op_sel_hi:[1,0,1] neg_lo:[0,1,0] neg_hi:[0,1,0]
    v_pk_fma_f32 v[154:155], v[126:127], v[14:15], v[154:155] op_sel_hi:[1,0,1] neg_lo:[0,1,0] neg_hi:[0,1,0]
    v_pk_fma_f32 v[156:157], v[124:125], v[18:19], v[156:157] op_sel_hi:[1,0,1] neg_lo:[0,1,0] neg_hi:[0,1,0]
    v_pk_fma_f32 v[158:159], v[126:127], v[18:19], v[158:159] op_sel_hi:[1,0,1] neg_lo:[0,1,0] neg_hi:[0,1,0]
    ds_read_b128 v[124:127], v30 offset:512
    s_waitcnt lgkmcnt(1)
    s_nop 0
    v_pk_fma_f32 v[192:193], v[120:121], v[46:47], v[192:193] op_sel_hi:[1,0,1] neg_lo:[0,1,0] neg_hi:[0,1,0]
    v_pk_fma_f32 v[194:195], v[122:123], v[46:47], v[194:195] op_sel_hi:[1,0,1] neg_lo:[0,1,0] neg_hi:[0,1,0]
    v_pk_fma_f32 v[196:197], v[120:121], v[50:51], v[196:197] op_sel_hi:[1,0,1] neg_lo:[0,1,0] neg_hi:[0,1,0]
    v_pk_fma_f32 v[198:199], v[122:123], v[50:51], v[198:199] op_sel_hi:[1,0,1] neg_lo:[0,1,0] neg_hi:[0,1,0]
    v_pk_fma_f32 v[200:201], v[120:121], v[14:15], v[200:201] op_sel_hi:[1,0,1] neg_lo:[0,1,0] neg_hi:[0,1,0]
    v_pk_fma_f32 v[202:203], v[122:123], v[14:15], v[202:203] op_sel_hi:[1,0,1] neg_lo:[0,1,0] neg_hi:[0,1,0]
    v_pk_fma_f32 v[204:205], v[120:121], v[18:19], v[204:205] op_sel_hi:[1,0,1] neg_lo:[0,1,0] neg_hi:[0,1,0]
    v_pk_fma_f32 v[206:207], v[122:123], v[18:19], v[206:207] op_sel_hi:[1,0,1] neg_lo:[0,1,0] neg_hi:[0,1,0]
    s_waitcnt lgkmcnt(0)
    s_nop 0
    v_pk_fma_f32 v[208:209], v[124:125], v[46:47], v[208:209] op_sel_hi:[1,0,1] neg_lo:[0,1,0] neg_hi:[0,1,0]
    v_pk_fma_f32 v[210:211], v[126:127], v[46:47], v[210:211] op_sel_hi:[1,0,1] neg_lo:[0,1,0] neg_hi:[0,1,0]
    v_pk_fma_f32 v[212:213], v[124:125], v[50:51], v[212:213] op_sel_hi:[1,0,1] neg_lo:[0,1,0] neg_hi:[0,1,0]
    v_pk_fma_f32 v[214:215], v[126:127], v[50:51], v[214:215] op_sel_hi:[1,0,1] neg_lo:[0,1,0] neg_hi:[0,1,0]
    v_pk_fma_f32 v[216:217], v[124:125], v[14:15], v[216:217] op_sel_hi:[1,0,1] neg_lo:[0,1,0] neg_hi:[0,1,0]
    v_pk_fma_f32 v[218:219], v[126:127], v[14:15], v[218:219] op_sel_hi:[1,0,1] neg_lo:[0,1,0] neg_hi:[0,1,0]
    v_pk_fma_f32 v[220:221], v[124:125], v[18:19], v[220:221] op_sel_hi:[1,0,1] neg_lo:[0,1,0] neg_hi:[0,1,0]
    v_pk_fma_f32 v[222:223], v[126:127], v[18:19], v[222:223] op_sel_hi:[1,0,1] neg_lo:[0,1,0] neg_hi:[0,1,0]
    s_lshl_b32 s84, s54, 2
    v_mov_b32 v42, s84
    v_mov_b32_e64 v43, s80
    v_pk_mul_f32 v[120:121], v[128:129], v[128:129]
    v_pk_mul_f32 v[122:123], v[130:131], v[130:131]
    v_pk_mul_f32 v[124:125], v[144:145], v[144:145]
    v_pk_mul_f32 v[126:127], v[146:147], v[146:147]
    v_pk_fma_f32 v[120:121], v[120:121], v[44:45], v[44:45] op_sel:[0,0,1] op_sel_hi:[1,0,1]
    v_pk_fma_f32 v[122:123], v[122:123], v[44:45], v[44:45] op_sel:[0,0,1] op_sel_hi:[1,0,1]
    v_pk_fma_f32 v[124:125], v[124:125], v[44:45], v[44:45] op_sel:[0,0,1] op_sel_hi:[1,0,1]
    v_pk_fma_f32 v[126:127], v[126:127], v[44:45], v[44:45] op_sel:[0,0,1] op_sel_hi:[1,0,1]
    v_pk_mul_f32 v[120:121], v[120:121], v[128:129]
    v_pk_mul_f32 v[122:123], v[122:123], v[130:131]
    v_pk_mul_f32 v[124:125], v[124:125], v[144:145]
    v_pk_mul_f32 v[126:127], v[126:127], v[146:147]
    v_exp_f32 v120, v120
    v_exp_f32 v121, v121
    v_exp_f32 v122, v122
    v_exp_f32 v123, v123
    v_exp_f32 v124, v124
    v_exp_f32 v125, v125
    v_exp_f32 v126, v126
    v_exp_f32 v127, v127
    v_pk_fma_f32 v[120:121], v[120:121], v[46:47], v[46:47] op_sel:[0,1,1] op_sel_hi:[1,1,1]
    v_pk_fma_f32 v[122:123], v[122:123], v[46:47], v[46:47] op_sel:[0,1,1] op_sel_hi:[1,1,1]
    v_pk_fma_f32 v[124:125], v[124:125], v[46:47], v[46:47] op_sel:[0,1,1] op_sel_hi:[1,1,1]
    v_pk_fma_f32 v[126:127], v[126:127], v[46:47], v[46:47] op_sel:[0,1,1] op_sel_hi:[1,1,1]
    v_rcp_f32 v120, v120
    v_rcp_f32 v121, v121
    v_rcp_f32 v122, v122
    v_rcp_f32 v123, v123
    v_rcp_f32 v124, v124
    v_rcp_f32 v125, v125
    v_rcp_f32 v126, v126
    v_rcp_f32 v127, v127
    v_pk_mul_f32 v[192:193], v[192:193], v[128:129]
    v_pk_mul_f32 v[194:195], v[194:195], v[130:131]
    v_pk_mul_f32 v[208:209], v[208:209], v[144:145]
    v_pk_mul_f32 v[210:211], v[210:211], v[146:147]
    v_pk_mul_f32 v[192:193], v[192:193], v[120:121]
    v_pk_mul_f32 v[194:195], v[194:195], v[122:123]
    v_pk_mul_f32 v[208:209], v[208:209], v[124:125]
    v_pk_mul_f32 v[210:211], v[210:211], v[126:127]
    v_cvt_pk_bf16_f32 v128, v192, v193
    v_cvt_pk_bf16_f32 v129, v194, v195
    v_cvt_pk_bf16_f32 v130, v208, v209
    v_cvt_pk_bf16_f32 v131, v210, v211
    buffer_store_dwordx4 v[128:131], v2, s[16:19], s81 offen offset:0 sc1
    v_pk_mul_f32 v[120:121], v[132:133], v[132:133]
    v_pk_mul_f32 v[122:123], v[134:135], v[134:135]
    v_pk_mul_f32 v[124:125], v[148:149], v[148:149]
    v_pk_mul_f32 v[126:127], v[150:151], v[150:151]
    v_pk_fma_f32 v[120:121], v[120:121], v[48:49], v[48:49] op_sel:[0,0,1] op_sel_hi:[1,0,1]
    v_pk_fma_f32 v[122:123], v[122:123], v[48:49], v[48:49] op_sel:[0,0,1] op_sel_hi:[1,0,1]
    v_pk_fma_f32 v[124:125], v[124:125], v[48:49], v[48:49] op_sel:[0,0,1] op_sel_hi:[1,0,1]
    v_pk_fma_f32 v[126:127], v[126:127], v[48:49], v[48:49] op_sel:[0,0,1] op_sel_hi:[1,0,1]
    v_pk_mul_f32 v[120:121], v[120:121], v[132:133]
    v_pk_mul_f32 v[122:123], v[122:123], v[134:135]
    v_pk_mul_f32 v[124:125], v[124:125], v[148:149]
    v_pk_mul_f32 v[126:127], v[126:127], v[150:151]
    v_exp_f32 v120, v120
    v_exp_f32 v121, v121
    v_exp_f32 v122, v122
    v_exp_f32 v123, v123
    v_exp_f32 v124, v124
    v_exp_f32 v125, v125
    v_exp_f32 v126, v126
    v_exp_f32 v127, v127
    v_pk_fma_f32 v[120:121], v[120:121], v[50:51], v[50:51] op_sel:[0,1,1] op_sel_hi:[1,1,1]
    v_pk_fma_f32 v[122:123], v[122:123], v[50:51], v[50:51] op_sel:[0,1,1] op_sel_hi:[1,1,1]
    v_pk_fma_f32 v[124:125], v[124:125], v[50:51], v[50:51] op_sel:[0,1,1] op_sel_hi:[1,1,1]
    v_pk_fma_f32 v[126:127], v[126:127], v[50:51], v[50:51] op_sel:[0,1,1] op_sel_hi:[1,1,1]
    v_rcp_f32 v120, v120
    v_rcp_f32 v121, v121
    v_rcp_f32 v122, v122
    v_rcp_f32 v123, v123
    v_rcp_f32 v124, v124
    v_rcp_f32 v125, v125
    v_rcp_f32 v126, v126
    v_rcp_f32 v127, v127
    v_pk_mul_f32 v[196:197], v[196:197], v[132:133]
    v_pk_mul_f32 v[198:199], v[198:199], v[134:135]
    v_pk_mul_f32 v[212:213], v[212:213], v[148:149]
    v_pk_mul_f32 v[214:215], v[214:215], v[150:151]
    v_pk_mul_f32 v[196:197], v[196:197], v[120:121]
    v_pk_mul_f32 v[198:199], v[198:199], v[122:123]
    v_pk_mul_f32 v[212:213], v[212:213], v[124:125]
    v_pk_mul_f32 v[214:215], v[214:215], v[126:127]
    v_cvt_pk_bf16_f32 v132, v196, v197
    v_cvt_pk_bf16_f32 v133, v198, v199
    v_cvt_pk_bf16_f32 v134, v212, v213
    v_cvt_pk_bf16_f32 v135, v214, v215
    buffer_store_dwordx4 v[132:135], v2, s[16:19], s81 offen offset:1024 sc1
    v_pk_mul_f32 v[120:121], v[136:137], v[136:137]
    v_pk_mul_f32 v[122:123], v[138:139], v[138:139]
    v_pk_mul_f32 v[124:125], v[152:153], v[152:153]
    v_pk_mul_f32 v[126:127], v[154:155], v[154:155]
    v_pk_fma_f32 v[120:121], v[120:121], v[12:13], v[12:13] op_sel:[0,0,1] op_sel_hi:[1,0,1]
    v_pk_fma_f32 v[122:123], v[122:123], v[12:13], v[12:13] op_sel:[0,0,1] op_sel_hi:[1,0,1]
    v_pk_fma_f32 v[124:125], v[124:125], v[12:13], v[12:13] op_sel:[0,0,1] op_sel_hi:[1,0,1]
    v_pk_fma_f32 v[126:127], v[126:127], v[12:13], v[12:13] op_sel:[0,0,1] op_sel_hi:[1,0,1]
    v_pk_mul_f32 v[120:121], v[120:121], v[136:137]
    v_pk_mul_f32 v[122:123], v[122:123], v[138:139]
    v_pk_mul_f32 v[124:125], v[124:125], v[152:153]
    v_pk_mul_f32 v[126:127], v[126:127], v[154:155]
    v_exp_f32 v120, v120
    v_exp_f32 v121, v121
    v_exp_f32 v122, v122
    v_exp_f32 v123, v123
    v_exp_f32 v124, v124
    v_exp_f32 v125, v125
    v_exp_f32 v126, v126
    v_exp_f32 v127, v127
    v_pk_fma_f32 v[120:121], v[120:121], v[14:15], v[14:15] op_sel:[0,1,1] op_sel_hi:[1,1,1]
    v_pk_fma_f32 v[122:123], v[122:123], v[14:15], v[14:15] op_sel:[0,1,1] op_sel_hi:[1,1,1]
    v_pk_fma_f32 v[124:125], v[124:125], v[14:15], v[14:15] op_sel:[0,1,1] op_sel_hi:[1,1,1]
    v_pk_fma_f32 v[126:127], v[126:127], v[14:15], v[14:15] op_sel:[0,1,1] op_sel_hi:[1,1,1]
    v_rcp_f32 v120, v120
    v_rcp_f32 v121, v121
    v_rcp_f32 v122, v122
    v_rcp_f32 v123, v123
    v_rcp_f32 v124, v124
    v_rcp_f32 v125, v125
    v_rcp_f32 v126, v126
    v_rcp_f32 v127, v127
    v_pk_mul_f32 v[200:201], v[200:201], v[136:137]
    v_pk_mul_f32 v[202:203], v[202:203], v[138:139]
    v_pk_mul_f32 v[216:217], v[216:217], v[152:153]
    v_pk_mul_f32 v[218:219], v[218:219], v[154:155]
    v_pk_mul_f32 v[200:201], v[200:201], v[120:121]
    v_pk_mul_f32 v[202:203], v[202:203], v[122:123]
    v_pk_mul_f32 v[216:217], v[216:217], v[124:125]
    v_pk_mul_f32 v[218:219], v[218:219], v[126:127]
    v_cvt_pk_bf16_f32 v136, v200, v201
    v_cvt_pk_bf16_f32 v137, v202, v203
    v_cvt_pk_bf16_f32 v138, v216, v217
    v_cvt_pk_bf16_f32 v139, v218, v219
    buffer_store_dwordx4 v[136:139], v2, s[16:19], s81 offen offset:2048 sc1
    v_pk_mul_f32 v[120:121], v[140:141], v[140:141]
    v_pk_mul_f32 v[122:123], v[142:143], v[142:143]
    v_pk_mul_f32 v[124:125], v[156:157], v[156:157]
    v_pk_mul_f32 v[126:127], v[158:159], v[158:159]
    v_pk_fma_f32 v[120:121], v[120:121], v[16:17], v[16:17] op_sel:[0,0,1] op_sel_hi:[1,0,1]
    v_pk_fma_f32 v[122:123], v[122:123], v[16:17], v[16:17] op_sel:[0,0,1] op_sel_hi:[1,0,1]
    v_pk_fma_f32 v[124:125], v[124:125], v[16:17], v[16:17] op_sel:[0,0,1] op_sel_hi:[1,0,1]
    v_pk_fma_f32 v[126:127], v[126:127], v[16:17], v[16:17] op_sel:[0,0,1] op_sel_hi:[1,0,1]
    v_pk_mul_f32 v[120:121], v[120:121], v[140:141]
    v_pk_mul_f32 v[122:123], v[122:123], v[142:143]
    v_pk_mul_f32 v[124:125], v[124:125], v[156:157]
    v_pk_mul_f32 v[126:127], v[126:127], v[158:159]
    v_exp_f32 v120, v120
    v_exp_f32 v121, v121
    v_exp_f32 v122, v122
    v_exp_f32 v123, v123
    v_exp_f32 v124, v124
    v_exp_f32 v125, v125
    v_exp_f32 v126, v126
    v_exp_f32 v127, v127
    v_pk_fma_f32 v[120:121], v[120:121], v[18:19], v[18:19] op_sel:[0,1,1] op_sel_hi:[1,1,1]
    v_pk_fma_f32 v[122:123], v[122:123], v[18:19], v[18:19] op_sel:[0,1,1] op_sel_hi:[1,1,1]
    v_pk_fma_f32 v[124:125], v[124:125], v[18:19], v[18:19] op_sel:[0,1,1] op_sel_hi:[1,1,1]
    v_pk_fma_f32 v[126:127], v[126:127], v[18:19], v[18:19] op_sel:[0,1,1] op_sel_hi:[1,1,1]
    v_rcp_f32 v120, v120
    v_rcp_f32 v121, v121
    v_rcp_f32 v122, v122
    v_rcp_f32 v123, v123
    v_rcp_f32 v124, v124
    v_rcp_f32 v125, v125
    v_rcp_f32 v126, v126
    v_rcp_f32 v127, v127
    v_pk_mul_f32 v[204:205], v[204:205], v[140:141]
    v_pk_mul_f32 v[206:207], v[206:207], v[142:143]
    v_pk_mul_f32 v[220:221], v[220:221], v[156:157]
    v_pk_mul_f32 v[222:223], v[222:223], v[158:159]
    v_pk_mul_f32 v[204:205], v[204:205], v[120:121]
    v_pk_mul_f32 v[206:207], v[206:207], v[122:123]
    v_pk_mul_f32 v[220:221], v[220:221], v[124:125]
    v_pk_mul_f32 v[222:223], v[222:223], v[126:127]
    v_cvt_pk_bf16_f32 v140, v204, v205
    v_cvt_pk_bf16_f32 v141, v206, v207
    v_cvt_pk_bf16_f32 v142, v220, v221
    v_cvt_pk_bf16_f32 v143, v222, v223
    buffer_store_dwordx4 v[140:143], v2, s[16:19], s81 offen offset:3072 sc1
    s_add_u32 s81, s81, 4096
    ds_read_b128 v[192:195], v30 offset:128
    ds_read_b128 v[196:199], v30 offset:192
    ds_read_b128 v[200:203], v30 offset:576
    ds_read_b128 v[204:207], v30 offset:640
    s_waitcnt vmcnt(5)
    s_barrier
    s_add_u32 m0, s60, 65536
    s_nop 0
    s_nop 0
    buffer_load_dwordx4 v3, s[24:27], s71 offen offset:0  lds
    buffer_load_dwordx4 v4, s[24:27], s71 offen offset:1024  lds
    buffer_load_dwordx4 v5, s[24:27], s71 offen offset:2048  lds
    buffer_load_dwordx4 v6, s[24:27], s71 offen offset:3072  lds
    s_add_u32 m0, s60, 69632
    s_nop 0
    s_nop 0
    buffer_load_dwordx4 v7, s[24:27], s71 offen offset:0  lds
    buffer_load_dwordx4 v8, s[24:27], s71 offen offset:1024  lds
    buffer_load_dwordx4 v9, s[24:27], s71 offen offset:2048  lds
    buffer_load_dwordx4 v10, s[24:27], s71 offen offset:3072  lds
    s_add_u32 s3, s3, 4
    s_add_u32 s88, s3, 3
    s_cmp_ge_u32 s3, s72
    s_cselect_b32 s71, s88, s3
    s_add_u32 s88, s71, 3
    s_mul_i32 s88, s88, 43
    s_lshr_b32 s88, s88, 8
    s_add_u32 s71, s71, s88
    s_lshl_b32 s71, s71, 16
    s_add_u32 s71, s71, s89
    s_waitcnt lgkmcnt(3)
    s_nop 0
    v_pk_fma_f32 v[160:161], v[192:193], v[46:47], v[160:161] op_sel_hi:[1,0,1] neg_lo:[0,1,0] neg_hi:[0,1,0]
    v_pk_fma_f32 v[162:163], v[194:195], v[46:47], v[162:163] op_sel_hi:[1,0,1] neg_lo:[0,1,0] neg_hi:[0,1,0]
    v_pk_fma_f32 v[164:165], v[192:193], v[50:51], v[164:165] op_sel_hi:[1,0,1] neg_lo:[0,1,0] neg_hi:[0,1,0]
    v_pk_fma_f32 v[166:167], v[194:195], v[50:51], v[166:167] op_sel_hi:[1,0,1] neg_lo:[0,1,0] neg_hi:[0,1,0]
    v_pk_fma_f32 v[168:169], v[192:193], v[14:15], v[168:169] op_sel_hi:[1,0,1] neg_lo:[0,1,0] neg_hi:[0,1,0]
    v_pk_fma_f32 v[170:171], v[194:195], v[14:15], v[170:171] op_sel_hi:[1,0,1] neg_lo:[0,1,0] neg_hi:[0,1,0]
    v_pk_fma_f32 v[172:173], v[192:193], v[18:19], v[172:173] op_sel_hi:[1,0,1] neg_lo:[0,1,0] neg_hi:[0,1,0]
    v_pk_fma_f32 v[174:175], v[194:195], v[18:19], v[174:175] op_sel_hi:[1,0,1] neg_lo:[0,1,0] neg_hi:[0,1,0]
    s_waitcnt lgkmcnt(2)
    s_nop 0
    v_pk_fma_f32 v[176:177], v[196:197], v[46:47], v[176:177] op_sel_hi:[1,0,1] neg_lo:[0,1,0] neg_hi:[0,1,0]
    v_pk_fma_f32 v[178:179], v[198:199], v[46:47], v[178:179] op_sel_hi:[1,0,1] neg_lo:[0,1,0] neg_hi:[0,1,0]
    v_pk_fma_f32 v[180:181], v[196:197], v[50:51], v[180:181] op_sel_hi:[1,0,1] neg_lo:[0,1,0] neg_hi:[0,1,0]
    v_pk_fma_f32 v[182:183], v[198:199], v[50:51], v[182:183] op_sel_hi:[1,0,1] neg_lo:[0,1,0] neg_hi:[0,1,0]
    v_pk_fma_f32 v[184:185], v[196:197], v[14:15], v[184:185] op_sel_hi:[1,0,1] neg_lo:[0,1,0] neg_hi:[0,1,0]
    v_pk_fma_f32 v[186:187], v[198:199], v[14:15], v[186:187] op_sel_hi:[1,0,1] neg_lo:[0,1,0] neg_hi:[0,1,0]
    v_pk_fma_f32 v[188:189], v[196:197], v[18:19], v[188:189] op_sel_hi:[1,0,1] neg_lo:[0,1,0] neg_hi:[0,1,0]
    v_pk_fma_f32 v[190:191], v[198:199], v[18:19], v[190:191] op_sel_hi:[1,0,1] neg_lo:[0,1,0] neg_hi:[0,1,0]
    s_waitcnt lgkmcnt(1)
    s_nop 0
    v_pk_fma_f32 v[224:225], v[200:201], v[46:47], v[224:225] op_sel_hi:[1,0,1] neg_lo:[0,1,0] neg_hi:[0,1,0]
    v_pk_fma_f32 v[226:227], v[202:203], v[46:47], v[226:227] op_sel_hi:[1,0,1] neg_lo:[0,1,0] neg_hi:[0,1,0]
    v_pk_fma_f32 v[228:229], v[200:201], v[50:51], v[228:229] op_sel_hi:[1,0,1] neg_lo:[0,1,0] neg_hi:[0,1,0]
    v_pk_fma_f32 v[230:231], v[202:203], v[50:51], v[230:231] op_sel_hi:[1,0,1] neg_lo:[0,1,0] neg_hi:[0,1,0]
    v_pk_fma_f32 v[232:233], v[200:201], v[14:15], v[232:233] op_sel_hi:[1,0,1] neg_lo:[0,1,0] neg_hi:[0,1,0]
    v_pk_fma_f32 v[234:235], v[202:203], v[14:15], v[234:235] op_sel_hi:[1,0,1] neg_lo:[0,1,0] neg_hi:[0,1,0]
    v_pk_fma_f32 v[236:237], v[200:201], v[18:19], v[236:237] op_sel_hi:[1,0,1] neg_lo:[0,1,0] neg_hi:[0,1,0]
    v_pk_fma_f32 v[238:239], v[202:203], v[18:19], v[238:239] op_sel_hi:[1,0,1] neg_lo:[0,1,0] neg_hi:[0,1,0]
    s_waitcnt lgkmcnt(0)
    s_nop 0
    v_pk_fma_f32 v[240:241], v[204:205], v[46:47], v[240:241] op_sel_hi:[1,0,1] neg_lo:[0,1,0] neg_hi:[0,1,0]
    v_pk_fma_f32 v[242:243], v[206:207], v[46:47], v[242:243] op_sel_hi:[1,0,1] neg_lo:[0,1,0] neg_hi:[0,1,0]
    v_pk_fma_f32 v[244:245], v[204:205], v[50:51], v[244:245] op_sel_hi:[1,0,1] neg_lo:[0,1,0] neg_hi:[0,1,0]
    v_pk_fma_f32 v[246:247], v[206:207], v[50:51], v[246:247] op_sel_hi:[1,0,1] neg_lo:[0,1,0] neg_hi:[0,1,0]
    v_pk_fma_f32 v[248:249], v[204:205], v[14:15], v[248:249] op_sel_hi:[1,0,1] neg_lo:[0,1,0] neg_hi:[0,1,0]
    v_pk_fma_f32 v[250:251], v[206:207], v[14:15], v[250:251] op_sel_hi:[1,0,1] neg_lo:[0,1,0] neg_hi:[0,1,0]
    v_pk_fma_f32 v[252:253], v[204:205], v[18:19], v[252:253] op_sel_hi:[1,0,1] neg_lo:[0,1,0] neg_hi:[0,1,0]
    v_pk_fma_f32 v[254:255], v[206:207], v[18:19], v[254:255] op_sel_hi:[1,0,1] neg_lo:[0,1,0] neg_hi:[0,1,0]
    v_pk_mul_f32 v[120:121], v[160:161], v[160:161]
    v_pk_mul_f32 v[122:123], v[162:163], v[162:163]
    v_pk_mul_f32 v[124:125], v[176:177], v[176:177]
    v_pk_mul_f32 v[126:127], v[178:179], v[178:179]
    v_pk_fma_f32 v[120:121], v[120:121], v[44:45], v[44:45] op_sel:[0,0,1] op_sel_hi:[1,0,1]
    v_pk_fma_f32 v[122:123], v[122:123], v[44:45], v[44:45] op_sel:[0,0,1] op_sel_hi:[1,0,1]
    v_pk_fma_f32 v[124:125], v[124:125], v[44:45], v[44:45] op_sel:[0,0,1] op_sel_hi:[1,0,1]
    v_pk_fma_f32 v[126:127], v[126:127], v[44:45], v[44:45] op_sel:[0,0,1] op_sel_hi:[1,0,1]
    v_pk_mul_f32 v[120:121], v[120:121], v[160:161]
    v_pk_mul_f32 v[122:123], v[122:123], v[162:163]
    v_pk_mul_f32 v[124:125], v[124:125], v[176:177]
    v_pk_mul_f32 v[126:127], v[126:127], v[178:179]
    v_exp_f32 v120, v120
    v_exp_f32 v121, v121
    v_exp_f32 v122, v122
    v_exp_f32 v123, v123
    v_exp_f32 v124, v124
    v_exp_f32 v125, v125
    v_exp_f32 v126, v126
    v_exp_f32 v127, v127
    v_pk_fma_f32 v[120:121], v[120:121], v[46:47], v[46:47] op_sel:[0,1,1] op_sel_hi:[1,1,1]
    v_pk_fma_f32 v[122:123], v[122:123], v[46:47], v[46:47] op_sel:[0,1,1] op_sel_hi:[1,1,1]
    v_pk_fma_f32 v[124:125], v[124:125], v[46:47], v[46:47] op_sel:[0,1,1] op_sel_hi:[1,1,1]
    v_pk_fma_f32 v[126:127], v[126:127], v[46:47], v[46:47] op_sel:[0,1,1] op_sel_hi:[1,1,1]
    v_rcp_f32 v120, v120
    v_rcp_f32 v121, v121
    v_rcp_f32 v122, v122
    v_rcp_f32 v123, v123
    v_rcp_f32 v124, v124
    v_rcp_f32 v125, v125
    v_rcp_f32 v126, v126
    v_rcp_f32 v127, v127
    v_pk_mul_f32 v[224:225], v[224:225], v[160:161]
    v_pk_mul_f32 v[226:227], v[226:227], v[162:163]
    v_pk_mul_f32 v[240:241], v[240:241], v[176:177]
    v_pk_mul_f32 v[242:243], v[242:243], v[178:179]
    v_pk_mul_f32 v[224:225], v[224:225], v[120:121]
    v_pk_mul_f32 v[226:227], v[226:227], v[122:123]
    v_pk_mul_f32 v[240:241], v[240:241], v[124:125]
    v_pk_mul_f32 v[242:243], v[242:243], v[126:127]
    v_cvt_pk_bf16_f32 v160, v224, v225
    v_cvt_pk_bf16_f32 v161, v226, v227
    v_cvt_pk_bf16_f32 v162, v240, v241
    v_cvt_pk_bf16_f32 v163, v242, v243
    buffer_store_dwordx4 v[160:163], v2, s[16:19], s81 offen offset:0 sc1
    v_pk_mul_f32 v[120:121], v[164:165], v[164:165]
    v_pk_mul_f32 v[122:123], v[166:167], v[166:167]
    v_pk_mul_f32 v[124:125], v[180:181], v[180:181]
    v_pk_mul_f32 v[126:127], v[182:183], v[182:183]
    v_pk_fma_f32 v[120:121], v[120:121], v[48:49], v[48:49] op_sel:[0,0,1] op_sel_hi:[1,0,1]
    v_pk_fma_f32 v[122:123], v[122:123], v[48:49], v[48:49] op_sel:[0,0,1] op_sel_hi:[1,0,1]
    v_pk_fma_f32 v[124:125], v[124:125], v[48:49], v[48:49] op_sel:[0,0,1] op_sel_hi:[1,0,1]
    v_pk_fma_f32 v[126:127], v[126:127], v[48:49], v[48:49] op_sel:[0,0,1] op_sel_hi:[1,0,1]
    v_pk_mul_f32 v[120:121], v[120:121], v[164:165]
    v_pk_mul_f32 v[122:123], v[122:123], v[166:167]
    v_pk_mul_f32 v[124:125], v[124:125], v[180:181]
    v_pk_mul_f32 v[126:127], v[126:127], v[182:183]
    v_exp_f32 v120, v120
    v_exp_f32 v121, v121
    v_exp_f32 v122, v122
    v_exp_f32 v123, v123
    v_exp_f32 v124, v124
    v_exp_f32 v125, v125
    v_exp_f32 v126, v126
    v_exp_f32 v127, v127
    v_pk_fma_f32 v[120:121], v[120:121], v[50:51], v[50:51] op_sel:[0,1,1] op_sel_hi:[1,1,1]
    v_pk_fma_f32 v[122:123], v[122:123], v[50:51], v[50:51] op_sel:[0,1,1] op_sel_hi:[1,1,1]
    v_pk_fma_f32 v[124:125], v[124:125], v[50:51], v[50:51] op_sel:[0,1,1] op_sel_hi:[1,1,1]
    v_pk_fma_f32 v[126:127], v[126:127], v[50:51], v[50:51] op_sel:[0,1,1] op_sel_hi:[1,1,1]
    v_rcp_f32 v120, v120
    v_rcp_f32 v121, v121
    v_rcp_f32 v122, v122
    v_rcp_f32 v123, v123
    v_rcp_f32 v124, v124
    v_rcp_f32 v125, v125
    v_rcp_f32 v126, v126
    v_rcp_f32 v127, v127
    v_pk_mul_f32 v[228:229], v[228:229], v[164:165]
    v_pk_mul_f32 v[230:231], v[230:231], v[166:167]
    v_pk_mul_f32 v[244:245], v[244:245], v[180:181]
    v_pk_mul_f32 v[246:247], v[246:247], v[182:183]
    v_pk_mul_f32 v[228:229], v[228:229], v[120:121]
    v_pk_mul_f32 v[230:231], v[230:231], v[122:123]
    v_pk_mul_f32 v[244:245], v[244:245], v[124:125]
    v_pk_mul_f32 v[246:247], v[246:247], v[126:127]
    v_cvt_pk_bf16_f32 v164, v228, v229
    v_cvt_pk_bf16_f32 v165, v230, v231
    v_cvt_pk_bf16_f32 v166, v244, v245
    v_cvt_pk_bf16_f32 v167, v246, v247
    buffer_store_dwordx4 v[164:167], v2, s[16:19], s81 offen offset:1024 sc1
    v_pk_mul_f32 v[120:121], v[168:169], v[168:169]
    v_pk_mul_f32 v[122:123], v[170:171], v[170:171]
    v_pk_mul_f32 v[124:125], v[184:185], v[184:185]
    v_pk_mul_f32 v[126:127], v[186:187], v[186:187]
    v_pk_fma_f32 v[120:121], v[120:121], v[12:13], v[12:13] op_sel:[0,0,1] op_sel_hi:[1,0,1]
    v_pk_fma_f32 v[122:123], v[122:123], v[12:13], v[12:13] op_sel:[0,0,1] op_sel_hi:[1,0,1]
    v_pk_fma_f32 v[124:125], v[124:125], v[12:13], v[12:13] op_sel:[0,0,1] op_sel_hi:[1,0,1]
    v_pk_fma_f32 v[126:127], v[126:127], v[12:13], v[12:13] op_sel:[0,0,1] op_sel_hi:[1,0,1]
    v_pk_mul_f32 v[120:121], v[120:121], v[168:169]
    v_pk_mul_f32 v[122:123], v[122:123], v[170:171]
    v_pk_mul_f32 v[124:125], v[124:125], v[184:185]
    v_pk_mul_f32 v[126:127], v[126:127], v[186:187]
    v_exp_f32 v120, v120
    v_exp_f32 v121, v121
    v_exp_f32 v122, v122
    v_exp_f32 v123, v123
    v_exp_f32 v124, v124
    v_exp_f32 v125, v125
    v_exp_f32 v126, v126
    v_exp_f32 v127, v127
    v_pk_fma_f32 v[120:121], v[120:121], v[14:15], v[14:15] op_sel:[0,1,1] op_sel_hi:[1,1,1]
    v_pk_fma_f32 v[122:123], v[122:123], v[14:15], v[14:15] op_sel:[0,1,1] op_sel_hi:[1,1,1]
    v_pk_fma_f32 v[124:125], v[124:125], v[14:15], v[14:15] op_sel:[0,1,1] op_sel_hi:[1,1,1]
    v_pk_fma_f32 v[126:127], v[126:127], v[14:15], v[14:15] op_sel:[0,1,1] op_sel_hi:[1,1,1]
    v_rcp_f32 v120, v120
    v_rcp_f32 v121, v121
    v_rcp_f32 v122, v122
    v_rcp_f32 v123, v123
    v_rcp_f32 v124, v124
    v_rcp_f32 v125, v125
    v_rcp_f32 v126, v126
    v_rcp_f32 v127, v127
    v_pk_mul_f32 v[232:233], v[232:233], v[168:169]
    v_pk_mul_f32 v[234:235], v[234:235], v[170:171]
    v_pk_mul_f32 v[248:249], v[248:249], v[184:185]
    v_pk_mul_f32 v[250:251], v[250:251], v[186:187]
    v_pk_mul_f32 v[232:233], v[232:233], v[120:121]
    v_pk_mul_f32 v[234:235], v[234:235], v[122:123]
    v_pk_mul_f32 v[248:249], v[248:249], v[124:125]
    v_pk_mul_f32 v[250:251], v[250:251], v[126:127]
    v_cvt_pk_bf16_f32 v168, v232, v233
    v_cvt_pk_bf16_f32 v169, v234, v235
    v_cvt_pk_bf16_f32 v170, v248, v249
    v_cvt_pk_bf16_f32 v171, v250, v251
    buffer_store_dwordx4 v[168:171], v2, s[16:19], s81 offen offset:2048 sc1
    v_pk_mul_f32 v[120:121], v[172:173], v[172:173]
    v_pk_mul_f32 v[122:123], v[174:175], v[174:175]
    v_pk_mul_f32 v[124:125], v[188:189], v[188:189]
    v_pk_mul_f32 v[126:127], v[190:191], v[190:191]
    v_pk_fma_f32 v[120:121], v[120:121], v[16:17], v[16:17] op_sel:[0,0,1] op_sel_hi:[1,0,1]
    v_pk_fma_f32 v[122:123], v[122:123], v[16:17], v[16:17] op_sel:[0,0,1] op_sel_hi:[1,0,1]
    v_pk_fma_f32 v[124:125], v[124:125], v[16:17], v[16:17] op_sel:[0,0,1] op_sel_hi:[1,0,1]
    v_pk_fma_f32 v[126:127], v[126:127], v[16:17], v[16:17] op_sel:[0,0,1] op_sel_hi:[1,0,1]
    v_pk_mul_f32 v[120:121], v[120:121], v[172:173]
    v_pk_mul_f32 v[122:123], v[122:123], v[174:175]
    v_pk_mul_f32 v[124:125], v[124:125], v[188:189]
    v_pk_mul_f32 v[126:127], v[126:127], v[190:191]
    v_exp_f32 v120, v120
    v_exp_f32 v121, v121
    v_exp_f32 v122, v122
    v_exp_f32 v123, v123
    v_exp_f32 v124, v124
    v_exp_f32 v125, v125
    v_exp_f32 v126, v126
    v_exp_f32 v127, v127
    v_pk_fma_f32 v[120:121], v[120:121], v[18:19], v[18:19] op_sel:[0,1,1] op_sel_hi:[1,1,1]
    v_pk_fma_f32 v[122:123], v[122:123], v[18:19], v[18:19] op_sel:[0,1,1] op_sel_hi:[1,1,1]
    v_pk_fma_f32 v[124:125], v[124:125], v[18:19], v[18:19] op_sel:[0,1,1] op_sel_hi:[1,1,1]
    v_pk_fma_f32 v[126:127], v[126:127], v[18:19], v[18:19] op_sel:[0,1,1] op_sel_hi:[1,1,1]
    v_rcp_f32 v120, v120
    v_rcp_f32 v121, v121
    v_rcp_f32 v122, v122
    v_rcp_f32 v123, v123
    v_rcp_f32 v124, v124
    v_rcp_f32 v125, v125
    v_rcp_f32 v126, v126
    v_rcp_f32 v127, v127
    v_pk_mul_f32 v[236:237], v[236:237], v[172:173]
    v_pk_mul_f32 v[238:239], v[238:239], v[174:175]
    v_pk_mul_f32 v[252:253], v[252:253], v[188:189]
    v_pk_mul_f32 v[254:255], v[254:255], v[190:191]
    v_pk_mul_f32 v[236:237], v[236:237], v[120:121]
    v_pk_mul_f32 v[238:239], v[238:239], v[122:123]
    v_pk_mul_f32 v[252:253], v[252:253], v[124:125]
    v_pk_mul_f32 v[254:255], v[254:255], v[126:127]
    v_cvt_pk_bf16_f32 v172, v236, v237
    v_cvt_pk_bf16_f32 v173, v238, v239
    v_cvt_pk_bf16_f32 v174, v252, v253
    v_cvt_pk_bf16_f32 v175, v254, v255
    buffer_store_dwordx4 v[172:175], v2, s[16:19], s81 offen offset:3072 sc1
    s_add_u32 s81, s81, 4096
    ds_read_b128 v[176:179], v30 offset:256
    ds_read_b128 v[180:183], v30 offset:320
    ds_read_b128 v[184:187], v30 offset:704
    ds_read_b128 v[188:191], v30 offset:768
    ds_read_b128 v[248:251], v31 offset:384
    ds_read_b128 v[252:255], v31 offset:832
    v_lshrrev_b32 v0, 4, v1
    v_and_b32 v120, 15, v1
    v_lshlrev_b32 v0, 11, v0
    v_lshl_add_u32 v0, v120, 4, v0
    s_sub_u32 s84, 32, s49
    s_lshl_b32 s84, s84, 8
    v_add_u32 v0, s84, v0
    buffer_load_dwordx4 v[192:195], v0, s[20:23], 0 offen offset:0 sc1
    buffer_load_dwordx4 v[196:199], v0, s[20:23], 0 offen offset:256 sc1
    buffer_load_dwordx4 v[200:203], v0, s[20:23], 0 offen offset:512 sc1
    buffer_load_dwordx4 v[204:207], v0, s[20:23], 0 offen offset:768 sc1
    buffer_load_dwordx4 v[208:211], v0, s[20:23], 0 offen offset:1024 sc1
    buffer_load_dwordx4 v[212:215], v0, s[20:23], 0 offen offset:1280 sc1
    buffer_load_dwordx4 v[216:219], v0, s[20:23], 0 offen offset:1536 sc1
    buffer_load_dwordx4 v[220:223], v0, s[20:23], 0 offen offset:1792 sc1
    v_accvgpr_read_b32 v224, a0
    v_accvgpr_read_b32 v225, a1
    v_accvgpr_read_b32 v226, a2
    v_accvgpr_read_b32 v227, a3
    v_accvgpr_read_b32 v228, a16
    v_accvgpr_read_b32 v229, a17
    v_accvgpr_read_b32 v230, a18
    v_accvgpr_read_b32 v231, a19
    s_waitcnt lgkmcnt(2)
    s_nop 0
    v_pk_fma_f32 v[224:225], v[176:177], v[46:47], v[224:225] op_sel_hi:[1,0,1] neg_lo:[0,1,0] neg_hi:[0,1,0]
    v_pk_fma_f32 v[226:227], v[178:179], v[46:47], v[226:227] op_sel_hi:[1,0,1] neg_lo:[0,1,0] neg_hi:[0,1,0]
    v_pk_fma_f32 v[228:229], v[180:181], v[46:47], v[228:229] op_sel_hi:[1,0,1] neg_lo:[0,1,0] neg_hi:[0,1,0]
    v_pk_fma_f32 v[230:231], v[182:183], v[46:47], v[230:231] op_sel_hi:[1,0,1] neg_lo:[0,1,0] neg_hi:[0,1,0]
    v_pk_mul_f32 v[120:121], v[224:225], v[224:225]
    v_pk_mul_f32 v[122:123], v[226:227], v[226:227]
    v_pk_mul_f32 v[124:125], v[228:229], v[228:229]
    v_pk_mul_f32 v[126:127], v[230:231], v[230:231]
    v_pk_fma_f32 v[120:121], v[120:121], v[44:45], v[44:45] op_sel:[0,0,1] op_sel_hi:[1,0,1]
    v_pk_fma_f32 v[122:123], v[122:123], v[44:45], v[44:45] op_sel:[0,0,1] op_sel_hi:[1,0,1]
    v_pk_fma_f32 v[124:125], v[124:125], v[44:45], v[44:45] op_sel:[0,0,1] op_sel_hi:[1,0,1]
    v_pk_fma_f32 v[126:127], v[126:127], v[44:45], v[44:45] op_sel:[0,0,1] op_sel_hi:[1,0,1]
    v_pk_mul_f32 v[120:121], v[120:121], v[224:225]
    v_pk_mul_f32 v[122:123], v[122:123], v[226:227]
    v_pk_mul_f32 v[124:125], v[124:125], v[228:229]
    v_pk_mul_f32 v[126:127], v[126:127], v[230:231]
    v_exp_f32 v120, v120
    v_exp_f32 v121, v121
    v_exp_f32 v122, v122
    v_exp_f32 v123, v123
    v_exp_f32 v124, v124
    v_exp_f32 v125, v125
    v_exp_f32 v126, v126
    v_exp_f32 v127, v127
    v_accvgpr_read_b32 v232, a48
    v_accvgpr_read_b32 v233, a49
    v_accvgpr_read_b32 v234, a50
    v_accvgpr_read_b32 v235, a51
    v_accvgpr_read_b32 v236, a64
    v_accvgpr_read_b32 v237, a65
    v_accvgpr_read_b32 v238, a66
    v_accvgpr_read_b32 v239, a67
    v_pk_fma_f32 v[232:233], v[184:185], v[46:47], v[232:233] op_sel_hi:[1,0,1] neg_lo:[0,1,0] neg_hi:[0,1,0]
    v_pk_fma_f32 v[234:235], v[186:187], v[46:47], v[234:235] op_sel_hi:[1,0,1] neg_lo:[0,1,0] neg_hi:[0,1,0]
    v_pk_fma_f32 v[236:237], v[188:189], v[46:47], v[236:237] op_sel_hi:[1,0,1] neg_lo:[0,1,0] neg_hi:[0,1,0]
    v_pk_fma_f32 v[238:239], v[190:191], v[46:47], v[238:239] op_sel_hi:[1,0,1] neg_lo:[0,1,0] neg_hi:[0,1,0]
    v_pk_fma_f32 v[120:121], v[120:121], v[46:47], v[46:47] op_sel:[0,1,1] op_sel_hi:[1,1,1]
    v_pk_fma_f32 v[122:123], v[122:123], v[46:47], v[46:47] op_sel:[0,1,1] op_sel_hi:[1,1,1]
    v_pk_fma_f32 v[124:125], v[124:125], v[46:47], v[46:47] op_sel:[0,1,1] op_sel_hi:[1,1,1]
    v_pk_fma_f32 v[126:127], v[126:127], v[46:47], v[46:47] op_sel:[0,1,1] op_sel_hi:[1,1,1]
    v_rcp_f32 v120, v120
    v_rcp_f32 v121, v121
    v_rcp_f32 v122, v122
    v_rcp_f32 v123, v123
    v_rcp_f32 v124, v124
    v_rcp_f32 v125, v125
    v_rcp_f32 v126, v126
    v_rcp_f32 v127, v127
    v_pk_mul_f32 v[232:233], v[232:233], v[224:225]
    v_pk_mul_f32 v[234:235], v[234:235], v[226:227]
    v_pk_mul_f32 v[236:237], v[236:237], v[228:229]
    v_pk_mul_f32 v[238:239], v[238:239], v[230:231]
    v_pk_mul_f32 v[232:233], v[232:233], v[120:121]
    v_pk_mul_f32 v[234:235], v[234:235], v[122:123]
    v_pk_mul_f32 v[236:237], v[236:237], v[124:125]
    v_pk_mul_f32 v[238:239], v[238:239], v[126:127]
    v_cvt_pk_bf16_f32 v144, v232, v233
    v_cvt_pk_bf16_f32 v145, v234, v235
    v_cvt_pk_bf16_f32 v146, v236, v237
    v_cvt_pk_bf16_f32 v147, v238, v239
    buffer_store_dwordx4 v[144:147], v2, s[16:19], s81 offen offset:0 sc1
    v_accvgpr_read_b32 v224, a4
    v_accvgpr_read_b32 v225, a5
    v_accvgpr_read_b32 v226, a6
    v_accvgpr_read_b32 v227, a7
    v_accvgpr_read_b32 v228, a20
    v_accvgpr_read_b32 v229, a21
    v_accvgpr_read_b32 v230, a22
    v_accvgpr_read_b32 v231, a23
    v_pk_fma_f32 v[224:225], v[176:177], v[50:51], v[224:225] op_sel_hi:[1,0,1] neg_lo:[0,1,0] neg_hi:[0,1,0]
    v_pk_fma_f32 v[226:227], v[178:179], v[50:51], v[226:227] op_sel_hi:[1,0,1] neg_lo:[0,1,0] neg_hi:[0,1,0]
    v_pk_fma_f32 v[228:229], v[180:181], v[50:51], v[228:229] op_sel_hi:[1,0,1] neg_lo:[0,1,0] neg_hi:[0,1,0]
    v_pk_fma_f32 v[230:231], v[182:183], v[50:51], v[230:231] op_sel_hi:[1,0,1] neg_lo:[0,1,0] neg_hi:[0,1,0]
    v_pk_mul_f32 v[120:121], v[224:225], v[224:225]
    v_pk_mul_f32 v[122:123], v[226:227], v[226:227]
    v_pk_mul_f32 v[124:125], v[228:229], v[228:229]
    v_pk_mul_f32 v[126:127], v[230:231], v[230:231]
    v_pk_fma_f32 v[120:121], v[120:121], v[48:49], v[48:49] op_sel:[0,0,1] op_sel_hi:[1,0,1]
    v_pk_fma_f32 v[122:123], v[122:123], v[48:49], v[48:49] op_sel:[0,0,1] op_sel_hi:[1,0,1]
    v_pk_fma_f32 v[124:125], v[124:125], v[48:49], v[48:49] op_sel:[0,0,1] op_sel_hi:[1,0,1]
    v_pk_fma_f32 v[126:127], v[126:127], v[48:49], v[48:49] op_sel:[0,0,1] op_sel_hi:[1,0,1]
    v_pk_mul_f32 v[120:121], v[120:121], v[224:225]
    v_pk_mul_f32 v[122:123], v[122:123], v[226:227]
    v_pk_mul_f32 v[124:125], v[124:125], v[228:229]
    v_pk_mul_f32 v[126:127], v[126:127], v[230:231]
    v_exp_f32 v120, v120
    v_exp_f32 v121, v121
    v_exp_f32 v122, v122
    v_exp_f32 v123, v123
LF_pad7:
    s_cbranch_execz LF_pad11
    v_exp_f32 v124, v124
    v_exp_f32 v125, v125
    v_exp_f32 v126, v126
    v_exp_f32_e64 v127, v127
    v_accvgpr_read_b32 v232, a52
    v_accvgpr_read_b32 v233, a53
    v_accvgpr_read_b32 v234, a54
    v_accvgpr_read_b32 v235, a55
    v_accvgpr_read_b32 v236, a68
    v_accvgpr_read_b32 v237, a69
    v_accvgpr_read_b32 v238, a70
    v_accvgpr_read_b32 v239, a71
    v_pk_fma_f32 v[232:233], v[184:185], v[50:51], v[232:233] op_sel_hi:[1,0,1] neg_lo:[0,1,0] neg_hi:[0,1,0]
    v_pk_fma_f32 v[234:235], v[186:187], v[50:51], v[234:235] op_sel_hi:[1,0,1] neg_lo:[0,1,0] neg_hi:[0,1,0]
    v_pk_fma_f32 v[236:237], v[188:189], v[50:51], v[236:237] op_sel_hi:[1,0,1] neg_lo:[0,1,0] neg_hi:[0,1,0]
    v_pk_fma_f32 v[238:239], v[190:191], v[50:51], v[238:239] op_sel_hi:[1,0,1] neg_lo:[0,1,0] neg_hi:[0,1,0]
    v_pk_fma_f32 v[120:121], v[120:121], v[50:51], v[50:51] op_sel:[0,1,1] op_sel_hi:[1,1,1]
    v_pk_fma_f32 v[122:123], v[122:123], v[50:51], v[50:51] op_sel:[0,1,1] op_sel_hi:[1,1,1]
    v_pk_fma_f32 v[124:125], v[124:125], v[50:51], v[50:51] op_sel:[0,1,1] op_sel_hi:[1,1,1]
    v_pk_fma_f32 v[126:127], v[126:127], v[50:51], v[50:51] op_sel:[0,1,1] op_sel_hi:[1,1,1]
    v_rcp_f32 v120, v120
    v_rcp_f32 v121, v121
    v_rcp_f32 v122, v122
    v_rcp_f32 v123, v123
    v_rcp_f32 v124, v124
    v_rcp_f32 v125, v125
    v_rcp_f32 v126, v126
    v_rcp_f32 v127, v127
    v_pk_mul_f32 v[232:233], v[232:233], v[224:225]
    v_pk_mul_f32 v[234:235], v[234:235], v[226:227]
    v_pk_mul_f32 v[236:237], v[236:237], v[228:229]
    v_pk_mul_f32 v[238:239], v[238:239], v[230:231]
    v_pk_mul_f32 v[232:233], v[232:233], v[120:121]
    v_pk_mul_f32 v[234:235], v[234:235], v[122:123]
    v_pk_mul_f32 v[236:237], v[236:237], v[124:125]
    v_pk_mul_f32 v[238:239], v[238:239], v[126:127]
    v_cvt_pk_bf16_f32 v148, v232, v233
    v_cvt_pk_bf16_f32 v149, v234, v235
    v_cvt_pk_bf16_f32 v150, v236, v237
    v_cvt_pk_bf16_f32 v151, v238, v239
    buffer_store_dwordx4 v[148:151], v2, s[16:19], s81 offen offset:1024 sc1
    v_accvgpr_read_b32 v224, a8
    v_accvgpr_read_b32 v225, a9
    v_accvgpr_read_b32 v226, a10
    v_accvgpr_read_b32 v227, a11
    v_accvgpr_read_b32 v228, a24
    v_accvgpr_read_b32 v229, a25
    v_accvgpr_read_b32 v230, a26
    v_accvgpr_read_b32 v231, a27
    v_pk_fma_f32 v[224:225], v[176:177], v[14:15], v[224:225] op_sel_hi:[1,0,1] neg_lo:[0,1,0] neg_hi:[0,1,0]
    v_pk_fma_f32 v[226:227], v[178:179], v[14:15], v[226:227] op_sel_hi:[1,0,1] neg_lo:[0,1,0] neg_hi:[0,1,0]
    v_pk_fma_f32 v[228:229], v[180:181], v[14:15], v[228:229] op_sel_hi:[1,0,1] neg_lo:[0,1,0] neg_hi:[0,1,0]
    v_pk_fma_f32 v[230:231], v[182:183], v[14:15], v[230:231] op_sel_hi:[1,0,1] neg_lo:[0,1,0] neg_hi:[0,1,0]
    v_pk_mul_f32 v[120:121], v[224:225], v[224:225]
    v_pk_mul_f32 v[122:123], v[226:227], v[226:227]
    v_pk_mul_f32 v[124:125], v[228:229], v[228:229]
    v_pk_mul_f32 v[126:127], v[230:231], v[230:231]
    v_pk_fma_f32 v[120:121], v[120:121], v[12:13], v[12:13] op_sel:[0,0,1] op_sel_hi:[1,0,1]
    v_pk_fma_f32 v[122:123], v[122:123], v[12:13], v[12:13] op_sel:[0,0,1] op_sel_hi:[1,0,1]
    v_pk_fma_f32 v[124:125], v[124:125], v[12:13], v[12:13] op_sel:[0,0,1] op_sel_hi:[1,0,1]
    v_pk_fma_f32 v[126:127], v[126:127], v[12:13], v[12:13] op_sel:[0,0,1] op_sel_hi:[1,0,1]
    v_pk_mul_f32 v[120:121], v[120:121], v[224:225]
    v_pk_mul_f32 v[122:123], v[122:123], v[226:227]
    v_pk_mul_f32 v[124:125], v[124:125], v[228:229]
    v_pk_mul_f32 v[126:127], v[126:127], v[230:231]
    v_exp_f32 v120, v120
    v_exp_f32 v121, v121
    v_exp_f32 v122, v122
    v_exp_f32 v123, v123
    v_exp_f32 v124, v124
    v_exp_f32 v125, v125
    v_exp_f32 v126, v126
    v_exp_f32 v127, v127
    v_accvgpr_read_b32 v232, a56
    v_accvgpr_read_b32 v233, a57
    v_accvgpr_read_b32 v234, a58
    v_accvgpr_read_b32 v235, a59
    v_accvgpr_read_b32 v236, a72
    v_accvgpr_read_b32 v237, a73
    v_accvgpr_read_b32 v238, a74
    v_accvgpr_read_b32 v239, a75
    v_pk_fma_f32 v[232:233], v[184:185], v[14:15], v[232:233] op_sel_hi:[1,0,1] neg_lo:[0,1,0] neg_hi:[0,1,0]
    v_pk_fma_f32 v[234:235], v[186:187], v[14:15], v[234:235] op_sel_hi:[1,0,1] neg_lo:[0,1,0] neg_hi:[0,1,0]
    v_pk_fma_f32 v[236:237], v[188:189], v[14:15], v[236:237] op_sel_hi:[1,0,1] neg_lo:[0,1,0] neg_hi:[0,1,0]
    v_pk_fma_f32 v[238:239], v[190:191], v[14:15], v[238:239] op_sel_hi:[1,0,1] neg_lo:[0,1,0] neg_hi:[0,1,0]
    v_pk_fma_f32 v[120:121], v[120:121], v[14:15], v[14:15] op_sel:[0,1,1] op_sel_hi:[1,1,1]
    v_pk_fma_f32 v[122:123], v[122:123], v[14:15], v[14:15] op_sel:[0,1,1] op_sel_hi:[1,1,1]
    v_pk_fma_f32 v[124:125], v[124:125], v[14:15], v[14:15] op_sel:[0,1,1] op_sel_hi:[1,1,1]
    v_pk_fma_f32 v[126:127], v[126:127], v[14:15], v[14:15] op_sel:[0,1,1] op_sel_hi:[1,1,1]
    v_rcp_f32 v120, v120
    v_rcp_f32 v121, v121
    v_rcp_f32 v122, v122
    v_rcp_f32 v123, v123
    v_rcp_f32 v124, v124
    v_rcp_f32 v125, v125
    v_rcp_f32 v126, v126
    v_rcp_f32 v127, v127
    v_pk_mul_f32 v[232:233], v[232:233], v[224:225]
    v_pk_mul_f32 v[234:235], v[234:235], v[226:227]
    v_pk_mul_f32 v[236:237], v[236:237], v[228:229]
    v_pk_mul_f32 v[238:239], v[238:239], v[230:231]
    v_pk_mul_f32 v[232:233], v[232:233], v[120:121]
    v_pk_mul_f32 v[234:235], v[234:235], v[122:123]
    v_pk_mul_f32 v[236:237], v[236:237], v[124:125]
    v_pk_mul_f32 v[238:239], v[238:239], v[126:127]
    v_cvt_pk_bf16_f32 v152, v232, v233
    v_cvt_pk_bf16_f32 v153, v234, v235
    v_cvt_pk_bf16_f32 v154, v236, v237
    v_cvt_pk_bf16_f32 v155, v238, v239
    buffer_store_dwordx4 v[152:155], v2, s[16:19], s81 offen offset:2048 sc1
    v_accvgpr_read_b32 v224, a12
    v_accvgpr_read_b32 v225, a13
    v_accvgpr_read_b32 v226, a14
    v_accvgpr_read_b32 v227, a15
    v_accvgpr_read_b32 v228, a28
    v_accvgpr_read_b32 v229, a29
    v_accvgpr_read_b32 v230, a30
    v_accvgpr_read_b32 v231, a31
    v_pk_fma_f32 v[224:225], v[176:177], v[18:19], v[224:225] op_sel_hi:[1,0,1] neg_lo:[0,1,0] neg_hi:[0,1,0]
    v_pk_fma_f32 v[226:227], v[178:179], v[18:19], v[226:227] op_sel_hi:[1,0,1] neg_lo:[0,1,0] neg_hi:[0,1,0]
    v_pk_fma_f32 v[228:229], v[180:181], v[18:19], v[228:229] op_sel_hi:[1,0,1] neg_lo:[0,1,0] neg_hi:[0,1,0]
    v_pk_fma_f32 v[230:231], v[182:183], v[18:19], v[230:231] op_sel_hi:[1,0,1] neg_lo:[0,1,0] neg_hi:[0,1,0]
    v_pk_mul_f32 v[120:121], v[224:225], v[224:225]
    v_pk_mul_f32 v[122:123], v[226:227], v[226:227]
    v_pk_mul_f32 v[124:125], v[228:229], v[228:229]
    v_pk_mul_f32 v[126:127], v[230:231], v[230:231]
    v_pk_fma_f32 v[120:121], v[120:121], v[16:17], v[16:17] op_sel:[0,0,1] op_sel_hi:[1,0,1]
    v_pk_fma_f32 v[122:123], v[122:123], v[16:17], v[16:17] op_sel:[0,0,1] op_sel_hi:[1,0,1]
    v_pk_fma_f32 v[124:125], v[124:125], v[16:17], v[16:17] op_sel:[0,0,1] op_sel_hi:[1,0,1]
    v_pk_fma_f32 v[126:127], v[126:127], v[16:17], v[16:17] op_sel:[0,0,1] op_sel_hi:[1,0,1]
    v_pk_mul_f32 v[120:121], v[120:121], v[224:225]
    v_pk_mul_f32 v[122:123], v[122:123], v[226:227]
    v_pk_mul_f32 v[124:125], v[124:125], v[228:229]
    v_pk_mul_f32 v[126:127], v[126:127], v[230:231]
    v_exp_f32 v120, v120
    v_exp_f32 v121, v121
    v_exp_f32 v122, v122
    v_exp_f32 v123, v123
    v_exp_f32 v124, v124
    v_exp_f32 v125, v125
    v_exp_f32 v126, v126
    v_exp_f32 v127, v127
    v_accvgpr_read_b32 v232, a60
    v_accvgpr_read_b32 v233, a61
    v_accvgpr_read_b32 v234, a62
    v_accvgpr_read_b32 v235, a63
    v_accvgpr_read_b32 v236, a76
    v_accvgpr_read_b32 v237, a77
    v_accvgpr_read_b32 v238, a78
    v_accvgpr_read_b32 v239, a79
    v_pk_fma_f32 v[232:233], v[184:185], v[18:19], v[232:233] op_sel_hi:[1,0,1] neg_lo:[0,1,0] neg_hi:[0,1,0]
    v_pk_fma_f32 v[234:235], v[186:187], v[18:19], v[234:235] op_sel_hi:[1,0,1] neg_lo:[0,1,0] neg_hi:[0,1,0]
    v_pk_fma_f32 v[236:237], v[188:189], v[18:19], v[236:237] op_sel_hi:[1,0,1] neg_lo:[0,1,0] neg_hi:[0,1,0]
    v_pk_fma_f32 v[238:239], v[190:191], v[18:19], v[238:239] op_sel_hi:[1,0,1] neg_lo:[0,1,0] neg_hi:[0,1,0]
    v_pk_fma_f32 v[120:121], v[120:121], v[18:19], v[18:19] op_sel:[0,1,1] op_sel_hi:[1,1,1]
    v_pk_fma_f32 v[122:123], v[122:123], v[18:19], v[18:19] op_sel:[0,1,1] op_sel_hi:[1,1,1]
    v_pk_fma_f32 v[124:125], v[124:125], v[18:19], v[18:19] op_sel:[0,1,1] op_sel_hi:[1,1,1]
    v_pk_fma_f32 v[126:127], v[126:127], v[18:19], v[18:19] op_sel:[0,1,1] op_sel_hi:[1,1,1]
    v_rcp_f32 v120, v120
    v_rcp_f32 v121, v121
    v_rcp_f32 v122, v122
    v_rcp_f32 v123, v123
    v_rcp_f32 v124, v124
    v_rcp_f32 v125, v125
    v_rcp_f32 v126, v126
    v_rcp_f32 v127, v127
    v_pk_mul_f32 v[232:233], v[232:233], v[224:225]
    v_pk_mul_f32 v[234:235], v[234:235], v[226:227]
    v_pk_mul_f32 v[236:237], v[236:237], v[228:229]
    v_pk_mul_f32 v[238:239], v[238:239], v[230:231]
    v_pk_mul_f32 v[232:233], v[232:233], v[120:121]
    v_pk_mul_f32 v[234:235], v[234:235], v[122:123]
    v_pk_mul_f32 v[236:237], v[236:237], v[124:125]
    v_pk_mul_f32 v[238:239], v[238:239], v[126:127]
    v_cvt_pk_bf16_f32 v156, v232, v233
    v_cvt_pk_bf16_f32 v157, v234, v235
    v_cvt_pk_bf16_f32 v158, v236, v237
    v_cvt_pk_bf16_f32 v159, v238, v239
    buffer_store_dwordx4 v[156:159], v2, s[16:19], s81 offen offset:3072 sc1
    v_accvgpr_read_b32 v224, a32
    v_accvgpr_read_b32 v225, a33
    v_accvgpr_read_b32 v226, a34
    v_accvgpr_read_b32 v227, a35
    v_accvgpr_read_b32 v228, a36
    v_accvgpr_read_b32 v229, a37
    v_accvgpr_read_b32 v230, a38
    v_accvgpr_read_b32 v231, a39
    s_waitcnt lgkmcnt(0)
    s_nop 0
    v_pk_fma_f32 v[224:225], v[248:249], v[46:47], v[224:225] op_sel_hi:[1,0,1] neg_lo:[0,1,0] neg_hi:[0,1,0]
    v_pk_fma_f32 v[226:227], v[250:251], v[46:47], v[226:227] op_sel_hi:[1,0,1] neg_lo:[0,1,0] neg_hi:[0,1,0]
    v_pk_fma_f32 v[228:229], v[248:249], v[50:51], v[228:229] op_sel_hi:[1,0,1] neg_lo:[0,1,0] neg_hi:[0,1,0]
    v_pk_fma_f32 v[230:231], v[250:251], v[50:51], v[230:231] op_sel_hi:[1,0,1] neg_lo:[0,1,0] neg_hi:[0,1,0]
    v_pk_mul_f32 v[120:121], v[224:225], v[224:225]
    v_pk_mul_f32 v[122:123], v[226:227], v[226:227]
    v_pk_mul_f32 v[124:125], v[228:229], v[228:229]
    v_pk_mul_f32 v[126:127], v[230:231], v[230:231]
    v_pk_fma_f32 v[120:121], v[120:121], v[44:45], v[44:45] op_sel:[0,0,1] op_sel_hi:[1,0,1]
    v_pk_fma_f32 v[122:123], v[122:123], v[44:45], v[44:45] op_sel:[0,0,1] op_sel_hi:[1,0,1]
    v_pk_fma_f32 v[124:125], v[124:125], v[48:49], v[48:49] op_sel:[0,0,1] op_sel_hi:[1,0,1]
    v_pk_fma_f32 v[126:127], v[126:127], v[48:49], v[48:49] op_sel:[0,0,1] op_sel_hi:[1,0,1]
    v_pk_mul_f32 v[120:121], v[120:121], v[224:225]
    v_pk_mul_f32 v[122:123], v[122:123], v[226:227]
    v_pk_mul_f32 v[124:125], v[124:125], v[228:229]
    v_pk_mul_f32 v[126:127], v[126:127], v[230:231]
    v_exp_f32 v120, v120
    v_exp_f32 v121, v121
    v_exp_f32 v122, v122
    v_exp_f32 v123, v123
    v_exp_f32 v124, v124
    v_exp_f32 v125, v125
    v_exp_f32 v126, v126
    v_exp_f32 v127, v127
    v_accvgpr_read_b32 v232, a80
    v_accvgpr_read_b32 v233, a81
    v_accvgpr_read_b32 v234, a82
    v_accvgpr_read_b32 v235, a83
    v_accvgpr_read_b32 v236, a84
    v_accvgpr_read_b32 v237, a85
    v_accvgpr_read_b32 v238, a86
    v_accvgpr_read_b32 v239, a87
    v_pk_fma_f32 v[232:233], v[252:253], v[46:47], v[232:233] op_sel_hi:[1,0,1] neg_lo:[0,1,0] neg_hi:[0,1,0]
    v_pk_fma_f32 v[234:235], v[254:255], v[46:47], v[234:235] op_sel_hi:[1,0,1] neg_lo:[0,1,0] neg_hi:[0,1,0]
    v_pk_fma_f32 v[236:237], v[252:253], v[50:51], v[236:237] op_sel_hi:[1,0,1] neg_lo:[0,1,0] neg_hi:[0,1,0]
    v_pk_fma_f32 v[238:239], v[254:255], v[50:51], v[238:239] op_sel_hi:[1,0,1] neg_lo:[0,1,0] neg_hi:[0,1,0]
    v_pk_fma_f32 v[120:121], v[120:121], v[46:47], v[46:47] op_sel:[0,1,1] op_sel_hi:[1,1,1]
    v_pk_fma_f32 v[122:123], v[122:123], v[46:47], v[46:47] op_sel:[0,1,1] op_sel_hi:[1,1,1]
    v_pk_fma_f32 v[124:125], v[124:125], v[50:51], v[50:51] op_sel:[0,1,1] op_sel_hi:[1,1,1]
    v_pk_fma_f32 v[126:127], v[126:127], v[50:51], v[50:51] op_sel:[0,1,1] op_sel_hi:[1,1,1]
    v_rcp_f32 v120, v120
    v_rcp_f32 v121, v121
    v_rcp_f32 v122, v122
    v_rcp_f32 v123, v123
    v_rcp_f32 v124, v124
    v_rcp_f32 v125, v125
    v_rcp_f32 v126, v126
    v_rcp_f32 v127, v127
    v_pk_mul_f32 v[232:233], v[232:233], v[224:225]
    v_pk_mul_f32 v[234:235], v[234:235], v[226:227]
    v_pk_mul_f32 v[236:237], v[236:237], v[228:229]
    v_pk_mul_f32 v[238:239], v[238:239], v[230:231]
    v_pk_mul_f32 v[232:233], v[232:233], v[120:121]
    v_pk_mul_f32 v[234:235], v[234:235], v[122:123]
    v_pk_mul_f32 v[236:237], v[236:237], v[124:125]
    v_pk_mul_f32 v[238:239], v[238:239], v[126:127]
    v_cvt_pk_bf16_f32 v240, v232, v233
    v_cvt_pk_bf16_f32 v241, v234, v235
    v_cvt_pk_bf16_f32 v242, v236, v237
    v_cvt_pk_bf16_f32 v243, v238, v239
    buffer_store_dwordx2 v[240:241], v11, s[16:19], s83 offen offset:0 sc1
    buffer_store_dwordx2 v[242:243], v11, s[16:19], s83 offen offset:1024 sc1
    v_accvgpr_read_b32 v224, a40
    v_accvgpr_read_b32 v225, a41
    v_accvgpr_read_b32 v226, a42
    v_accvgpr_read_b32 v227, a43
    v_accvgpr_read_b32 v228, a44
    v_accvgpr_read_b32 v229, a45
    v_accvgpr_read_b32 v230, a46
    v_accvgpr_read_b32 v231, a47
    v_pk_fma_f32 v[224:225], v[248:249], v[14:15], v[224:225] op_sel_hi:[1,0,1] neg_lo:[0,1,0] neg_hi:[0,1,0]
    v_pk_fma_f32 v[226:227], v[250:251], v[14:15], v[226:227] op_sel_hi:[1,0,1] neg_lo:[0,1,0] neg_hi:[0,1,0]
    v_pk_fma_f32 v[228:229], v[248:249], v[18:19], v[228:229] op_sel_hi:[1,0,1] neg_lo:[0,1,0] neg_hi:[0,1,0]
    v_pk_fma_f32 v[230:231], v[250:251], v[18:19], v[230:231] op_sel_hi:[1,0,1] neg_lo:[0,1,0] neg_hi:[0,1,0]
    v_pk_mul_f32 v[120:121], v[224:225], v[224:225]
    v_pk_mul_f32 v[122:123], v[226:227], v[226:227]
    v_pk_mul_f32 v[124:125], v[228:229], v[228:229]
    v_pk_mul_f32 v[126:127], v[230:231], v[230:231]
    v_pk_fma_f32 v[120:121], v[120:121], v[12:13], v[12:13] op_sel:[0,0,1] op_sel_hi:[1,0,1]
    v_pk_fma_f32 v[122:123], v[122:123], v[12:13], v[12:13] op_sel:[0,0,1] op_sel_hi:[1,0,1]
    v_pk_fma_f32 v[124:125], v[124:125], v[16:17], v[16:17] op_sel:[0,0,1] op_sel_hi:[1,0,1]
    v_pk_fma_f32 v[126:127], v[126:127], v[16:17], v[16:17] op_sel:[0,0,1] op_sel_hi:[1,0,1]
    v_pk_mul_f32 v[120:121], v[120:121], v[224:225]
    v_pk_mul_f32 v[122:123], v[122:123], v[226:227]
    v_pk_mul_f32 v[124:125], v[124:125], v[228:229]
    v_pk_mul_f32 v[126:127], v[126:127], v[230:231]
    v_exp_f32 v120, v120
    v_exp_f32 v121, v121
    v_exp_f32 v122, v122
    v_exp_f32 v123, v123
    v_exp_f32 v124, v124
    v_exp_f32 v125, v125
    v_exp_f32 v126, v126
    v_exp_f32 v127, v127
    v_accvgpr_read_b32 v232, a88
    v_accvgpr_read_b32 v233, a89
    v_accvgpr_read_b32 v234, a90
    v_accvgpr_read_b32 v235, a91
    v_accvgpr_read_b32 v236, a92
    v_accvgpr_read_b32 v237, a93
    v_accvgpr_read_b32 v238, a94
    v_accvgpr_read_b32 v239, a95
    v_pk_fma_f32 v[232:233], v[252:253], v[14:15], v[232:233] op_sel_hi:[1,0,1] neg_lo:[0,1,0] neg_hi:[0,1,0]
    v_pk_fma_f32 v[234:235], v[254:255], v[14:15], v[234:235] op_sel_hi:[1,0,1] neg_lo:[0,1,0] neg_hi:[0,1,0]
    v_pk_fma_f32 v[236:237], v[252:253], v[18:19], v[236:237] op_sel_hi:[1,0,1] neg_lo:[0,1,0] neg_hi:[0,1,0]
    v_pk_fma_f32 v[238:239], v[254:255], v[18:19], v[238:239] op_sel_hi:[1,0,1] neg_lo:[0,1,0] neg_hi:[0,1,0]
    v_pk_fma_f32 v[120:121], v[120:121], v[14:15], v[14:15] op_sel:[0,1,1] op_sel_hi:[1,1,1]
    v_pk_fma_f32 v[122:123], v[122:123], v[14:15], v[14:15] op_sel:[0,1,1] op_sel_hi:[1,1,1]
    v_pk_fma_f32 v[124:125], v[124:125], v[18:19], v[18:19] op_sel:[0,1,1] op_sel_hi:[1,1,1]
    v_pk_fma_f32 v[126:127], v[126:127], v[18:19], v[18:19] op_sel:[0,1,1] op_sel_hi:[1,1,1]
    v_rcp_f32 v120, v120
    v_rcp_f32 v121, v121
    v_rcp_f32 v122, v122
    v_rcp_f32 v123, v123
    v_rcp_f32 v124, v124
    v_rcp_f32 v125, v125
    v_rcp_f32 v126, v126
    v_rcp_f32 v127, v127
    v_pk_mul_f32 v[232:233], v[232:233], v[224:225]
    v_pk_mul_f32 v[234:235], v[234:235], v[226:227]
    v_pk_mul_f32 v[236:237], v[236:237], v[228:229]
    v_pk_mul_f32 v[238:239], v[238:239], v[230:231]
    v_pk_mul_f32 v[232:233], v[232:233], v[120:121]
    v_pk_mul_f32 v[234:235], v[234:235], v[122:123]
    v_pk_mul_f32 v[236:237], v[236:237], v[124:125]
    v_pk_mul_f32 v[238:239], v[238:239], v[126:127]
    v_cvt_pk_bf16_f32 v244, v232, v233
    v_cvt_pk_bf16_f32 v245, v234, v235
    v_cvt_pk_bf16_f32 v246, v236, v237
    v_cvt_pk_bf16_f32 v247, v238, v239
    buffer_store_dwordx2 v[244:245], v11, s[16:19], s83 offen offset:2048 sc1
    buffer_store_dwordx2 v[246:247], v11, s[16:19], s83 offen offset:3072 sc1
    s_mov_b32 s85, 0
    s_waitcnt vmcnt(8)
LF_lbchk:
    v_max_u32_e64 v120, v192, v193
    v_max3_u32 v120, v120, v194, v195
    v_max3_u32 v120, v120, v196, v197
    v_max3_u32 v120, v120, v198, v199
    v_max3_u32 v120, v120, v200, v201
    v_max3_u32 v120, v120, v202, v203
    v_max3_u32 v120, v120, v204, v205
    v_max3_u32 v120, v120, v206, v207
    v_max3_u32 v120, v120, v208, v209
    v_max3_u32 v120, v120, v210, v211
    v_max3_u32 v120, v120, v212, v213
    v_max3_u32 v120, v120, v214, v215
    v_max3_u32 v120, v120, v216, v217
    v_max3_u32 v120, v120, v218, v219
    v_max3_u32 v120, v120, v220, v221
    v_max3_u32 v120, v120, v222, v223
    v_cmp_eq_u32 vcc, -1, v120
    s_add_u32 s85, s85, 1
    s_cbranch_vccnz LF_lbspin
LF_lbok:
    s_nop 0
    v_pk_fma_f32 v[216:217], v[24:25], v[220:221], v[216:217] op_sel_hi:[1,0,1]
    v_pk_fma_f32 v[218:219], v[36:37], v[222:223], v[218:219] op_sel_hi:[1,0,1]
    v_pk_fma_f32 v[216:217], v[24:25], v[220:221], v[216:217] op_sel:[1,1,0] op_sel_hi:[0,1,1] neg_lo:[1,0,0]
    v_pk_fma_f32 v[218:219], v[36:37], v[222:223], v[218:219] op_sel:[1,1,0] op_sel_hi:[0,1,1] neg_lo:[1,0,0]
    v_pk_fma_f32 v[212:213], v[24:25], v[216:217], v[212:213] op_sel_hi:[1,0,1]
    v_pk_fma_f32 v[214:215], v[36:37], v[218:219], v[214:215] op_sel_hi:[1,0,1]
    v_pk_fma_f32 v[212:213], v[24:25], v[216:217], v[212:213] op_sel:[1,1,0] op_sel_hi:[0,1,1] neg_lo:[1,0,0]
    v_pk_fma_f32 v[214:215], v[36:37], v[218:219], v[214:215] op_sel:[1,1,0] op_sel_hi:[0,1,1] neg_lo:[1,0,0]
    v_pk_fma_f32 v[208:209], v[24:25], v[212:213], v[208:209] op_sel_hi:[1,0,1]
    v_pk_fma_f32 v[210:211], v[36:37], v[214:215], v[210:211] op_sel_hi:[1,0,1]
    v_pk_fma_f32 v[208:209], v[24:25], v[212:213], v[208:209] op_sel:[1,1,0] op_sel_hi:[0,1,1] neg_lo:[1,0,0]
    v_pk_fma_f32 v[210:211], v[36:37], v[214:215], v[210:211] op_sel:[1,1,0] op_sel_hi:[0,1,1] neg_lo:[1,0,0]
    v_pk_fma_f32 v[204:205], v[24:25], v[208:209], v[204:205] op_sel_hi:[1,0,1]
    v_pk_fma_f32 v[206:207], v[36:37], v[210:211], v[206:207] op_sel_hi:[1,0,1]
    v_pk_fma_f32 v[204:205], v[24:25], v[208:209], v[204:205] op_sel:[1,1,0] op_sel_hi:[0,1,1] neg_lo:[1,0,0]
    v_pk_fma_f32 v[206:207], v[36:37], v[210:211], v[206:207] op_sel:[1,1,0] op_sel_hi:[0,1,1] neg_lo:[1,0,0]
    v_pk_fma_f32 v[200:201], v[24:25], v[204:205], v[200:201] op_sel_hi:[1,0,1]
    v_pk_fma_f32 v[202:203], v[36:37], v[206:207], v[202:203] op_sel_hi:[1,0,1]
    v_pk_fma_f32 v[200:201], v[24:25], v[204:205], v[200:201] op_sel:[1,1,0] op_sel_hi:[0,1,1] neg_lo:[1,0,0]
    v_pk_fma_f32 v[202:203], v[36:37], v[206:207], v[202:203] op_sel:[1,1,0] op_sel_hi:[0,1,1] neg_lo:[1,0,0]
    v_pk_fma_f32 v[196:197], v[24:25], v[200:201], v[196:197] op_sel_hi:[1,0,1]
    v_pk_fma_f32 v[198:199], v[36:37], v[202:203], v[198:199] op_sel_hi:[1,0,1]
    v_pk_fma_f32 v[196:197], v[24:25], v[200:201], v[196:197] op_sel:[1,1,0] op_sel_hi:[0,1,1] neg_lo:[1,0,0]
    v_pk_fma_f32 v[198:199], v[36:37], v[202:203], v[198:199] op_sel:[1,1,0] op_sel_hi:[0,1,1] neg_lo:[1,0,0]
    v_pk_fma_f32 v[192:193], v[24:25], v[196:197], v[192:193] op_sel_hi:[1,0,1]
    v_pk_fma_f32 v[194:195], v[36:37], v[198:199], v[194:195] op_sel_hi:[1,0,1]
    v_pk_fma_f32 v[192:193], v[24:25], v[196:197], v[192:193] op_sel:[1,1,0] op_sel_hi:[0,1,1] neg_lo:[1,0,0]
    v_pk_fma_f32 v[194:195], v[36:37], v[198:199], v[194:195] op_sel:[1,1,0] op_sel_hi:[0,1,1] neg_lo:[1,0,0]
    v_pk_mul_f32 v[196:197], v[28:29], v[192:193] op_sel_hi:[1,0]
    v_pk_mul_f32 v[198:199], v[40:41], v[194:195] op_sel_hi:[1,0]
    v_pk_fma_f32 v[196:197], v[28:29], v[192:193], v[196:197] op_sel:[1,1,0] op_sel_hi:[0,1,1] neg_lo:[1,0,0]
    v_pk_fma_f32 v[198:199], v[40:41], v[194:195], v[198:199] op_sel:[1,1,0] op_sel_hi:[0,1,1] neg_lo:[1,0,0]
    v_mov_b64 v[200:201], v[196:197]
    v_mov_b64 v[202:203], v[198:199]
    s_nop 1
    v_permlane32_swap_b32 v196, v200
    v_permlane32_swap_b32 v197, v201
    v_permlane32_swap_b32 v198, v202
    v_permlane32_swap_b32 v199, v203
    v_pk_add_f32 v[196:197], v[196:197], v[200:201]
    v_pk_add_f32 v[198:199], v[198:199], v[202:203]
    v_mov_b64 v[200:201], v[196:197]
    v_mov_b64 v[202:203], v[198:199]
    s_nop 1
    v_permlane16_swap_b32 v196, v200
    v_permlane16_swap_b32 v197, v201
    v_permlane16_swap_b32 v198, v202
    v_permlane16_swap_b32 v199, v203
    v_pk_add_f32 v[196:197], v[196:197], v[200:201]
    v_pk_add_f32 v[198:199], v[198:199], v[202:203]
    v_pk_fma_f32 v[52:53], v[26:27], v[196:197], v[52:53] op_sel_hi:[1,0,1]
    v_pk_fma_f32 v[54:55], v[38:39], v[198:199], v[54:55] op_sel_hi:[1,0,1]
    v_pk_fma_f32 v[52:53], v[26:27], v[196:197], v[52:53] op_sel:[1,1,0] op_sel_hi:[0,1,1] neg_lo:[1,0,0]
    v_pk_fma_f32 v[54:55], v[38:39], v[198:199], v[54:55] op_sel:[1,1,0] op_sel_hi:[0,1,1] neg_lo:[1,0,0]
    s_waitcnt vmcnt(4)
    s_mov_b64 exec, 1
    buffer_store_dword v43, v42, s[36:39], s61 offen sc1
    s_mov_b64 exec, -1
    s_nop 0
    v_pk_fma_f32 v[56:57], v[20:21], v[52:53], v[56:57] op_sel_hi:[1,0,1]
    v_pk_fma_f32 v[64:65], v[32:33], v[54:55], v[64:65] op_sel_hi:[1,0,1]
    v_pk_fma_f32 v[56:57], v[20:21], v[52:53], v[56:57] op_sel:[1,1,0] op_sel_hi:[0,1,1] neg_lo:[1,0,0]
    v_pk_fma_f32 v[64:65], v[32:33], v[54:55], v[64:65] op_sel:[1,1,0] op_sel_hi:[0,1,1] neg_lo:[1,0,0]
    v_pk_fma_f32 v[72:73], v[20:21], v[56:57], v[72:73] op_sel_hi:[1,0,1]
    v_pk_fma_f32 v[80:81], v[32:33], v[64:65], v[80:81] op_sel_hi:[1,0,1]
    v_pk_fma_f32 v[72:73], v[20:21], v[56:57], v[72:73] op_sel:[1,1,0] op_sel_hi:[0,1,1] neg_lo:[1,0,0]
    v_pk_fma_f32 v[80:81], v[32:33], v[64:65], v[80:81] op_sel:[1,1,0] op_sel_hi:[0,1,1] neg_lo:[1,0,0]
    v_pk_fma_f32 v[88:89], v[20:21], v[72:73], v[88:89] op_sel_hi:[1,0,1]
    v_pk_fma_f32 v[96:97], v[32:33], v[80:81], v[96:97] op_sel_hi:[1,0,1]
    v_pk_fma_f32 v[88:89], v[20:21], v[72:73], v[88:89] op_sel:[1,1,0] op_sel_hi:[0,1,1] neg_lo:[1,0,0]
    v_pk_fma_f32 v[96:97], v[32:33], v[80:81], v[96:97] op_sel:[1,1,0] op_sel_hi:[0,1,1] neg_lo:[1,0,0]
    v_pk_fma_f32 v[104:105], v[20:21], v[88:89], v[104:105] op_sel_hi:[1,0,1]
    v_pk_fma_f32 v[112:113], v[32:33], v[96:97], v[112:113] op_sel_hi:[1,0,1]
    v_pk_fma_f32 v[104:105], v[20:21], v[88:89], v[104:105] op_sel:[1,1,0] op_sel_hi:[0,1,1] neg_lo:[1,0,0]
    v_pk_fma_f32 v[112:113], v[32:33], v[96:97], v[112:113] op_sel:[1,1,0] op_sel_hi:[0,1,1] neg_lo:[1,0,0]
    v_pk_fma_f32 v[58:59], v[20:21], v[104:105], v[58:59] op_sel_hi:[1,0,1]
    v_pk_fma_f32 v[66:67], v[32:33], v[112:113], v[66:67] op_sel_hi:[1,0,1]
    v_pk_fma_f32 v[58:59], v[20:21], v[104:105], v[58:59] op_sel:[1,1,0] op_sel_hi:[0,1,1] neg_lo:[1,0,0]
    v_pk_fma_f32 v[66:67], v[32:33], v[112:113], v[66:67] op_sel:[1,1,0] op_sel_hi:[0,1,1] neg_lo:[1,0,0]
    v_pk_fma_f32 v[74:75], v[20:21], v[58:59], v[74:75] op_sel_hi:[1,0,1]
    v_pk_fma_f32 v[82:83], v[32:33], v[66:67], v[82:83] op_sel_hi:[1,0,1]
    v_pk_fma_f32 v[74:75], v[20:21], v[58:59], v[74:75] op_sel:[1,1,0] op_sel_hi:[0,1,1] neg_lo:[1,0,0]
    v_pk_fma_f32 v[82:83], v[32:33], v[66:67], v[82:83] op_sel:[1,1,0] op_sel_hi:[0,1,1] neg_lo:[1,0,0]
    v_pk_fma_f32 v[90:91], v[20:21], v[74:75], v[90:91] op_sel_hi:[1,0,1]
    v_pk_fma_f32 v[98:99], v[32:33], v[82:83], v[98:99] op_sel_hi:[1,0,1]
    v_pk_fma_f32 v[90:91], v[20:21], v[74:75], v[90:91] op_sel:[1,1,0] op_sel_hi:[0,1,1] neg_lo:[1,0,0]
    v_pk_fma_f32 v[98:99], v[32:33], v[82:83], v[98:99] op_sel:[1,1,0] op_sel_hi:[0,1,1] neg_lo:[1,0,0]
    v_pk_fma_f32 v[106:107], v[20:21], v[90:91], v[106:107] op_sel_hi:[1,0,1]
    v_pk_fma_f32 v[114:115], v[32:33], v[98:99], v[114:115] op_sel_hi:[1,0,1]
    v_pk_fma_f32 v[106:107], v[20:21], v[90:91], v[106:107] op_sel:[1,1,0] op_sel_hi:[0,1,1] neg_lo:[1,0,0]
    v_pk_fma_f32 v[114:115], v[32:33], v[98:99], v[114:115] op_sel:[1,1,0] op_sel_hi:[0,1,1] neg_lo:[1,0,0]
    v_pk_fma_f32 v[60:61], v[20:21], v[106:107], v[60:61] op_sel_hi:[1,0,1]
    v_pk_fma_f32 v[68:69], v[32:33], v[114:115], v[68:69] op_sel_hi:[1,0,1]
    v_pk_fma_f32 v[60:61], v[20:21], v[106:107], v[60:61] op_sel:[1,1,0] op_sel_hi:[0,1,1] neg_lo:[1,0,0]
    v_pk_fma_f32 v[68:69], v[32:33], v[114:115], v[68:69] op_sel:[1,1,0] op_sel_hi:[0,1,1] neg_lo:[1,0,0]
    v_pk_fma_f32 v[76:77], v[20:21], v[60:61], v[76:77] op_sel_hi:[1,0,1]
    v_pk_fma_f32 v[84:85], v[32:33], v[68:69], v[84:85] op_sel_hi:[1,0,1]
    v_pk_fma_f32 v[76:77], v[20:21], v[60:61], v[76:77] op_sel:[1,1,0] op_sel_hi:[0,1,1] neg_lo:[1,0,0]
    v_pk_fma_f32 v[84:85], v[32:33], v[68:69], v[84:85] op_sel:[1,1,0] op_sel_hi:[0,1,1] neg_lo:[1,0,0]
    v_pk_fma_f32 v[92:93], v[20:21], v[76:77], v[92:93] op_sel_hi:[1,0,1]
    v_pk_fma_f32 v[100:101], v[32:33], v[84:85], v[100:101] op_sel_hi:[1,0,1]
    v_pk_fma_f32 v[92:93], v[20:21], v[76:77], v[92:93] op_sel:[1,1,0] op_sel_hi:[0,1,1] neg_lo:[1,0,0]
    v_pk_fma_f32 v[100:101], v[32:33], v[84:85], v[100:101] op_sel:[1,1,0] op_sel_hi:[0,1,1] neg_lo:[1,0,0]
    v_pk_fma_f32 v[108:109], v[20:21], v[92:93], v[108:109] op_sel_hi:[1,0,1]
    v_pk_fma_f32 v[116:117], v[32:33], v[100:101], v[116:117] op_sel_hi:[1,0,1]
    v_pk_fma_f32 v[108:109], v[20:21], v[92:93], v[108:109] op_sel:[1,1,0] op_sel_hi:[0,1,1] neg_lo:[1,0,0]
    v_pk_fma_f32 v[116:117], v[32:33], v[100:101], v[116:117] op_sel:[1,1,0] op_sel_hi:[0,1,1] neg_lo:[1,0,0]
    v_pk_fma_f32 v[62:63], v[20:21], v[108:109], v[62:63] op_sel_hi:[1,0,1]
    v_pk_fma_f32 v[70:71], v[32:33], v[116:117], v[70:71] op_sel_hi:[1,0,1]
    v_pk_fma_f32 v[62:63], v[20:21], v[108:109], v[62:63] op_sel:[1,1,0] op_sel_hi:[0,1,1] neg_lo:[1,0,0]
    v_pk_fma_f32 v[70:71], v[32:33], v[116:117], v[70:71] op_sel:[1,1,0] op_sel_hi:[0,1,1] neg_lo:[1,0,0]
    v_pk_fma_f32 v[78:79], v[20:21], v[62:63], v[78:79] op_sel_hi:[1,0,1]
    v_pk_fma_f32 v[86:87], v[32:33], v[70:71], v[86:87] op_sel_hi:[1,0,1]
    v_pk_fma_f32 v[78:79], v[20:21], v[62:63], v[78:79] op_sel:[1,1,0] op_sel_hi:[0,1,1] neg_lo:[1,0,0]
    v_pk_fma_f32 v[86:87], v[32:33], v[70:71], v[86:87] op_sel:[1,1,0] op_sel_hi:[0,1,1] neg_lo:[1,0,0]
    v_pk_fma_f32 v[94:95], v[20:21], v[78:79], v[94:95] op_sel_hi:[1,0,1]
    v_pk_fma_f32 v[102:103], v[32:33], v[86:87], v[102:103] op_sel_hi:[1,0,1]
    v_pk_fma_f32 v[94:95], v[20:21], v[78:79], v[94:95] op_sel:[1,1,0] op_sel_hi:[0,1,1] neg_lo:[1,0,0]
    v_pk_fma_f32 v[102:103], v[32:33], v[86:87], v[102:103] op_sel:[1,1,0] op_sel_hi:[0,1,1] neg_lo:[1,0,0]
    v_pk_fma_f32 v[110:111], v[20:21], v[94:95], v[110:111] op_sel_hi:[1,0,1]
    v_pk_fma_f32 v[118:119], v[32:33], v[102:103], v[118:119] op_sel_hi:[1,0,1]
    v_pk_fma_f32 v[110:111], v[20:21], v[94:95], v[110:111] op_sel:[1,1,0] op_sel_hi:[0,1,1] neg_lo:[1,0,0]
    v_pk_fma_f32 v[118:119], v[32:33], v[102:103], v[118:119] op_sel:[1,1,0] op_sel_hi:[0,1,1] neg_lo:[1,0,0]
    v_and_b32 v41, 15, v1
    v_lshrrev_b32 v40, 4, v1
    s_add_u32 s84, s60, 98304
    v_lshrrev_b32 v44, 2, v41
    v_xor_b32 v44, v44, v40
    v_lshl_add_u32 v46, v41, 5, s84
    v_lshl_add_u32 v46, v44, 3, v46
    v_cvt_pk_bf16_f32 v208, v56, v58
    v_cvt_pk_bf16_f32 v209, v60, v62
    v_cvt_pk_bf16_f32 v210, v64, v66
    v_cvt_pk_bf16_f32 v211, v68, v70
    v_cvt_pk_bf16_f32 v212, v72, v74
    v_cvt_pk_bf16_f32 v213, v76, v78
    v_cvt_pk_bf16_f32 v214, v80, v82
    v_cvt_pk_bf16_f32 v215, v84, v86
    v_cvt_pk_bf16_f32 v216, v88, v90
    v_cvt_pk_bf16_f32 v217, v92, v94
    v_cvt_pk_bf16_f32 v218, v96, v98
    v_cvt_pk_bf16_f32 v219, v100, v102
    v_cvt_pk_bf16_f32 v220, v104, v106
    v_cvt_pk_bf16_f32 v221, v108, v110
    v_cvt_pk_bf16_f32 v222, v112, v114
    v_cvt_pk_bf16_f32 v223, v116, v118
    ds_write_b64 v46, v[208:209] offset:0
    ds_write_b64 v46, v[210:211] offset:512
    ds_write_b64 v46, v[212:213] offset:1024
    ds_write_b64 v46, v[214:215] offset:1536
    ds_write_b64 v46, v[216:217] offset:2048
    ds_write_b64 v46, v[218:219] offset:2560
    ds_write_b64 v46, v[220:221] offset:3072
    ds_write_b64 v46, v[222:223] offset:3584
    v_cvt_pk_bf16_f32 v224, -v57, -v59
    v_cvt_pk_bf16_f32 v225, -v61, -v63
    v_cvt_pk_bf16_f32 v226, -v65, -v67
    v_cvt_pk_bf16_f32 v227, -v69, -v71
    v_cvt_pk_bf16_f32 v228, -v73, -v75
    v_cvt_pk_bf16_f32 v229, -v77, -v79
    v_cvt_pk_bf16_f32 v230, -v81, -v83
    v_cvt_pk_bf16_f32 v231, -v85, -v87
    v_cvt_pk_bf16_f32 v232, -v89, -v91
    v_cvt_pk_bf16_f32 v233, -v93, -v95
    v_cvt_pk_bf16_f32 v234, -v97, -v99
    v_cvt_pk_bf16_f32 v235, -v101, -v103
    v_cvt_pk_bf16_f32 v236, -v105, -v107
    v_cvt_pk_bf16_f32 v237, -v109, -v111
    v_cvt_pk_bf16_f32 v238, -v113, -v115
    v_cvt_pk_bf16_f32 v239, -v117, -v119
    ds_write_b64 v46, v[224:225] offset:4096
    ds_write_b64 v46, v[226:227] offset:4608
    ds_write_b64 v46, v[228:229] offset:5120
    ds_write_b64 v46, v[230:231] offset:5632
    ds_write_b64 v46, v[232:233] offset:6144
    ds_write_b64 v46, v[234:235] offset:6656
    ds_write_b64 v46, v[236:237] offset:7168
    ds_write_b64 v46, v[238:239] offset:7680
    v_lshlrev_b32 v44, 1, v40
    v_and_b32 v44, 2, v44
    v_xor_b32 v44, v44, v41
    v_lshl_add_u32 v47, v44, 3, s84
    v_lshl_add_u32 v47, v40, 8, v47
    v_xor_b32 v46, 8, v47
    ds_read_b64_tr_b16 v[208:209], v47 offset:0
    ds_read_b64_tr_b16 v[210:211], v46 offset:128
    ds_read_b64_tr_b16 v[212:213], v47 offset:1024
    ds_read_b64_tr_b16 v[214:215], v46 offset:1152
    ds_read_b64_tr_b16 v[216:217], v47 offset:2048
    ds_read_b64_tr_b16 v[218:219], v46 offset:2176
    ds_read_b64_tr_b16 v[220:221], v47 offset:3072
    ds_read_b64_tr_b16 v[222:223], v46 offset:3200
    ds_read_b64_tr_b16 v[224:225], v47 offset:4096
    ds_read_b64_tr_b16 v[226:227], v46 offset:4224
    ds_read_b64_tr_b16 v[228:229], v47 offset:5120
    ds_read_b64_tr_b16 v[230:231], v46 offset:5248
    ds_read_b64_tr_b16 v[232:233], v47 offset:6144
    ds_read_b64_tr_b16 v[234:235], v46 offset:6272
    ds_read_b64_tr_b16 v[236:237], v47 offset:7168
    ds_read_b64_tr_b16 v[238:239], v46 offset:7296
    v_lshrrev_b32 v44, 2, v1
    v_and_b32 v45, 7, v44
    v_lshlrev_b32 v44, 8, v44
    v_lshl_add_u32 v44, v45, 5, v44
    v_and_b32 v45, 3, v1
    v_lshl_add_u32 v12, v45, 3, v44
    v_xor_b32 v13, 32, v12
    v_xor_b32 v14, 64, v12
    v_xor_b32 v15, 96, v12
    v_xor_b32 v16, 128, v12
    v_xor_b32 v17, 160, v12
    v_xor_b32 v18, 192, v12
    v_xor_b32 v19, 224, v12
    v_and_b32 v39, 7, v1
    v_lshlrev_b32 v39, 2, v39
    s_lshl_b32 s62, s54, 13
    s_add_u32 s62, s62, s70
    s_add_u32 s63, s62, 4096
    ds_read_b64_tr_b16 a[192:193], v12 offset:0
    ds_read_b64_tr_b16 a[194:195], v12 offset:4096
    ds_read_b64_tr_b16 a[196:197], v13 offset:0
    ds_read_b64_tr_b16 a[198:199], v13 offset:4096
    ds_read_b64_tr_b16 a[200:201], v14 offset:0
    ds_read_b64_tr_b16 a[202:203], v14 offset:4096
    ds_read_b64_tr_b16 a[204:205], v15 offset:0
    ds_read_b64_tr_b16 a[206:207], v15 offset:4096
    s_waitcnt lgkmcnt(4)
    v_mfma_f32_16x16x32_bf16 v[48:51], a[192:195], v[128:131], 0
    ds_read_b64_tr_b16 a[208:209], v16 offset:0
    v_mfma_f32_16x16x32_bf16 v[64:67], a[196:199], v[128:131], 0
LF_pad8:
    s_cbranch_execz LF_pad12
    ds_read_b64_tr_b16 a[210:211], v16 offset:4096
    v_mfma_f32_16x16x32_bf16 v[68:71], a[196:199], v[132:135], 0
    buffer_store_dwordx4 v[208:211], v2, s[16:19], s62 offen offset:0 sc1
    v_mfma_f32_16x16x32_bf16 v[52:55], a[192:195], v[132:135], 0
    ds_read_b64_tr_b16 a[212:213], v17 offset:0
    v_mfma_f32_16x16x32_bf16 v[56:59], a[192:195], v[136:139], 0
    ds_read_b64_tr_b16 a[214:215], v17 offset:4096
    v_mfma_f32_16x16x32_bf16 v[72:75], a[196:199], v[136:139], 0
    buffer_store_dwordx4 v[212:215], v2, s[16:19], s62 offen offset:1024 sc1
    v_mfma_f32_16x16x32_bf16 v[76:79], a[196:199], v[140:143], 0
    v_mfma_f32_16x16x32_bf16 v[60:63], a[192:195], v[140:143], 0
    s_waitcnt lgkmcnt(4)
    v_mfma_f32_16x16x32_bf16 v[92:95], a[200:203], v[140:143], 0
    ds_read_b64_tr_b16 a[216:217], v18 offset:0
    v_mfma_f32_16x16x32_bf16 v[108:111], a[204:207], v[140:143], 0
    ds_read_b64_tr_b16 a[218:219], v18 offset:4096
    v_mfma_f32_16x16x32_bf16 v[104:107], a[204:207], v[136:139], 0
    buffer_store_dwordx4 v[216:219], v2, s[16:19], s62 offen offset:2048 sc1
    v_mfma_f32_16x16x32_bf16 v[88:91], a[200:203], v[136:139], 0
    ds_read_b64_tr_b16 a[220:221], v19 offset:0
    v_mfma_f32_16x16x32_bf16 v[84:87], a[200:203], v[132:135], 0
    ds_read_b64_tr_b16 a[222:223], v19 offset:4096
    v_mfma_f32_16x16x32_bf16 v[100:103], a[204:207], v[132:135], 0
    buffer_store_dwordx4 v[220:223], v2, s[16:19], s62 offen offset:3072 sc1
    v_mfma_f32_16x16x32_bf16 v[96:99], a[204:207], v[128:131], 0
    v_mfma_f32_16x16x32_bf16 v[80:83], a[200:203], v[128:131], 0
    s_waitcnt lgkmcnt(4)
    v_mfma_f32_16x16x32_bf16 v[112:115], a[208:211], v[128:131], 0
    ds_read_b64_tr_b16 a[192:193], v12 offset:8192
    v_mfma_f32_16x16x32_bf16 v[176:179], a[212:215], v[128:131], 0
    ds_read_b64_tr_b16 a[194:195], v12 offset:12288
    v_mfma_f32_16x16x32_bf16 v[180:183], a[212:215], v[132:135], 0
    buffer_store_dwordx4 v[224:227], v2, s[16:19], s63 offen offset:0 sc1
    v_mfma_f32_16x16x32_bf16 v[116:119], a[208:211], v[132:135], 0
    ds_read_b64_tr_b16 a[196:197], v13 offset:8192
    v_mfma_f32_16x16x32_bf16 v[120:123], a[208:211], v[136:139], 0
    ds_read_b64_tr_b16 a[198:199], v13 offset:12288
    v_mfma_f32_16x16x32_bf16 v[184:187], a[212:215], v[136:139], 0
    buffer_store_dwordx4 v[228:231], v2, s[16:19], s63 offen offset:1024 sc1
    v_mfma_f32_16x16x32_bf16 v[188:191], a[212:215], v[140:143], 0
    v_mfma_f32_16x16x32_bf16 v[124:127], a[208:211], v[140:143], 0
    s_waitcnt lgkmcnt(4)
    v_mfma_f32_16x16x32_bf16 v[204:207], a[216:219], v[140:143], 0
    ds_read_b64_tr_b16 a[200:201], v14 offset:8192
    v_mfma_f32_16x16x32_bf16 v[252:255], a[220:223], v[140:143], 0
    ds_read_b64_tr_b16 a[202:203], v14 offset:12288
    v_mfma_f32_16x16x32_bf16 v[248:251], a[220:223], v[136:139], 0
    buffer_store_dwordx4 v[232:235], v2, s[16:19], s63 offen offset:2048 sc1
    v_mfma_f32_16x16x32_bf16 v[200:203], a[216:219], v[136:139], 0
    ds_read_b64_tr_b16 a[204:205], v15 offset:8192
    v_mfma_f32_16x16x32_bf16 v[196:199], a[216:219], v[132:135], 0
    ds_read_b64_tr_b16 a[206:207], v15 offset:12288
    v_mfma_f32_16x16x32_bf16 v[244:247], a[220:223], v[132:135], 0
    buffer_store_dwordx4 v[236:239], v2, s[16:19], s63 offen offset:3072 sc1
    v_mfma_f32_16x16x32_bf16 v[240:243], a[220:223], v[128:131], 0
    v_mfma_f32_16x16x32_bf16 v[192:195], a[216:219], v[128:131], 0
    s_waitcnt lgkmcnt(4)
    buffer_load_dword v38, v39, s[36:39], s61 offen sc1
    v_mfma_f32_16x16x32_bf16 v[48:51], a[192:195], v[160:163], v[48:51]
    ds_read_b64_tr_b16 a[208:209], v16 offset:8192
    v_mfma_f32_16x16x32_bf16 v[64:67], a[196:199], v[160:163], v[64:67]
    ds_read_b64_tr_b16 a[210:211], v16 offset:12288
    v_mfma_f32_16x16x32_bf16 v[68:71], a[196:199], v[164:167], v[68:71]
    v_mfma_f32_16x16x32_bf16 v[52:55], a[192:195], v[164:167], v[52:55]
    ds_read_b64_tr_b16 a[212:213], v17 offset:8192
    v_mfma_f32_16x16x32_bf16 v[56:59], a[192:195], v[168:171], v[56:59]
    ds_read_b64_tr_b16 a[214:215], v17 offset:12288
    v_mfma_f32_16x16x32_bf16 v[72:75], a[196:199], v[168:171], v[72:75]
    v_mfma_f32_16x16x32_bf16 v[76:79], a[196:199], v[172:175], v[76:79]
    v_mfma_f32_16x16x32_bf16 v[60:63], a[192:195], v[172:175], v[60:63]
    s_waitcnt lgkmcnt(4)
    v_mfma_f32_16x16x32_bf16 v[92:95], a[200:203], v[172:175], v[92:95]
    ds_read_b64_tr_b16 a[216:217], v18 offset:8192
    v_mfma_f32_16x16x32_bf16 v[108:111], a[204:207], v[172:175], v[108:111]
    ds_read_b64_tr_b16 a[218:219], v18 offset:12288
    v_mfma_f32_16x16x32_bf16 v[104:107], a[204:207], v[168:171], v[104:107]
    v_mfma_f32_16x16x32_bf16 v[88:91], a[200:203], v[168:171], v[88:91]
    ds_read_b64_tr_b16 a[220:221], v19 offset:8192
    v_mfma_f32_16x16x32_bf16 v[84:87], a[200:203], v[164:167], v[84:87]
    ds_read_b64_tr_b16 a[222:223], v19 offset:12288
    v_mfma_f32_16x16x32_bf16 v[100:103], a[204:207], v[164:167], v[100:103]
    v_mfma_f32_16x16x32_bf16 v[96:99], a[204:207], v[160:163], v[96:99]
    v_mfma_f32_16x16x32_bf16 v[80:83], a[200:203], v[160:163], v[80:83]
    s_waitcnt lgkmcnt(4)
    v_mfma_f32_16x16x32_bf16 v[112:115], a[208:211], v[160:163], v[112:115]
    ds_read_b64_tr_b16 a[192:193], v12 offset:16384
    v_mfma_f32_16x16x32_bf16 v[176:179], a[212:215], v[160:163], v[176:179]
    ds_read_b64_tr_b16 a[194:195], v12 offset:20480
    v_mfma_f32_16x16x32_bf16 v[180:183], a[212:215], v[164:167], v[180:183]
    v_mfma_f32_16x16x32_bf16 v[116:119], a[208:211], v[164:167], v[116:119]
    ds_read_b64_tr_b16 a[196:197], v13 offset:16384
    v_mfma_f32_16x16x32_bf16 v[120:123], a[208:211], v[168:171], v[120:123]
    ds_read_b64_tr_b16 a[198:199], v13 offset:20480
    v_mfma_f32_16x16x32_bf16 v[184:187], a[212:215], v[168:171], v[184:187]
    v_mfma_f32_16x16x32_bf16 v[188:191], a[212:215], v[172:175], v[188:191]
    v_mfma_f32_16x16x32_bf16 v[124:127], a[208:211], v[172:175], v[124:127]
    s_waitcnt lgkmcnt(4)
    v_mfma_f32_16x16x32_bf16 v[204:207], a[216:219], v[172:175], v[204:207]
    ds_read_b64_tr_b16 a[200:201], v14 offset:16384
    v_mfma_f32_16x16x32_bf16 v[252:255], a[220:223], v[172:175], v[252:255]
    ds_read_b64_tr_b16 a[202:203], v14 offset:20480
    v_mfma_f32_16x16x32_bf16 v[248:251], a[220:223], v[168:171], v[248:251]
    v_mfma_f32_16x16x32_bf16 v[200:203], a[216:219], v[168:171], v[200:203]
    ds_read_b64_tr_b16 a[204:205], v15 offset:16384
    v_mfma_f32_16x16x32_bf16 v[196:199], a[216:219], v[164:167], v[196:199]
    ds_read_b64_tr_b16 a[206:207], v15 offset:20480
    v_mfma_f32_16x16x32_bf16 v[244:247], a[220:223], v[164:167], v[244:247]
    s_waitcnt vmcnt(0)
    v_cmp_ne_u32 vcc, s80, v38
    v_mfma_f32_16x16x32_bf16 v[240:243], a[220:223], v[160:163], v[240:243]
    s_cbranch_vccnz LF_fa_spin
LF_fa_back:
    v_mfma_f32_16x16x32_bf16 v[192:195], a[216:219], v[160:163], v[192:195]
    s_waitcnt lgkmcnt(4)
    buffer_load_dwordx4 a[48:51], v2, s[16:19], s67 offen offset:0 sc1
    v_mfma_f32_16x16x32_bf16 v[48:51], a[192:195], v[144:147], v[48:51]
    s_and_b32 s81, s48, 1
    s_lshl_b32 s81, s81, 1
    ds_read_b64_tr_b16 a[208:209], v16 offset:16384
    v_mfma_f32_16x16x32_bf16 v[64:67], a[196:199], v[144:147], v[64:67]
    s_add_u32 s81, s81, s53
    s_lshl_b32 s81, s81, 5
    ds_read_b64_tr_b16 a[210:211], v16 offset:20480
    v_mfma_f32_16x16x32_bf16 v[68:71], a[196:199], v[148:151], v[68:71]
    buffer_load_dwordx4 a[52:55], v2, s[16:19], s67 offen offset:1024 sc1
    v_mfma_f32_16x16x32_bf16 v[52:55], a[192:195], v[148:151], v[52:55]
    ds_read_b64_tr_b16 a[212:213], v17 offset:16384
    v_lshrrev_b32 v44, 3, v1
    v_mfma_f32_16x16x32_bf16 v[56:59], a[192:195], v[152:155], v[56:59]
    ds_read_b64_tr_b16 a[214:215], v17 offset:20480
    v_and_b32 v45, 7, v1
    v_mfma_f32_16x16x32_bf16 v[72:75], a[196:199], v[152:155], v[72:75]
    buffer_load_dwordx4 a[56:59], v2, s[16:19], s67 offen offset:2048 sc1
    v_mfma_f32_16x16x32_bf16 v[76:79], a[196:199], v[156:159], v[76:79]
    v_add_u32 v46, 0, v44
    v_bfe_u32 v47, v46, 1, 3
    v_mfma_f32_16x16x32_bf16 v[60:63], a[192:195], v[156:159], v[60:63]
    s_waitcnt lgkmcnt(4)
    buffer_load_dwordx4 a[60:63], v2, s[16:19], s67 offen offset:3072 sc1
    v_mfma_f32_16x16x32_bf16 v[92:95], a[200:203], v[156:159], v[92:95]
    s_add_u32 s67, s67, 4096
    ds_read_b64_tr_b16 a[216:217], v18 offset:16384
    v_xor_b32 v47, v47, v45
    v_mfma_f32_16x16x32_bf16 v[108:111], a[204:207], v[156:159], v[108:111]
    s_cmp_eq_u32 s67, s69
    s_cselect_b32 s67, s68, s67
    ds_read_b64_tr_b16 a[218:219], v18 offset:20480
    v_mfma_f32_16x16x32_bf16 v[104:107], a[204:207], v[152:155], v[104:107]
    buffer_load_dwordx4 a[64:67], v2, s[16:19], s67 offen offset:0 sc1
    v_mfma_f32_16x16x32_bf16 v[88:91], a[200:203], v[152:155], v[88:91]
    ds_read_b64_tr_b16 a[220:221], v19 offset:16384
    v_lshlrev_b32 v47, 4, v47
    v_mfma_f32_16x16x32_bf16 v[84:87], a[200:203], v[148:151], v[84:87]
    ds_read_b64_tr_b16 a[222:223], v19 offset:20480
    v_add_u32 v46, s81, v46
    v_mfma_f32_16x16x32_bf16 v[100:103], a[204:207], v[148:151], v[100:103]
    buffer_load_dwordx4 a[68:71], v2, s[16:19], s67 offen offset:1024 sc1
    v_mfma_f32_16x16x32_bf16 v[96:99], a[204:207], v[144:147], v[96:99]
    v_and_b32 v46, 127, v46
    v_lshl_add_u32 v20, v46, 11, v47
    v_mfma_f32_16x16x32_bf16 v[80:83], a[200:203], v[144:147], v[80:83]
    s_waitcnt lgkmcnt(4)
    buffer_load_dwordx4 a[72:75], v2, s[16:19], s67 offen offset:2048 sc1
    v_mfma_f32_16x16x32_bf16 v[112:115], a[208:211], v[144:147], v[112:115]
    ds_read_b64_tr_b16 a[192:193], v12 offset:24576
    v_add_u32 v46, 8, v44
    v_mfma_f32_16x16x32_bf16 v[176:179], a[212:215], v[144:147], v[176:179]
    ds_read_b64_tr_b16 a[194:195], v12 offset:28672
    v_bfe_u32 v47, v46, 1, 3
    v_mfma_f32_16x16x32_bf16 v[180:183], a[212:215], v[148:151], v[180:183]
    buffer_load_dwordx4 a[76:79], v2, s[16:19], s67 offen offset:3072 sc1
    v_mfma_f32_16x16x32_bf16 v[116:119], a[208:211], v[148:151], v[116:119]
    s_add_u32 s67, s67, 4096
    ds_read_b64_tr_b16 a[196:197], v13 offset:24576
    v_xor_b32 v47, v47, v45
    v_mfma_f32_16x16x32_bf16 v[120:123], a[208:211], v[152:155], v[120:123]
    s_cmp_eq_u32 s67, s69
    s_cselect_b32 s67, s68, s67
    ds_read_b64_tr_b16 a[198:199], v13 offset:28672
    v_mfma_f32_16x16x32_bf16 v[184:187], a[212:215], v[152:155], v[184:187]
    buffer_load_dwordx4 a[80:83], v2, s[16:19], s67 offen offset:0 sc1
    v_mfma_f32_16x16x32_bf16 v[188:191], a[212:215], v[156:159], v[188:191]
    v_lshlrev_b32 v47, 4, v47
    v_add_u32 v46, s81, v46
    v_mfma_f32_16x16x32_bf16 v[124:127], a[208:211], v[156:159], v[124:127]
    s_waitcnt lgkmcnt(4)
    buffer_load_dwordx4 a[84:87], v2, s[16:19], s67 offen offset:1024 sc1
    v_mfma_f32_16x16x32_bf16 v[204:207], a[216:219], v[156:159], v[204:207]
    ds_read_b64_tr_b16 a[200:201], v14 offset:24576
    v_and_b32 v46, 127, v46
    v_mfma_f32_16x16x32_bf16 v[252:255], a[220:223], v[156:159], v[252:255]
    ds_read_b64_tr_b16 a[202:203], v14 offset:28672
    v_lshl_add_u32 v21, v46, 11, v47
    v_mfma_f32_16x16x32_bf16 v[248:251], a[220:223], v[152:155], v[248:251]
    buffer_load_dwordx4 a[88:91], v2, s[16:19], s67 offen offset:2048 sc1
    v_mfma_f32_16x16x32_bf16 v[200:203], a[216:219], v[152:155], v[200:203]
    ds_read_b64_tr_b16 a[204:205], v15 offset:24576
    v_subrev_u32 v21, 1024, v21
    v_mfma_f32_16x16x32_bf16 v[196:199], a[216:219], v[148:151], v[196:199]
    ds_read_b64_tr_b16 a[206:207], v15 offset:28672
    v_add_u32 v46, 16, v44
    v_mfma_f32_16x16x32_bf16 v[244:247], a[220:223], v[148:151], v[244:247]
    buffer_load_dwordx4 a[92:95], v2, s[16:19], s67 offen offset:3072 sc1
    v_mfma_f32_16x16x32_bf16 v[240:243], a[220:223], v[144:147], v[240:243]
    s_add_u32 s67, s67, 4096
    s_cmp_eq_u32 s67, s69
    s_cselect_b32 s67, s68, s67
    v_mfma_f32_16x16x32_bf16 v[192:195], a[216:219], v[144:147], v[192:195]
    s_waitcnt vmcnt(8) lgkmcnt(4)
    buffer_load_dwordx4 a[96:99], v2, s[16:19], s67 offen offset:0 sc1
    v_mfma_f32_16x16x32_bf16 v[48:51], a[192:195], a[48:51], v[48:51]
    ds_read_b64_tr_b16 a[208:209], v16 offset:24576
    v_bfe_u32 v47, v46, 1, 3
    v_mfma_f32_16x16x32_bf16 v[64:67], a[196:199], a[48:51], v[64:67]
    ds_read_b64_tr_b16 a[210:211], v16 offset:28672
    v_xor_b32 v47, v47, v45
    v_mfma_f32_16x16x32_bf16 v[68:71], a[196:199], a[52:55], v[68:71]
    v_lshlrev_b32 v47, 4, v47
    v_add_u32 v46, s81, v46
    v_mfma_f32_16x16x32_bf16 v[52:55], a[192:195], a[52:55], v[52:55]
    ds_read_b64_tr_b16 a[212:213], v17 offset:24576
    v_and_b32 v46, 127, v46
    v_mfma_f32_16x16x32_bf16 v[56:59], a[192:195], a[56:59], v[56:59]
    ds_read_b64_tr_b16 a[214:215], v17 offset:28672
    v_lshl_add_u32 v22, v46, 11, v47
    v_mfma_f32_16x16x32_bf16 v[72:75], a[196:199], a[56:59], v[72:75]
    buffer_load_dwordx4 a[100:103], v2, s[16:19], s67 offen offset:1024 sc1
    v_mfma_f32_16x16x32_bf16 v[76:79], a[196:199], a[60:63], v[76:79]
    v_subrev_u32 v22, 2048, v22
    v_add_u32 v46, 24, v44
    v_mfma_f32_16x16x32_bf16 v[60:63], a[192:195], a[60:63], v[60:63]
    s_waitcnt lgkmcnt(4)
    v_bfe_u32 v47, v46, 1, 3
    v_xor_b32 v47, v47, v45
    v_mfma_f32_16x16x32_bf16 v[92:95], a[200:203], a[60:63], v[92:95]
    ds_read_b64_tr_b16 a[216:217], v18 offset:24576
    v_lshlrev_b32 v47, 4, v47
    v_mfma_f32_16x16x32_bf16 v[108:111], a[204:207], a[60:63], v[108:111]
    ds_read_b64_tr_b16 a[218:219], v18 offset:28672
    v_add_u32 v46, s81, v46
    v_mfma_f32_16x16x32_bf16 v[104:107], a[204:207], a[56:59], v[104:107]
    buffer_load_dwordx4 a[104:107], v2, s[16:19], s67 offen offset:2048 sc1
    v_mfma_f32_16x16x32_bf16 v[88:91], a[200:203], a[56:59], v[88:91]
    ds_read_b64_tr_b16 a[220:221], v19 offset:24576
    v_and_b32 v46, 127, v46
    v_mfma_f32_16x16x32_bf16 v[84:87], a[200:203], a[52:55], v[84:87]
    ds_read_b64_tr_b16 a[222:223], v19 offset:28672
    v_lshl_add_u32 v23, v46, 11, v47
    v_mfma_f32_16x16x32_bf16 v[100:103], a[204:207], a[52:55], v[100:103]
    v_subrev_u32 v23, 3072, v23
    v_add_u32 v46, 32, v44
    v_mfma_f32_16x16x32_bf16 v[96:99], a[204:207], a[48:51], v[96:99]
    buffer_load_dwordx4 a[108:111], v2, s[16:19], s67 offen offset:3072 sc1
    v_mfma_f32_16x16x32_bf16 v[80:83], a[200:203], a[48:51], v[80:83]
    s_add_u32 s67, s67, 4096
    s_waitcnt lgkmcnt(4)
    s_barrier
    v_mfma_f32_16x16x32_bf16 v[112:115], a[208:211], a[48:51], v[112:115]
    s_cmp_eq_u32 s67, s69
    s_cselect_b32 s67, s68, s67
    ds_read_b64_tr_b16 a[192:193], v12 offset:32768
    v_mfma_f32_16x16x32_bf16 v[176:179], a[212:215], a[48:51], v[176:179]
    ds_read_b64_tr_b16 a[194:195], v12 offset:36864
    v_bfe_u32 v47, v46, 1, 3
    v_mfma_f32_16x16x32_bf16 v[180:183], a[212:215], a[52:55], v[180:183]
    buffer_load_dwordx4 a[112:115], v2, s[16:19], s67 offen offset:0 sc1
    v_mfma_f32_16x16x32_bf16 v[116:119], a[208:211], a[52:55], v[116:119]
    ds_read_b64_tr_b16 a[196:197], v13 offset:32768
    v_xor_b32 v47, v47, v45
    v_mfma_f32_16x16x32_bf16 v[120:123], a[208:211], a[56:59], v[120:123]
    ds_read_b64_tr_b16 a[198:199], v13 offset:36864
    v_lshlrev_b32 v47, 4, v47
    v_mfma_f32_16x16x32_bf16 v[184:187], a[212:215], a[56:59], v[184:187]
    v_add_u32 v46, s81, v46
    v_and_b32 v46, 127, v46
    v_mfma_f32_16x16x32_bf16 v[188:191], a[212:215], a[60:63], v[188:191]
    buffer_load_dwordx4 a[116:119], v2, s[16:19], s67 offen offset:1024 sc1
    v_mfma_f32_16x16x32_bf16 v[124:127], a[208:211], a[60:63], v[124:127]
    s_waitcnt lgkmcnt(4)
    v_lshl_add_u32 v24, v46, 11, v47
    v_add_u32 v46, 40, v44
    v_mfma_f32_16x16x32_bf16 v[204:207], a[216:219], a[60:63], v[204:207]
    ds_read_b64_tr_b16 a[200:201], v14 offset:32768
    v_bfe_u32 v47, v46, 1, 3
    v_mfma_f32_16x16x32_bf16 v[252:255], a[220:223], a[60:63], v[252:255]
    ds_read_b64_tr_b16 a[202:203], v14 offset:36864
    v_xor_b32 v47, v47, v45
    v_mfma_f32_16x16x32_bf16 v[248:251], a[220:223], a[56:59], v[248:251]
    buffer_load_dwordx4 a[120:123], v2, s[16:19], s67 offen offset:2048 sc1
    v_mfma_f32_16x16x32_bf16 v[200:203], a[216:219], a[56:59], v[200:203]
    ds_read_b64_tr_b16 a[204:205], v15 offset:32768
    v_lshlrev_b32 v47, 4, v47
    v_mfma_f32_16x16x32_bf16 v[196:199], a[216:219], a[52:55], v[196:199]
    ds_read_b64_tr_b16 a[206:207], v15 offset:36864
    v_add_u32 v46, s81, v46
    v_mfma_f32_16x16x32_bf16 v[244:247], a[220:223], a[52:55], v[244:247]
    v_and_b32 v46, 127, v46
    v_lshl_add_u32 v25, v46, 11, v47
    v_mfma_f32_16x16x32_bf16 v[240:243], a[220:223], a[48:51], v[240:243]
    buffer_load_dwordx4 a[124:127], v2, s[16:19], s67 offen offset:3072 sc1
    v_mfma_f32_16x16x32_bf16 v[192:195], a[216:219], a[48:51], v[192:195]
    s_add_u32 s67, s67, 4096
    s_waitcnt vmcnt(12) lgkmcnt(4)
    v_subrev_u32 v25, 1024, v25
    v_mfma_f32_16x16x32_bf16 v[48:51], a[192:195], a[64:67], v[48:51]
    s_cmp_eq_u32 s67, s69
    s_cselect_b32 s67, s68, s67
    ds_read_b64_tr_b16 a[208:209], v16 offset:32768
    v_mfma_f32_16x16x32_bf16 v[64:67], a[196:199], a[64:67], v[64:67]
    ds_read_b64_tr_b16 a[210:211], v16 offset:36864
    v_add_u32 v46, 48, v44
    v_mfma_f32_16x16x32_bf16 v[68:71], a[196:199], a[68:71], v[68:71]
    buffer_load_dwordx4 a[128:131], v2, s[16:19], s67 offen offset:0 sc1
    v_mfma_f32_16x16x32_bf16 v[52:55], a[192:195], a[68:71], v[52:55]
    ds_read_b64_tr_b16 a[212:213], v17 offset:32768
    v_bfe_u32 v47, v46, 1, 3
    v_mfma_f32_16x16x32_bf16 v[56:59], a[192:195], a[72:75], v[56:59]
    ds_read_b64_tr_b16 a[214:215], v17 offset:36864
    v_xor_b32 v47, v47, v45
    v_mfma_f32_16x16x32_bf16 v[72:75], a[196:199], a[72:75], v[72:75]
    v_lshlrev_b32 v47, 4, v47
    v_add_u32 v46, s81, v46
    v_mfma_f32_16x16x32_bf16 v[76:79], a[196:199], a[76:79], v[76:79]
    buffer_load_dwordx4 a[132:135], v2, s[16:19], s67 offen offset:1024 sc1
    v_mfma_f32_16x16x32_bf16 v[60:63], a[192:195], a[76:79], v[60:63]
    s_waitcnt lgkmcnt(4)
    v_and_b32 v46, 127, v46
    v_lshl_add_u32 v26, v46, 11, v47
    v_mfma_f32_16x16x32_bf16 v[92:95], a[200:203], a[76:79], v[92:95]
    ds_read_b64_tr_b16 a[216:217], v18 offset:32768
    v_subrev_u32 v26, 2048, v26
    v_mfma_f32_16x16x32_bf16 v[108:111], a[204:207], a[76:79], v[108:111]
    ds_read_b64_tr_b16 a[218:219], v18 offset:36864
    v_add_u32 v46, 56, v44
    v_mfma_f32_16x16x32_bf16 v[104:107], a[204:207], a[72:75], v[104:107]
    buffer_load_dwordx4 a[136:139], v2, s[16:19], s67 offen offset:2048 sc1
    v_mfma_f32_16x16x32_bf16 v[88:91], a[200:203], a[72:75], v[88:91]
    ds_read_b64_tr_b16 a[220:221], v19 offset:32768
    v_bfe_u32 v47, v46, 1, 3
    v_mfma_f32_16x16x32_bf16 v[84:87], a[200:203], a[68:71], v[84:87]
    ds_read_b64_tr_b16 a[222:223], v19 offset:36864
    v_xor_b32 v47, v47, v45
    v_mfma_f32_16x16x32_bf16 v[100:103], a[204:207], a[68:71], v[100:103]
    v_lshlrev_b32 v47, 4, v47
    v_add_u32 v46, s81, v46
    v_mfma_f32_16x16x32_bf16 v[96:99], a[204:207], a[64:67], v[96:99]
    buffer_load_dwordx4 a[140:143], v2, s[16:19], s67 offen offset:3072 sc1
    v_mfma_f32_16x16x32_bf16 v[80:83], a[200:203], a[64:67], v[80:83]
    s_add_u32 s67, s67, 4096
    s_waitcnt lgkmcnt(4)
    v_and_b32 v46, 127, v46
    v_mfma_f32_16x16x32_bf16 v[112:115], a[208:211], a[64:67], v[112:115]
    s_cmp_eq_u32 s67, s69
    s_cselect_b32 s67, s68, s67
    ds_read_b64_tr_b16 a[192:193], v12 offset:40960
    v_mfma_f32_16x16x32_bf16 v[176:179], a[212:215], a[64:67], v[176:179]
    ds_read_b64_tr_b16 a[194:195], v12 offset:45056
    v_lshl_add_u32 v27, v46, 11, v47
    v_mfma_f32_16x16x32_bf16 v[180:183], a[212:215], a[68:71], v[180:183]
    buffer_load_dwordx4 a[144:147], v2, s[16:19], s67 offen offset:0 sc1
    v_mfma_f32_16x16x32_bf16 v[116:119], a[208:211], a[68:71], v[116:119]
    ds_read_b64_tr_b16 a[196:197], v13 offset:40960
    v_subrev_u32 v27, 3072, v27
    v_mfma_f32_16x16x32_bf16 v[120:123], a[208:211], a[72:75], v[120:123]
    ds_read_b64_tr_b16 a[198:199], v13 offset:45056
    v_lshrrev_b32 v44, 1, v41
    v_mfma_f32_16x16x32_bf16 v[184:187], a[212:215], a[72:75], v[184:187]
    v_xor_b32 v44, v44, v40
    v_lshlrev_b32 v44, 4, v44
    v_mfma_f32_16x16x32_bf16 v[188:191], a[212:215], a[76:79], v[188:191]
    v_lshl_add_u32 v28, v41, 7, v44
    v_xor_b32 v29, 64, v28
    v_mfma_f32_16x16x32_bf16 v[124:127], a[208:211], a[76:79], v[124:127]
    s_waitcnt lgkmcnt(4)
    buffer_load_dwordx4 a[148:151], v2, s[16:19], s67 offen offset:1024 sc1
    v_mfma_f32_16x16x32_bf16 v[204:207], a[216:219], a[76:79], v[204:207]
    ds_read_b64_tr_b16 a[200:201], v14 offset:40960
    v_add_u32 v30, 0x10000, v28
    v_mfma_f32_16x16x32_bf16 v[252:255], a[220:223], a[76:79], v[252:255]
    ds_read_b64_tr_b16 a[202:203], v14 offset:45056
    v_add_u32 v31, 0x10000, v29
    v_mfma_f32_16x16x32_bf16 v[248:251], a[220:223], a[72:75], v[248:251]
    v_mov_b32 v32, 0
    v_mov_b32 v33, 0
    v_mfma_f32_16x16x32_bf16 v[200:203], a[216:219], a[72:75], v[200:203]
    ds_read_b64_tr_b16 a[204:205], v15 offset:40960
    v_mov_b32 v36, 0
    v_mfma_f32_16x16x32_bf16 v[196:199], a[216:219], a[68:71], v[196:199]
    ds_read_b64_tr_b16 a[206:207], v15 offset:45056
    v_mov_b32 v37, 0
    v_mfma_f32_16x16x32_bf16 v[244:247], a[220:223], a[68:71], v[244:247]
    buffer_load_dwordx4 a[152:155], v2, s[16:19], s67 offen offset:2048 sc1
    v_mfma_f32_16x16x32_bf16 v[240:243], a[220:223], a[64:67], v[240:243]
    v_lshlrev_b32 v44, 2, v40
    v_sub_u32 v44, v41, v44
    v_mfma_f32_16x16x32_bf16 v[192:195], a[216:219], a[64:67], v[192:195]
    s_waitcnt vmcnt(15) lgkmcnt(4)
    v_and_b32 v45, 1, v44
    v_lshlrev_b32 v45, 4, v45
    v_mfma_f32_16x16x32_bf16 v[48:51], a[192:195], a[80:83], v[48:51]
    ds_read_b64_tr_b16 a[208:209], v16 offset:40960
    v_mov_b32 v46, 0x3f80
    v_mfma_f32_16x16x32_bf16 v[64:67], a[196:199], a[80:83], v[64:67]
    ds_read_b64_tr_b16 a[210:211], v16 offset:45056
    v_lshlrev_b32 v45, v45, v46
    v_mfma_f32_16x16x32_bf16 v[68:71], a[196:199], a[84:87], v[68:71]
    buffer_load_dwordx4 a[156:159], v2, s[16:19], s67 offen offset:3072 sc1
    v_mfma_f32_16x16x32_bf16 v[52:55], a[192:195], a[84:87], v[52:55]
    s_add_u32 s67, s67, 4096
    ds_read_b64_tr_b16 a[212:213], v17 offset:40960
    v_lshrrev_b32 v44, 1, v44
    v_mfma_f32_16x16x32_bf16 v[56:59], a[192:195], a[88:91], v[56:59]
    s_cmp_eq_u32 s67, s69
    s_cselect_b32 s67, s68, s67
    ds_read_b64_tr_b16 a[214:215], v17 offset:45056
    v_mfma_f32_16x16x32_bf16 v[72:75], a[196:199], a[88:91], v[72:75]
    v_cmp_eq_u32 s[82:83], 0, v44
    v_cmp_eq_u32 s[84:85], 1, v44
    v_mfma_f32_16x16x32_bf16 v[76:79], a[196:199], a[92:95], v[76:79]
    v_mov_b32 v46, 0
    v_mov_b32 v47, 0
    v_mfma_f32_16x16x32_bf16 v[60:63], a[192:195], a[92:95], v[60:63]
    s_waitcnt lgkmcnt(4)
    buffer_load_dwordx4 a[160:163], v2, s[16:19], s67 offen offset:0 sc1
    v_mfma_f32_16x16x32_bf16 v[92:95], a[200:203], a[92:95], v[92:95]
    ds_read_b64_tr_b16 a[216:217], v18 offset:40960
    v_cndmask_b32 v34, v46, v45, s[82:83]
    v_mfma_f32_16x16x32_bf16 v[108:111], a[204:207], a[92:95], v[108:111]
    ds_read_b64_tr_b16 a[218:219], v18 offset:45056
    v_cndmask_b32 v35, v46, v45, s[84:85]
    v_mfma_f32_16x16x32_bf16 v[104:107], a[204:207], a[88:91], v[104:107]
    v_mfma_f32_16x16x32_bf16 v[88:91], a[200:203], a[88:91], v[88:91]
    ds_read_b64_tr_b16 a[220:221], v19 offset:40960
    v_mfma_f32_16x16x32_bf16 v[84:87], a[200:203], a[84:87], v[84:87]
    ds_read_b64_tr_b16 a[222:223], v19 offset:45056
    v_mfma_f32_16x16x32_bf16 v[100:103], a[204:207], a[84:87], v[100:103]
    buffer_load_dwordx4 a[164:167], v2, s[16:19], s67 offen offset:1024 sc1
    v_mfma_f32_16x16x32_bf16 v[96:99], a[204:207], a[80:83], v[96:99]
    v_mfma_f32_16x16x32_bf16 v[80:83], a[200:203], a[80:83], v[80:83]
    s_waitcnt lgkmcnt(4)
    v_mfma_f32_16x16x32_bf16 v[112:115], a[208:211], a[80:83], v[112:115]
    ds_read_b64_tr_b16 a[192:193], v12 offset:49152
    v_mfma_f32_16x16x32_bf16 v[176:179], a[212:215], a[80:83], v[176:179]
    ds_read_b64_tr_b16 a[194:195], v12 offset:53248
    v_mfma_f32_16x16x32_bf16 v[180:183], a[212:215], a[84:87], v[180:183]
    buffer_load_dwordx4 a[168:171], v2, s[16:19], s67 offen offset:2048 sc1
    v_mfma_f32_16x16x32_bf16 v[116:119], a[208:211], a[84:87], v[116:119]
    ds_read_b64_tr_b16 a[196:197], v13 offset:49152
    v_mfma_f32_16x16x32_bf16 v[120:123], a[208:211], a[88:91], v[120:123]
    ds_read_b64_tr_b16 a[198:199], v13 offset:53248
    v_mfma_f32_16x16x32_bf16 v[184:187], a[212:215], a[88:91], v[184:187]
    v_mfma_f32_16x16x32_bf16 v[188:191], a[212:215], a[92:95], v[188:191]
    v_mfma_f32_16x16x32_bf16 v[124:127], a[208:211], a[92:95], v[124:127]
    s_waitcnt lgkmcnt(4)
    buffer_load_dwordx4 a[172:175], v2, s[16:19], s67 offen offset:3072 sc1
    v_mfma_f32_16x16x32_bf16 v[204:207], a[216:219], a[92:95], v[204:207]
    s_add_u32 s67, s67, 4096
    ds_read_b64_tr_b16 a[200:201], v14 offset:49152
    v_mfma_f32_16x16x32_bf16 v[252:255], a[220:223], a[92:95], v[252:255]
    s_cmp_eq_u32 s67, s69
    s_cselect_b32 s67, s68, s67
    ds_read_b64_tr_b16 a[202:203], v14 offset:53248
    v_mfma_f32_16x16x32_bf16 v[248:251], a[220:223], a[88:91], v[248:251]
    v_mfma_f32_16x16x32_bf16 v[200:203], a[216:219], a[88:91], v[200:203]
    ds_read_b64_tr_b16 a[204:205], v15 offset:49152
    v_mfma_f32_16x16x32_bf16 v[196:199], a[216:219], a[84:87], v[196:199]
    ds_read_b64_tr_b16 a[206:207], v15 offset:53248
    v_mfma_f32_16x16x32_bf16 v[244:247], a[220:223], a[84:87], v[244:247]
    buffer_load_dwordx4 a[176:179], v2, s[16:19], s67 offen offset:0 sc1
    v_mfma_f32_16x16x32_bf16 v[240:243], a[220:223], a[80:83], v[240:243]
    v_mfma_f32_16x16x32_bf16 v[192:195], a[216:219], a[80:83], v[192:195]
    s_waitcnt vmcnt(17) lgkmcnt(4)
    v_mfma_f32_16x16x32_bf16 v[48:51], a[192:195], a[96:99], v[48:51]
    ds_read_b64_tr_b16 a[208:209], v16 offset:49152
    v_mfma_f32_16x16x32_bf16 v[64:67], a[196:199], a[96:99], v[64:67]
    ds_read_b64_tr_b16 a[210:211], v16 offset:53248
    v_mfma_f32_16x16x32_bf16 v[68:71], a[196:199], a[100:103], v[68:71]
    buffer_load_dwordx4 a[180:183], v2, s[16:19], s67 offen offset:1024 sc1
    v_mfma_f32_16x16x32_bf16 v[52:55], a[192:195], a[100:103], v[52:55]
    ds_read_b64_tr_b16 a[212:213], v17 offset:49152
    v_mfma_f32_16x16x32_bf16 v[56:59], a[192:195], a[104:107], v[56:59]
    ds_read_b64_tr_b16 a[214:215], v17 offset:53248
    v_mfma_f32_16x16x32_bf16 v[72:75], a[196:199], a[104:107], v[72:75]
    v_mfma_f32_16x16x32_bf16 v[76:79], a[196:199], a[108:111], v[76:79]
    v_mfma_f32_16x16x32_bf16 v[60:63], a[192:195], a[108:111], v[60:63]
    s_waitcnt lgkmcnt(4)
    buffer_load_dwordx4 a[184:187], v2, s[16:19], s67 offen offset:2048 sc1
    v_mfma_f32_16x16x32_bf16 v[92:95], a[200:203], a[108:111], v[92:95]
    ds_read_b64_tr_b16 a[216:217], v18 offset:49152
    v_mfma_f32_16x16x32_bf16 v[108:111], a[204:207], a[108:111], v[108:111]
    ds_read_b64_tr_b16 a[218:219], v18 offset:53248
    v_mfma_f32_16x16x32_bf16 v[104:107], a[204:207], a[104:107], v[104:107]
    v_mfma_f32_16x16x32_bf16 v[88:91], a[200:203], a[104:107], v[88:91]
    ds_read_b64_tr_b16 a[220:221], v19 offset:49152
    v_mfma_f32_16x16x32_bf16 v[84:87], a[200:203], a[100:103], v[84:87]
    ds_read_b64_tr_b16 a[222:223], v19 offset:53248
    v_mfma_f32_16x16x32_bf16 v[100:103], a[204:207], a[100:103], v[100:103]
    buffer_load_dwordx4 a[188:191], v2, s[16:19], s67 offen offset:3072 sc1
    v_mfma_f32_16x16x32_bf16 v[96:99], a[204:207], a[96:99], v[96:99]
    s_add_u32 s67, s67, 4096
    s_cmp_eq_u32 s67, s69
    s_cselect_b32 s67, s68, s67
    v_mfma_f32_16x16x32_bf16 v[80:83], a[200:203], a[96:99], v[80:83]
    s_waitcnt lgkmcnt(4)
    v_mfma_f32_16x16x32_bf16 v[112:115], a[208:211], a[96:99], v[112:115]
    ds_read_b64_tr_b16 a[192:193], v12 offset:57344
    v_mfma_f32_16x16x32_bf16 v[176:179], a[212:215], a[96:99], v[176:179]
    ds_read_b64_tr_b16 a[194:195], v12 offset:61440
    v_xor_b32 v12, 0x10000, v12
    v_mfma_f32_16x16x32_bf16 v[180:183], a[212:215], a[100:103], v[180:183]
    buffer_store_dword v43, v42, s[36:39], s61 offen offset:32 sc1
    v_mfma_f32_16x16x32_bf16 v[116:119], a[208:211], a[100:103], v[116:119]
    ds_read_b64_tr_b16 a[196:197], v13 offset:57344
    v_lshl_add_u32 v47, v41, 5, s78
    v_mfma_f32_16x16x32_bf16 v[120:123], a[208:211], a[104:107], v[120:123]
    s_add_u32 m0, s60, 98304
    ds_read_b64_tr_b16 a[198:199], v13 offset:61440
    v_xor_b32 v13, 0x10000, v13
    v_mfma_f32_16x16x32_bf16 v[184:187], a[212:215], a[104:107], v[184:187]
    buffer_load_dwordx4 v3, s[24:27], s71 offen offset:0  lds
    v_mfma_f32_16x16x32_bf16 v[188:191], a[212:215], a[108:111], v[188:191]
    ds_read_b128 v[128:131], v47 offset:1024
    v_mfma_f32_16x16x32_bf16 v[124:127], a[208:211], a[108:111], v[124:127]
    s_waitcnt lgkmcnt(5)
    ds_read_b128 v[132:135], v47 offset:1040
    v_lshl_add_u32 v47, v41, 6, s78
    v_mfma_f32_16x16x32_bf16 v[204:207], a[216:219], a[108:111], v[204:207]
    ds_read_b64_tr_b16 a[200:201], v14 offset:57344
    v_lshl_add_u32 v47, v40, 3, v47
    v_mfma_f32_16x16x32_bf16 v[252:255], a[220:223], a[108:111], v[252:255]
    ds_read_b64_tr_b16 a[202:203], v14 offset:61440
    v_xor_b32 v14, 0x10000, v14
    v_mfma_f32_16x16x32_bf16 v[248:251], a[220:223], a[104:107], v[248:251]
    buffer_load_dwordx4 v4, s[24:27], s71 offen offset:1024  lds
    v_mfma_f32_16x16x32_bf16 v[200:203], a[216:219], a[104:107], v[200:203]
    ds_read_b64_tr_b16 a[204:205], v15 offset:57344
    v_mfma_f32_16x16x32_bf16 v[196:199], a[216:219], a[100:103], v[196:199]
    ds_read_b64_tr_b16 a[206:207], v15 offset:61440
    v_xor_b32 v15, 0x10000, v15
    v_mfma_f32_16x16x32_bf16 v[244:247], a[220:223], a[100:103], v[244:247]
    ds_read_b64 v[140:141], v47 offset:4096
    v_mfma_f32_16x16x32_bf16 v[240:243], a[220:223], a[96:99], v[240:243]
    ds_read_b64 v[142:143], v47 offset:4128
    v_mfma_f32_16x16x32_bf16 v[192:195], a[216:219], a[96:99], v[192:195]
    s_waitcnt vmcnt(19) lgkmcnt(8)
    buffer_load_dwordx4 v5, s[24:27], s71 offen offset:2048  lds
    v_mfma_f32_16x16x32_bf16 v[48:51], a[192:195], a[112:115], v[48:51]
    ds_read_b64_tr_b16 a[208:209], v16 offset:57344
    v_mfma_f32_16x16x32_bf16 v[64:67], a[196:199], a[112:115], v[64:67]
    ds_read_b64_tr_b16 a[210:211], v16 offset:61440
    v_xor_b32 v16, 0x10000, v16
    v_mfma_f32_16x16x32_bf16 v[68:71], a[196:199], a[116:119], v[68:71]
    ds_read_b64 v[144:145], v47 offset:5120
    v_mfma_f32_16x16x32_bf16 v[52:55], a[192:195], a[116:119], v[52:55]
    ds_read_b64_tr_b16 a[212:213], v17 offset:57344
    v_mfma_f32_16x16x32_bf16 v[56:59], a[192:195], a[120:123], v[56:59]
    ds_read_b64_tr_b16 a[214:215], v17 offset:61440
    v_xor_b32 v17, 0x10000, v17
    v_mfma_f32_16x16x32_bf16 v[72:75], a[196:199], a[120:123], v[72:75]
    buffer_load_dwordx4 v6, s[24:27], s71 offen offset:3072  lds
    v_mfma_f32_16x16x32_bf16 v[76:79], a[196:199], a[124:127], v[76:79]
    ds_read_b64 v[146:147], v47 offset:5152
    v_mfma_f32_16x16x32_bf16 v[60:63], a[192:195], a[124:127], v[60:63]
LF_pad9:
    s_cbranch_execz LF_pad13
    s_waitcnt lgkmcnt(8)
    ds_read_b64 v[148:149], v47 offset:6144
    v_mfma_f32_16x16x32_bf16 v[92:95], a[200:203], a[124:127], v[92:95]
    ds_read_b64_tr_b16 a[216:217], v18 offset:57344
    v_mfma_f32_16x16x32_bf16 v[108:111], a[204:207], a[124:127], v[108:111]
    s_add_u32 m0, s60, 102400
    ds_read_b64_tr_b16 a[218:219], v18 offset:61440
    v_xor_b32 v18, 0x10000, v18
    v_mfma_f32_16x16x32_bf16 v[104:107], a[204:207], a[120:123], v[104:107]
    buffer_load_dwordx4 v7, s[24:27], s71 offen offset:0  lds
    v_mfma_f32_16x16x32_bf16 v[88:91], a[200:203], a[120:123], v[88:91]
    ds_read_b64_tr_b16 a[220:221], v19 offset:57344
    v_mfma_f32_16x16x32_bf16 v[84:87], a[200:203], a[116:119], v[84:87]
    ds_read_b64_tr_b16 a[222:223], v19 offset:61440
    v_xor_b32 v19, 0x10000, v19
    v_mfma_f32_16x16x32_bf16 v[100:103], a[204:207], a[116:119], v[100:103]
    ds_read_b64 v[150:151], v47 offset:6176
    v_mfma_f32_16x16x32_bf16 v[96:99], a[204:207], a[112:115], v[96:99]
    ds_read_b64 v[152:153], v47 offset:7168
    v_mfma_f32_16x16x32_bf16 v[80:83], a[200:203], a[112:115], v[80:83]
    s_waitcnt lgkmcnt(8)
    s_barrier
    ds_read_b64 v[154:155], v47 offset:7200
    v_mfma_f32_16x16x32_bf16 v[112:115], a[208:211], a[112:115], v[112:115]
    ds_read_b64_tr_b16 a[192:193], v12 offset:0
    v_accvgpr_read_b32 v136, a224
    v_mfma_f32_16x16x32_bf16 v[176:179], a[212:215], a[112:115], v[176:179]
    ds_read_b64_tr_b16 a[194:195], v12 offset:4096
    v_accvgpr_read_b32 v137, a225
    v_mfma_f32_16x16x32_bf16 v[180:183], a[212:215], a[116:119], v[180:183]
    buffer_load_dwordx4 v8, s[24:27], s71 offen offset:1024  lds
    v_mfma_f32_16x16x32_bf16 v[116:119], a[208:211], a[116:119], v[116:119]
    ds_read_b64_tr_b16 a[196:197], v13 offset:0
    v_accvgpr_read_b32 v138, a226
    v_mfma_f32_16x16x32_bf16 v[120:123], a[208:211], a[120:123], v[120:123]
    ds_read_b64_tr_b16 a[198:199], v13 offset:4096
    v_accvgpr_read_b32 v139, a227
    v_mfma_f32_16x16x32_bf16 v[184:187], a[212:215], a[120:123], v[184:187]
    v_mfma_f32_16x16x32_bf16 v[188:191], a[212:215], a[124:127], v[188:191]
    v_mfma_f32_16x16x32_bf16 v[124:127], a[208:211], a[124:127], v[124:127]
    s_waitcnt lgkmcnt(7)
    buffer_load_dwordx4 v9, s[24:27], s71 offen offset:2048  lds
    v_mfma_f32_16x16x32_bf16 v[204:207], a[216:219], a[124:127], v[204:207]
    ds_read_b64_tr_b16 a[200:201], v14 offset:0
    v_mfma_f32_16x16x32_bf16 v[252:255], a[220:223], a[124:127], v[252:255]
    ds_read_b64_tr_b16 a[202:203], v14 offset:4096
    v_mfma_f32_16x16x32_bf16 v[248:251], a[220:223], a[120:123], v[248:251]
    v_mfma_f32_16x16x32_bf16 v[200:203], a[216:219], a[120:123], v[200:203]
    ds_read_b64_tr_b16 a[204:205], v15 offset:0
    v_mfma_f32_16x16x32_bf16 v[196:199], a[216:219], a[116:119], v[196:199]
    ds_read_b64_tr_b16 a[206:207], v15 offset:4096
    v_mfma_f32_16x16x32_bf16 v[244:247], a[220:223], a[116:119], v[244:247]
    buffer_load_dwordx4 v10, s[24:27], s71 offen offset:3072  lds
    v_mfma_f32_16x16x32_bf16 v[240:243], a[220:223], a[112:115], v[240:243]
    s_add_u32 s3, s3, 4
    s_add_u32 s88, s3, 3
    v_lshlrev_b32 v156, 16, v136
    v_mfma_f32_16x16x32_bf16 v[192:195], a[216:219], a[112:115], v[192:195]
    s_cmp_ge_u32 s3, s72
    s_cselect_b32 s71, s88, s3
    s_waitcnt vmcnt(21) lgkmcnt(4)
    v_mfma_f32_16x16x32_bf16 v[48:51], a[192:195], a[128:131], v[48:51]
    s_add_u32 s88, s71, 3
    s_mul_i32 s88, s88, 43
    ds_read_b64_tr_b16 a[208:209], v16 offset:0
    v_mfma_f32_16x16x32_bf16 v[64:67], a[196:199], a[128:131], v[64:67]
    s_lshr_b32 s88, s88, 8
    s_add_u32 s71, s71, s88
    ds_read_b64_tr_b16 a[210:211], v16 offset:4096
    v_mfma_f32_16x16x32_bf16 v[68:71], a[196:199], a[132:135], v[68:71]
    s_lshl_b32 s71, s71, 16
    s_add_u32 s71, s71, s89
    v_and_b32 v157, 0xffff0000, v136
    v_mfma_f32_16x16x32_bf16 v[52:55], a[192:195], a[132:135], v[52:55]
    ds_read_b64_tr_b16 a[212:213], v17 offset:0
    v_lshlrev_b32 v158, 16, v137
    v_mfma_f32_16x16x32_bf16 v[56:59], a[192:195], a[136:139], v[56:59]
    ds_read_b64_tr_b16 a[214:215], v17 offset:4096
    v_and_b32 v159, 0xffff0000, v137
    v_mfma_f32_16x16x32_bf16 v[72:75], a[196:199], a[136:139], v[72:75]
    buffer_load_dwordx4 a[0:3], v2, s[16:19], s67 offen offset:0 sc1
    v_mfma_f32_16x16x32_bf16 v[76:79], a[196:199], a[140:143], v[76:79]
    v_lshlrev_b32 v160, 16, v138
    v_and_b32 v161, 0xffff0000, v138
    v_mfma_f32_16x16x32_bf16 v[60:63], a[192:195], a[140:143], v[60:63]
    s_waitcnt lgkmcnt(4)
    v_lshlrev_b32 v162, 16, v139
    v_and_b32 v163, 0xffff0000, v139
    v_mfma_f32_16x16x32_bf16 v[92:95], a[200:203], a[140:143], v[92:95]
    ds_read_b64_tr_b16 a[216:217], v18 offset:0
    v_mfma_f32_16x16x32_bf16 v[108:111], a[204:207], a[140:143], v[108:111]
    ds_read_b64_tr_b16 a[218:219], v18 offset:4096
    v_mfma_f32_16x16x32_bf16 v[104:107], a[204:207], a[136:139], v[104:107]
    buffer_load_dwordx4 a[4:7], v2, s[16:19], s67 offen offset:1024 sc1
    v_mfma_f32_16x16x32_bf16 v[88:91], a[200:203], a[136:139], v[88:91]
    ds_read_b64_tr_b16 a[220:221], v19 offset:0
    v_mfma_f32_16x16x32_bf16 v[84:87], a[200:203], a[132:135], v[84:87]
    ds_read_b64_tr_b16 a[222:223], v19 offset:4096
    v_mfma_f32_16x16x32_bf16 v[100:103], a[204:207], a[132:135], v[100:103]
    v_mul_f32 v164, v128, v129
    v_mul_f32 v165, v130, v131
    v_mfma_f32_16x16x32_bf16 v[96:99], a[204:207], a[128:131], v[96:99]
    buffer_load_dwordx4 a[8:11], v2, s[16:19], s67 offen offset:2048 sc1
    v_mfma_f32_16x16x32_bf16 v[80:83], a[200:203], a[128:131], v[80:83]
    s_waitcnt lgkmcnt(4)
    v_mul_f32 v166, v132, v133
    v_mul_f32 v167, v134, v135
    v_mfma_f32_16x16x32_bf16 v[112:115], a[208:211], a[128:131], v[112:115]
    ds_read_b64_tr_b16 a[192:193], v12 offset:8192
    v_mfma_f32_16x16x32_bf16 v[176:179], a[212:215], a[128:131], v[176:179]
    ds_read_b64_tr_b16 a[194:195], v12 offset:12288
    v_mfma_f32_16x16x32_bf16 v[180:183], a[212:215], a[132:135], v[180:183]
    buffer_load_dwordx4 a[12:15], v2, s[16:19], s67 offen offset:3072 sc1
    v_mfma_f32_16x16x32_bf16 v[116:119], a[208:211], a[132:135], v[116:119]
    s_add_u32 s67, s67, 4096
    ds_read_b64_tr_b16 a[196:197], v13 offset:8192
    v_mfma_f32_16x16x32_bf16 v[120:123], a[208:211], a[136:139], v[120:123]
    s_cmp_eq_u32 s67, s69
    s_cselect_b32 s67, s68, s67
    ds_read_b64_tr_b16 a[198:199], v13 offset:12288
    v_mfma_f32_16x16x32_bf16 v[184:187], a[212:215], a[136:139], v[184:187]
    v_lshlrev_b32 v168, 16, v140
    v_fma_f32 v169, v168, v129, -v164
    v_mfma_f32_16x16x32_bf16 v[188:191], a[212:215], a[140:143], v[188:191]
    buffer_load_dwordx4 a[16:19], v2, s[16:19], s67 offen offset:0 sc1
    v_mfma_f32_16x16x32_bf16 v[124:127], a[208:211], a[140:143], v[124:127]
    s_waitcnt lgkmcnt(4)
    v_fma_f32 v208, v169, v156, v168
    v_and_b32 v168, 0xffff0000, v140
    v_mfma_f32_16x16x32_bf16 v[204:207], a[216:219], a[140:143], v[204:207]
    ds_read_b64_tr_b16 a[200:201], v14 offset:8192
    v_fma_f32 v169, v168, v129, -v164
    v_mfma_f32_16x16x32_bf16 v[252:255], a[220:223], a[140:143], v[252:255]
    ds_read_b64_tr_b16 a[202:203], v14 offset:12288
    v_fma_f32 v209, v169, v157, v168
    v_mfma_f32_16x16x32_bf16 v[248:251], a[220:223], a[136:139], v[248:251]
    v_lshlrev_b32 v168, 16, v141
    v_fma_f32 v169, v168, v129, -v164
    v_mfma_f32_16x16x32_bf16 v[200:203], a[216:219], a[136:139], v[200:203]
    ds_read_b64_tr_b16 a[204:205], v15 offset:8192
    v_fma_f32 v210, v169, v158, v168
    v_mfma_f32_16x16x32_bf16 v[196:199], a[216:219], a[132:135], v[196:199]
    ds_read_b64_tr_b16 a[206:207], v15 offset:12288
    v_and_b32 v168, 0xffff0000, v141
    v_mfma_f32_16x16x32_bf16 v[244:247], a[220:223], a[132:135], v[244:247]
    buffer_load_dwordx4 a[20:23], v2, s[16:19], s67 offen offset:1024 sc1
    v_mfma_f32_16x16x32_bf16 v[240:243], a[220:223], a[128:131], v[240:243]
    v_fma_f32 v169, v168, v129, -v164
    v_fma_f32 v211, v169, v159, v168
    v_mfma_f32_16x16x32_bf16 v[192:195], a[216:219], a[128:131], v[192:195]
    s_waitcnt vmcnt(23) lgkmcnt(4)
    v_lshlrev_b32 v168, 16, v142
    v_fma_f32 v169, v168, v129, -v164
    v_mfma_f32_16x16x32_bf16 v[48:51], a[192:195], a[144:147], v[48:51]
    ds_read_b64_tr_b16 a[208:209], v16 offset:8192
    v_fma_f32 v224, v169, v160, v168
    v_mfma_f32_16x16x32_bf16 v[64:67], a[196:199], a[144:147], v[64:67]
    ds_read_b64_tr_b16 a[210:211], v16 offset:12288
    v_and_b32 v168, 0xffff0000, v142
    v_mfma_f32_16x16x32_bf16 v[68:71], a[196:199], a[148:151], v[68:71]
    buffer_load_dwordx4 a[24:27], v2, s[16:19], s67 offen offset:2048 sc1
    v_mfma_f32_16x16x32_bf16 v[52:55], a[192:195], a[148:151], v[52:55]
    ds_read_b64_tr_b16 a[212:213], v17 offset:8192
    v_fma_f32 v169, v168, v129, -v164
    v_mfma_f32_16x16x32_bf16 v[56:59], a[192:195], a[152:155], v[56:59]
    ds_read_b64_tr_b16 a[214:215], v17 offset:12288
    v_fma_f32 v225, v169, v161, v168
    v_mfma_f32_16x16x32_bf16 v[72:75], a[196:199], a[152:155], v[72:75]
    v_lshlrev_b32 v168, 16, v143
    v_fma_f32 v169, v168, v129, -v164
    v_mfma_f32_16x16x32_bf16 v[76:79], a[196:199], a[156:159], v[76:79]
    v_fma_f32 v226, v169, v162, v168
    v_and_b32 v168, 0xffff0000, v143
    v_mfma_f32_16x16x32_bf16 v[60:63], a[192:195], a[156:159], v[60:63]
    s_waitcnt lgkmcnt(4)
    buffer_load_dwordx4 a[28:31], v2, s[16:19], s67 offen offset:3072 sc1
    v_mfma_f32_16x16x32_bf16 v[92:95], a[200:203], a[156:159], v[92:95]
    s_add_u32 s67, s67, 4096
    ds_read_b64_tr_b16 a[216:217], v18 offset:8192
    v_fma_f32 v169, v168, v129, -v164
    v_mfma_f32_16x16x32_bf16 v[108:111], a[204:207], a[156:159], v[108:111]
    s_cmp_eq_u32 s67, s69
    s_cselect_b32 s67, s68, s67
    ds_read_b64_tr_b16 a[218:219], v18 offset:12288
    v_mfma_f32_16x16x32_bf16 v[104:107], a[204:207], a[152:155], v[104:107]
    v_fma_f32 v227, v169, v163, v168
    v_lshlrev_b32 v168, 16, v144
    v_mfma_f32_16x16x32_bf16 v[88:91], a[200:203], a[152:155], v[88:91]
    ds_read_b64_tr_b16 a[220:221], v19 offset:8192
    v_fma_f32 v169, v168, v131, -v165
    v_mfma_f32_16x16x32_bf16 v[84:87], a[200:203], a[148:151], v[84:87]
    ds_read_b64_tr_b16 a[222:223], v19 offset:12288
    v_fma_f32 v212, v169, v156, v168
    v_mfma_f32_16x16x32_bf16 v[100:103], a[204:207], a[148:151], v[100:103]
    buffer_load_dwordx4 a[32:35], v2, s[16:19], s67 offen offset:0 sc1
    v_mfma_f32_16x16x32_bf16 v[96:99], a[204:207], a[144:147], v[96:99]
    v_and_b32 v168, 0xffff0000, v144
    v_fma_f32 v169, v168, v131, -v165
    v_mfma_f32_16x16x32_bf16 v[80:83], a[200:203], a[144:147], v[80:83]
    s_waitcnt lgkmcnt(4)
    v_fma_f32 v213, v169, v157, v168
    v_lshlrev_b32 v168, 16, v145
    v_mfma_f32_16x16x32_bf16 v[112:115], a[208:211], a[144:147], v[112:115]
    ds_read_b64_tr_b16 a[192:193], v12 offset:16384
    v_fma_f32 v169, v168, v131, -v165
    v_mfma_f32_16x16x32_bf16 v[176:179], a[212:215], a[144:147], v[176:179]
    ds_read_b64_tr_b16 a[194:195], v12 offset:20480
    v_fma_f32 v214, v169, v158, v168
    v_mfma_f32_16x16x32_bf16 v[180:183], a[212:215], a[148:151], v[180:183]
    buffer_load_dwordx4 a[36:39], v2, s[16:19], s67 offen offset:1024 sc1
    v_mfma_f32_16x16x32_bf16 v[116:119], a[208:211], a[148:151], v[116:119]
    ds_read_b64_tr_b16 a[196:197], v13 offset:16384
    v_and_b32 v168, 0xffff0000, v145
    v_mfma_f32_16x16x32_bf16 v[120:123], a[208:211], a[152:155], v[120:123]
    ds_read_b64_tr_b16 a[198:199], v13 offset:20480
    v_fma_f32 v169, v168, v131, -v165
    v_mfma_f32_16x16x32_bf16 v[184:187], a[212:215], a[152:155], v[184:187]
    v_fma_f32 v215, v169, v159, v168
    v_lshlrev_b32 v168, 16, v146
    v_mfma_f32_16x16x32_bf16 v[188:191], a[212:215], a[156:159], v[188:191]
    v_fma_f32 v169, v168, v131, -v165
    v_fma_f32 v228, v169, v160, v168
    v_mfma_f32_16x16x32_bf16 v[124:127], a[208:211], a[156:159], v[124:127]
    s_waitcnt lgkmcnt(4)
    buffer_load_dwordx4 a[40:43], v2, s[16:19], s67 offen offset:2048 sc1
    v_mfma_f32_16x16x32_bf16 v[204:207], a[216:219], a[156:159], v[204:207]
    ds_read_b64_tr_b16 a[200:201], v14 offset:16384
    v_and_b32 v168, 0xffff0000, v146
    v_mfma_f32_16x16x32_bf16 v[252:255], a[220:223], a[156:159], v[252:255]
    ds_read_b64_tr_b16 a[202:203], v14 offset:20480
    v_fma_f32 v169, v168, v131, -v165
    v_mfma_f32_16x16x32_bf16 v[248:251], a[220:223], a[152:155], v[248:251]
    v_fma_f32 v229, v169, v161, v168
    v_lshlrev_b32 v168, 16, v147
    v_mfma_f32_16x16x32_bf16 v[200:203], a[216:219], a[152:155], v[200:203]
    ds_read_b64_tr_b16 a[204:205], v15 offset:16384
    v_fma_f32 v169, v168, v131, -v165
    v_mfma_f32_16x16x32_bf16 v[196:199], a[216:219], a[148:151], v[196:199]
    ds_read_b64_tr_b16 a[206:207], v15 offset:20480
    v_fma_f32 v230, v169, v162, v168
    v_mfma_f32_16x16x32_bf16 v[244:247], a[220:223], a[148:151], v[244:247]
    buffer_load_dwordx4 a[44:47], v2, s[16:19], s67 offen offset:3072 sc1
    v_mfma_f32_16x16x32_bf16 v[240:243], a[220:223], a[144:147], v[240:243]
    s_add_u32 s67, s67, 4096
    s_cmp_eq_u32 s67, s69
    s_cselect_b32 s67, s68, s67
    v_mfma_f32_16x16x32_bf16 v[192:195], a[216:219], a[144:147], v[192:195]
    s_waitcnt vmcnt(25) lgkmcnt(4)
    v_and_b32 v168, 0xffff0000, v147
    v_fma_f32 v169, v168, v131, -v165
    v_mfma_f32_16x16x32_bf16 v[48:51], a[192:195], a[160:163], v[48:51]
    ds_read_b64_tr_b16 a[208:209], v16 offset:16384
    v_fma_f32 v231, v169, v163, v168
    v_mfma_f32_16x16x32_bf16 v[64:67], a[196:199], a[160:163], v[64:67]
    ds_read_b64_tr_b16 a[210:211], v16 offset:20480
    v_lshlrev_b32 v168, 16, v148
    v_mfma_f32_16x16x32_bf16 v[68:71], a[196:199], a[164:167], v[68:71]
    buffer_load_dwordx4 a[48:51], v2, s[16:19], s67 offen offset:0 sc1
    v_mfma_f32_16x16x32_bf16 v[52:55], a[192:195], a[164:167], v[52:55]
    ds_read_b64_tr_b16 a[212:213], v17 offset:16384
    v_fma_f32 v169, v168, v133, -v166
    v_mfma_f32_16x16x32_bf16 v[56:59], a[192:195], a[168:171], v[56:59]
    ds_read_b64_tr_b16 a[214:215], v17 offset:20480
    v_fma_f32 v216, v169, v156, v168
    v_mfma_f32_16x16x32_bf16 v[72:75], a[196:199], a[168:171], v[72:75]
    v_and_b32 v168, 0xffff0000, v148
    v_fma_f32 v169, v168, v133, -v166
    v_mfma_f32_16x16x32_bf16 v[76:79], a[196:199], a[172:175], v[76:79]
    v_fma_f32 v217, v169, v157, v168
    v_lshlrev_b32 v168, 16, v149
    v_mfma_f32_16x16x32_bf16 v[60:63], a[192:195], a[172:175], v[60:63]
    s_waitcnt lgkmcnt(4)
    buffer_load_dwordx4 a[52:55], v2, s[16:19], s67 offen offset:1024 sc1
    v_mfma_f32_16x16x32_bf16 v[92:95], a[200:203], a[172:175], v[92:95]
    ds_read_b64_tr_b16 a[216:217], v18 offset:16384
    v_fma_f32 v169, v168, v133, -v166
    v_mfma_f32_16x16x32_bf16 v[108:111], a[204:207], a[172:175], v[108:111]
    ds_read_b64_tr_b16 a[218:219], v18 offset:20480
    v_fma_f32 v218, v169, v158, v168
    v_mfma_f32_16x16x32_bf16 v[104:107], a[204:207], a[168:171], v[104:107]
    v_and_b32 v168, 0xffff0000, v149
    v_fma_f32 v169, v168, v133, -v166
    v_mfma_f32_16x16x32_bf16 v[88:91], a[200:203], a[168:171], v[88:91]
    ds_read_b64_tr_b16 a[220:221], v19 offset:16384
    v_fma_f32 v219, v169, v159, v168
    v_mfma_f32_16x16x32_bf16 v[84:87], a[200:203], a[164:167], v[84:87]
    ds_read_b64_tr_b16 a[222:223], v19 offset:20480
    v_lshlrev_b32 v168, 16, v150
    v_mfma_f32_16x16x32_bf16 v[100:103], a[204:207], a[164:167], v[100:103]
    buffer_load_dwordx4 a[56:59], v2, s[16:19], s67 offen offset:2048 sc1
    v_mfma_f32_16x16x32_bf16 v[96:99], a[204:207], a[160:163], v[96:99]
    v_fma_f32 v169, v168, v133, -v166
    v_fma_f32 v232, v169, v160, v168
    v_mfma_f32_16x16x32_bf16 v[80:83], a[200:203], a[160:163], v[80:83]
    s_waitcnt lgkmcnt(4)
    v_and_b32 v168, 0xffff0000, v150
    v_fma_f32 v169, v168, v133, -v166
    v_mfma_f32_16x16x32_bf16 v[112:115], a[208:211], a[160:163], v[112:115]
    ds_read_b64_tr_b16 a[192:193], v12 offset:24576
    v_fma_f32 v233, v169, v161, v168
    v_mfma_f32_16x16x32_bf16 v[176:179], a[212:215], a[160:163], v[176:179]
    ds_read_b64_tr_b16 a[194:195], v12 offset:28672
    v_lshlrev_b32 v168, 16, v151
    v_mfma_f32_16x16x32_bf16 v[180:183], a[212:215], a[164:167], v[180:183]
    buffer_load_dwordx4 a[60:63], v2, s[16:19], s67 offen offset:3072 sc1
    v_mfma_f32_16x16x32_bf16 v[116:119], a[208:211], a[164:167], v[116:119]
    s_add_u32 s67, s67, 4096
    ds_read_b64_tr_b16 a[196:197], v13 offset:24576
    v_fma_f32 v169, v168, v133, -v166
    v_mfma_f32_16x16x32_bf16 v[120:123], a[208:211], a[168:171], v[120:123]
    s_cmp_eq_u32 s67, s69
    s_cselect_b32 s67, s68, s67
    ds_read_b64_tr_b16 a[198:199], v13 offset:28672
    v_mfma_f32_16x16x32_bf16 v[184:187], a[212:215], a[168:171], v[184:187]
    v_fma_f32 v234, v169, v162, v168
    v_and_b32 v168, 0xffff0000, v151
    v_mfma_f32_16x16x32_bf16 v[188:191], a[212:215], a[172:175], v[188:191]
    s_add_u32 m0, s60, 0
    v_fma_f32 v169, v168, v133, -v166
    v_fma_f32 v235, v169, v163, v168
    v_mfma_f32_16x16x32_bf16 v[124:127], a[208:211], a[172:175], v[124:127]
    s_waitcnt lgkmcnt(4)
    buffer_load_dwordx4 v3, s[24:27], s71 offen offset:0  lds
    v_mfma_f32_16x16x32_bf16 v[204:207], a[216:219], a[172:175], v[204:207]
    ds_read_b64_tr_b16 a[200:201], v14 offset:24576
    v_lshlrev_b32 v168, 16, v152
    v_mfma_f32_16x16x32_bf16 v[252:255], a[220:223], a[172:175], v[252:255]
    ds_read_b64_tr_b16 a[202:203], v14 offset:28672
    v_fma_f32 v169, v168, v135, -v167
    v_mfma_f32_16x16x32_bf16 v[248:251], a[220:223], a[168:171], v[248:251]
    v_fma_f32 v220, v169, v156, v168
    v_and_b32 v168, 0xffff0000, v152
    v_mfma_f32_16x16x32_bf16 v[200:203], a[216:219], a[168:171], v[200:203]
    ds_read_b64_tr_b16 a[204:205], v15 offset:24576
    v_fma_f32 v169, v168, v135, -v167
    v_mfma_f32_16x16x32_bf16 v[196:199], a[216:219], a[164:167], v[196:199]
    ds_read_b64_tr_b16 a[206:207], v15 offset:28672
    v_fma_f32 v221, v169, v157, v168
    v_mfma_f32_16x16x32_bf16 v[244:247], a[220:223], a[164:167], v[244:247]
    buffer_load_dwordx4 v4, s[24:27], s71 offen offset:1024  lds
    v_mfma_f32_16x16x32_bf16 v[240:243], a[220:223], a[160:163], v[240:243]
    v_lshlrev_b32 v168, 16, v153
    v_fma_f32 v169, v168, v135, -v167
    v_mfma_f32_16x16x32_bf16 v[192:195], a[216:219], a[160:163], v[192:195]
    s_waitcnt vmcnt(27) lgkmcnt(4)
    v_fma_f32 v222, v169, v158, v168
    v_and_b32 v168, 0xffff0000, v153
    v_mfma_f32_16x16x32_bf16 v[48:51], a[192:195], a[176:179], v[48:51]
    ds_read_b64_tr_b16 a[208:209], v16 offset:24576
    v_fma_f32 v169, v168, v135, -v167
    v_mfma_f32_16x16x32_bf16 v[64:67], a[196:199], a[176:179], v[64:67]
    ds_read_b64_tr_b16 a[210:211], v16 offset:28672
    v_fma_f32 v223, v169, v159, v168
    v_mfma_f32_16x16x32_bf16 v[68:71], a[196:199], a[180:183], v[68:71]
    buffer_load_dwordx4 v5, s[24:27], s71 offen offset:2048  lds
    v_mfma_f32_16x16x32_bf16 v[52:55], a[192:195], a[180:183], v[52:55]
    ds_read_b64_tr_b16 a[212:213], v17 offset:24576
    v_lshlrev_b32 v168, 16, v154
    v_mfma_f32_16x16x32_bf16 v[56:59], a[192:195], a[184:187], v[56:59]
    ds_read_b64_tr_b16 a[214:215], v17 offset:28672
    v_fma_f32 v169, v168, v135, -v167
    v_mfma_f32_16x16x32_bf16 v[72:75], a[196:199], a[184:187], v[72:75]
    v_fma_f32 v236, v169, v160, v168
    v_and_b32 v168, 0xffff0000, v154
    v_mfma_f32_16x16x32_bf16 v[76:79], a[196:199], a[188:191], v[76:79]
    v_fma_f32 v169, v168, v135, -v167
    v_fma_f32 v237, v169, v161, v168
    v_mfma_f32_16x16x32_bf16 v[60:63], a[192:195], a[188:191], v[60:63]
    s_waitcnt lgkmcnt(4)
    buffer_load_dwordx4 v6, s[24:27], s71 offen offset:3072  lds
    v_mfma_f32_16x16x32_bf16 v[92:95], a[200:203], a[188:191], v[92:95]
    ds_read_b64_tr_b16 a[216:217], v18 offset:24576
    v_lshlrev_b32 v168, 16, v155
    v_mfma_f32_16x16x32_bf16 v[108:111], a[204:207], a[188:191], v[108:111]
    ds_read_b64_tr_b16 a[218:219], v18 offset:28672
    v_fma_f32 v169, v168, v135, -v167
    v_mfma_f32_16x16x32_bf16 v[104:107], a[204:207], a[184:187], v[104:107]
    v_fma_f32 v238, v169, v162, v168
    v_and_b32 v168, 0xffff0000, v155
    v_mfma_f32_16x16x32_bf16 v[88:91], a[200:203], a[184:187], v[88:91]
    ds_read_b64_tr_b16 a[220:221], v19 offset:24576
    v_fma_f32 v169, v168, v135, -v167
    v_mfma_f32_16x16x32_bf16 v[84:87], a[200:203], a[180:183], v[84:87]
    s_add_u32 m0, s60, 4096
    ds_read_b64_tr_b16 a[222:223], v19 offset:28672
    v_fma_f32 v239, v169, v163, v168
    v_mfma_f32_16x16x32_bf16 v[100:103], a[204:207], a[180:183], v[100:103]
    buffer_load_dwordx4 v7, s[24:27], s71 offen offset:0  lds
    v_mfma_f32_16x16x32_bf16 v[96:99], a[204:207], a[176:179], v[96:99]
    v_lshlrev_b32 v44, 14, v41
    v_lshl_add_u32 v44, v40, 4, v44
    v_mfma_f32_16x16x32_bf16 v[80:83], a[200:203], a[176:179], v[80:83]
    s_waitcnt vmcnt(21) lgkmcnt(4)
    s_barrier
    v_mov_b32 v45, 0
    v_mfma_f32_16x16x32_bf16 v[112:115], a[208:211], a[176:179], v[112:115]
    s_lshl_b32 s56, s56, 7
    s_lshl_b32 s81, s49, 18
    ds_read_b64_tr_b16 a[192:193], v12 offset:32768
    v_mfma_f32_16x16x32_bf16 v[176:179], a[212:215], a[176:179], v[176:179]
    s_add_u32 s56, s56, s81
    s_lshl_b32 s57, s55, 11
    ds_read_b64_tr_b16 a[194:195], v12 offset:36864
    v_mfma_f32_16x16x32_bf16 v[180:183], a[212:215], a[180:183], v[180:183]
    s_lshl_b32 s81, s48, 7
    buffer_load_dwordx4 v8, s[24:27], s71 offen offset:1024  lds
    v_mfma_f32_16x16x32_bf16 v[116:119], a[208:211], a[180:183], v[116:119]
    s_add_u32 s57, s57, s81
    s_add_u32 s57, s57, 327680
    ds_read_b64_tr_b16 a[196:197], v13 offset:32768
    v_mfma_f32_16x16x32_bf16 v[120:123], a[208:211], a[184:187], v[120:123]
    s_mul_i32 s58, s55, 196608
    s_lshl_b32 s81, s48, 12
    ds_read_b64_tr_b16 a[198:199], v13 offset:36864
    v_mfma_f32_16x16x32_bf16 v[184:187], a[212:215], a[184:187], v[184:187]
    s_add_u32 s58, s58, s81
    v_mfma_f32_16x16x32_bf16 v[188:191], a[212:215], a[188:191], v[188:191]
    s_add_u32 s82, s53, 1
    s_and_b32 s82, s82, 3
    s_mul_i32 s81, s82, 49152
    v_mfma_f32_16x16x32_bf16 v[124:127], a[208:211], a[188:191], v[124:127]
    s_waitcnt lgkmcnt(4)
    buffer_load_dwordx4 v9, s[24:27], s71 offen offset:2048  lds
    v_mfma_f32_16x16x32_bf16 v[204:207], a[216:219], a[188:191], v[204:207]
    s_add_u32 s81, s81, 0
    s_add_u32 s81, s81, s58
    ds_read_b64_tr_b16 a[200:201], v14 offset:32768
    v_mfma_f32_16x16x32_bf16 v[252:255], a[220:223], a[188:191], v[252:255]
    s_lshl_b32 s82, s82, 9
    s_add_u32 s82, s82, s57
    ds_read_b64_tr_b16 a[202:203], v14 offset:36864
    v_mfma_f32_16x16x32_bf16 v[248:251], a[220:223], a[184:187], v[248:251]
    s_add_u32 s84, s53, 2
    s_and_b32 s84, s84, 3
    s_mul_i32 s83, s84, 49152
    v_mfma_f32_16x16x32_bf16 v[200:203], a[216:219], a[184:187], v[200:203]
    s_add_u32 s83, s83, 16384
    s_add_u32 s83, s83, s58
    ds_read_b64_tr_b16 a[204:205], v15 offset:32768
    v_mfma_f32_16x16x32_bf16 v[196:199], a[216:219], a[180:183], v[196:199]
    s_lshl_b32 s84, s84, 9
    s_add_u32 s84, s84, s57
    ds_read_b64_tr_b16 a[206:207], v15 offset:36864
    v_mfma_f32_16x16x32_bf16 v[244:247], a[220:223], a[180:183], v[244:247]
    s_add_u32 s86, s53, 3
    buffer_load_dwordx4 v10, s[24:27], s71 offen offset:3072  lds
    v_mfma_f32_16x16x32_bf16 v[240:243], a[220:223], a[176:179], v[240:243]
    s_add_u32 s3, s3, 4
    s_add_u32 s88, s3, 3
    s_and_b32 s86, s86, 3
    v_mfma_f32_16x16x32_bf16 v[192:195], a[216:219], a[176:179], v[192:195]
    s_cmp_ge_u32 s3, s72
    s_cselect_b32 s71, s88, s3
    s_waitcnt vmcnt(20) lgkmcnt(4)
    v_mfma_f32_16x16x32_bf16 v[48:51], a[192:195], a[0:3], v[48:51]
    s_add_u32 s88, s71, 3
    s_mul_i32 s88, s88, 43
    ds_read_b64_tr_b16 a[208:209], v16 offset:32768
    v_mfma_f32_16x16x32_bf16 v[64:67], a[196:199], a[0:3], v[64:67]
    s_lshr_b32 s88, s88, 8
    s_add_u32 s71, s71, s88
    ds_read_b64_tr_b16 a[210:211], v16 offset:36864
    v_mfma_f32_16x16x32_bf16 v[68:71], a[196:199], a[4:7], v[68:71]
    s_lshl_b32 s71, s71, 16
    s_add_u32 s71, s71, s89
    s_mul_i32 s85, s86, 49152
    v_mfma_f32_16x16x32_bf16 v[52:55], a[192:195], a[4:7], v[52:55]
    s_add_u32 s85, s85, 32768
    s_add_u32 s85, s85, s58
    ds_read_b64_tr_b16 a[212:213], v17 offset:32768
    v_mfma_f32_16x16x32_bf16 v[56:59], a[192:195], a[8:11], v[56:59]
    s_lshl_b32 s86, s86, 9
    s_add_u32 s86, s86, s57
    ds_read_b64_tr_b16 a[214:215], v17 offset:36864
    v_mfma_f32_16x16x32_bf16 v[72:75], a[196:199], a[8:11], v[72:75]
    s_lshl_b32 s59, s53, 9
    buffer_load_dwordx4 a[64:67], v2, s[16:19], s67 offen offset:0 sc1
    v_mfma_f32_16x16x32_bf16 v[76:79], a[196:199], a[12:15], v[76:79]
    s_add_u32 s57, s57, s59
    s_mul_i32 s59, s53, 49152
    s_add_u32 s58, s58, s59
    v_mfma_f32_16x16x32_bf16 v[60:63], a[192:195], a[12:15], v[60:63]
    s_add_u32 s59, s58, 16384
    s_add_u32 s63, s58, 32768
    s_waitcnt lgkmcnt(4)
    v_mfma_f32_16x16x32_bf16 v[92:95], a[200:203], a[12:15], v[92:95]
    ds_read_b64_tr_b16 a[216:217], v18 offset:32768
    v_mfma_f32_16x16x32_bf16 v[108:111], a[204:207], a[12:15], v[108:111]
    ds_read_b64_tr_b16 a[218:219], v18 offset:36864
    v_mfma_f32_16x16x32_bf16 v[104:107], a[204:207], a[8:11], v[104:107]
    buffer_load_dwordx4 a[68:71], v2, s[16:19], s67 offen offset:1024 sc1
    v_mfma_f32_16x16x32_bf16 v[88:91], a[200:203], a[8:11], v[88:91]
    ds_read_b64_tr_b16 a[220:221], v19 offset:32768
    v_mfma_f32_16x16x32_bf16 v[84:87], a[200:203], a[4:7], v[84:87]
    ds_read_b64_tr_b16 a[222:223], v19 offset:36864
    v_mfma_f32_16x16x32_bf16 v[100:103], a[204:207], a[4:7], v[100:103]
    v_mfma_f32_16x16x32_bf16 v[96:99], a[204:207], a[0:3], v[96:99]
    buffer_load_dwordx4 a[72:75], v2, s[16:19], s67 offen offset:2048 sc1
    v_mfma_f32_16x16x32_bf16 v[80:83], a[200:203], a[0:3], v[80:83]
    s_waitcnt lgkmcnt(4)
    v_mfma_f32_16x16x32_bf16 v[112:115], a[208:211], a[0:3], v[112:115]
    ds_read_b64_tr_b16 a[192:193], v12 offset:40960
    v_mfma_f32_16x16x32_bf16 v[176:179], a[212:215], a[0:3], v[176:179]
    ds_read_b64_tr_b16 a[194:195], v12 offset:45056
    v_mfma_f32_16x16x32_bf16 v[180:183], a[212:215], a[4:7], v[180:183]
    buffer_load_dwordx4 a[76:79], v2, s[16:19], s67 offen offset:3072 sc1
    v_mfma_f32_16x16x32_bf16 v[116:119], a[208:211], a[4:7], v[116:119]
    s_add_u32 s67, s67, 4096
    ds_read_b64_tr_b16 a[196:197], v13 offset:40960
    v_mfma_f32_16x16x32_bf16 v[120:123], a[208:211], a[8:11], v[120:123]
    s_cmp_eq_u32 s67, s69
    s_cselect_b32 s67, s68, s67
    ds_read_b64_tr_b16 a[198:199], v13 offset:45056
    v_mfma_f32_16x16x32_bf16 v[184:187], a[212:215], a[8:11], v[184:187]
    v_mfma_f32_16x16x32_bf16 v[188:191], a[212:215], a[12:15], v[188:191]
    buffer_load_dwordx4 a[80:83], v2, s[16:19], s67 offen offset:0 sc1
    v_mfma_f32_16x16x32_bf16 v[124:127], a[208:211], a[12:15], v[124:127]
    s_waitcnt lgkmcnt(4)
    v_mfma_f32_16x16x32_bf16 v[204:207], a[216:219], a[12:15], v[204:207]
    ds_read_b64_tr_b16 a[200:201], v14 offset:40960
    v_mfma_f32_16x16x32_bf16 v[252:255], a[220:223], a[12:15], v[252:255]
    ds_read_b64_tr_b16 a[202:203], v14 offset:45056
    v_mfma_f32_16x16x32_bf16 v[248:251], a[220:223], a[8:11], v[248:251]
    v_mfma_f32_16x16x32_bf16 v[200:203], a[216:219], a[8:11], v[200:203]
    ds_read_b64_tr_b16 a[204:205], v15 offset:40960
    v_mfma_f32_16x16x32_bf16 v[196:199], a[216:219], a[4:7], v[196:199]
    ds_read_b64_tr_b16 a[206:207], v15 offset:45056
    v_mfma_f32_16x16x32_bf16 v[244:247], a[220:223], a[4:7], v[244:247]
    buffer_load_dwordx4 a[84:87], v2, s[16:19], s67 offen offset:1024 sc1
    v_mfma_f32_16x16x32_bf16 v[240:243], a[220:223], a[0:3], v[240:243]
    v_mfma_f32_16x16x32_bf16 v[192:195], a[216:219], a[0:3], v[192:195]
    s_waitcnt vmcnt(22) lgkmcnt(4)
    v_mfma_f32_16x16x32_bf16 v[48:51], a[192:195], a[16:19], v[48:51]
    ds_read_b64_tr_b16 a[208:209], v16 offset:40960
    v_mfma_f32_16x16x32_bf16 v[64:67], a[196:199], a[16:19], v[64:67]
    ds_read_b64_tr_b16 a[210:211], v16 offset:45056
    v_mfma_f32_16x16x32_bf16 v[68:71], a[196:199], a[20:23], v[68:71]
    buffer_load_dwordx4 a[88:91], v2, s[16:19], s67 offen offset:2048 sc1
    v_mfma_f32_16x16x32_bf16 v[52:55], a[192:195], a[20:23], v[52:55]
    ds_read_b64_tr_b16 a[212:213], v17 offset:40960
    v_mfma_f32_16x16x32_bf16 v[56:59], a[192:195], a[24:27], v[56:59]
    ds_read_b64_tr_b16 a[214:215], v17 offset:45056
    v_mfma_f32_16x16x32_bf16 v[72:75], a[196:199], a[24:27], v[72:75]
    v_mfma_f32_16x16x32_bf16 v[76:79], a[196:199], a[28:31], v[76:79]
    v_mfma_f32_16x16x32_bf16 v[60:63], a[192:195], a[28:31], v[60:63]
    s_waitcnt lgkmcnt(4)
    buffer_load_dwordx4 a[92:95], v2, s[16:19], s67 offen offset:3072 sc1
    v_mfma_f32_16x16x32_bf16 v[92:95], a[200:203], a[28:31], v[92:95]
    s_add_u32 s67, s67, 4096
    ds_read_b64_tr_b16 a[216:217], v18 offset:40960
    v_mfma_f32_16x16x32_bf16 v[108:111], a[204:207], a[28:31], v[108:111]
    s_cmp_eq_u32 s67, s69
    s_cselect_b32 s67, s68, s67
    ds_read_b64_tr_b16 a[218:219], v18 offset:45056
    v_mfma_f32_16x16x32_bf16 v[104:107], a[204:207], a[24:27], v[104:107]
    v_mfma_f32_16x16x32_bf16 v[88:91], a[200:203], a[24:27], v[88:91]
    ds_read_b64_tr_b16 a[220:221], v19 offset:40960
    v_mfma_f32_16x16x32_bf16 v[84:87], a[200:203], a[20:23], v[84:87]
    ds_read_b64_tr_b16 a[222:223], v19 offset:45056
    v_mfma_f32_16x16x32_bf16 v[100:103], a[204:207], a[20:23], v[100:103]
    buffer_load_dwordx4 a[96:99], v2, s[16:19], s67 offen offset:0 sc1
    v_mfma_f32_16x16x32_bf16 v[96:99], a[204:207], a[16:19], v[96:99]
    v_mfma_f32_16x16x32_bf16 v[80:83], a[200:203], a[16:19], v[80:83]
    s_waitcnt lgkmcnt(4)
    v_mfma_f32_16x16x32_bf16 v[112:115], a[208:211], a[16:19], v[112:115]
    ds_read_b64_tr_b16 a[192:193], v12 offset:49152
    v_mfma_f32_16x16x32_bf16 v[176:179], a[212:215], a[16:19], v[176:179]
    ds_read_b64_tr_b16 a[194:195], v12 offset:53248
    v_mfma_f32_16x16x32_bf16 v[180:183], a[212:215], a[20:23], v[180:183]
LF_pad10:
    s_cbranch_execz LF_walked
    buffer_load_dwordx4 a[100:103], v2, s[16:19], s67 offen offset:1024 sc1
    v_mfma_f32_16x16x32_bf16 v[116:119], a[208:211], a[20:23], v[116:119]
    ds_read_b64_tr_b16 a[196:197], v13 offset:49152
    v_mfma_f32_16x16x32_bf16 v[120:123], a[208:211], a[24:27], v[120:123]
    ds_read_b64_tr_b16 a[198:199], v13 offset:53248
    v_mfma_f32_16x16x32_bf16 v[184:187], a[212:215], a[24:27], v[184:187]
    v_mfma_f32_16x16x32_bf16 v[188:191], a[212:215], a[28:31], v[188:191]
    v_mfma_f32_16x16x32_bf16 v[124:127], a[208:211], a[28:31], v[124:127]
    s_waitcnt lgkmcnt(4)
    buffer_load_dwordx4 a[104:107], v2, s[16:19], s67 offen offset:2048 sc1
    v_mfma_f32_16x16x32_bf16 v[204:207], a[216:219], a[28:31], v[204:207]
    ds_read_b64_tr_b16 a[200:201], v14 offset:49152
    v_mfma_f32_16x16x32_bf16 v[252:255], a[220:223], a[28:31], v[252:255]
    ds_read_b64_tr_b16 a[202:203], v14 offset:53248
    v_mfma_f32_16x16x32_bf16 v[248:251], a[220:223], a[24:27], v[248:251]
    v_mfma_f32_16x16x32_bf16 v[200:203], a[216:219], a[24:27], v[200:203]
    ds_read_b64_tr_b16 a[204:205], v15 offset:49152
    v_mfma_f32_16x16x32_bf16 v[196:199], a[216:219], a[20:23], v[196:199]
    ds_read_b64_tr_b16 a[206:207], v15 offset:53248
    v_mfma_f32_16x16x32_bf16 v[244:247], a[220:223], a[20:23], v[244:247]
    buffer_load_dwordx4 a[108:111], v2, s[16:19], s67 offen offset:3072 sc1
    v_mfma_f32_16x16x32_bf16 v[240:243], a[220:223], a[16:19], v[240:243]
    s_add_u32 s67, s67, 4096
    s_cmp_eq_u32 s67, s69
    s_cselect_b32 s67, s68, s67
    v_mfma_f32_16x16x32_bf16 v[192:195], a[216:219], a[16:19], v[192:195]
    s_waitcnt vmcnt(24) lgkmcnt(4)
    v_mfma_f32_16x16x32_bf16 v[48:51], a[192:195], a[32:35], v[48:51]
    ds_read_b64_tr_b16 a[208:209], v16 offset:49152
    v_mfma_f32_16x16x32_bf16 v[64:67], a[196:199], a[32:35], v[64:67]
    ds_read_b64_tr_b16 a[210:211], v16 offset:53248
    v_mfma_f32_16x16x32_bf16 v[68:71], a[196:199], a[36:39], v[68:71]
    buffer_load_dwordx4 a[112:115], v2, s[16:19], s67 offen offset:0 sc1
    v_mfma_f32_16x16x32_bf16 v[52:55], a[192:195], a[36:39], v[52:55]
    ds_read_b64_tr_b16 a[212:213], v17 offset:49152
    v_mfma_f32_16x16x32_bf16 v[56:59], a[192:195], a[40:43], v[56:59]
    ds_read_b64_tr_b16 a[214:215], v17 offset:53248
    v_mfma_f32_16x16x32_bf16 v[72:75], a[196:199], a[40:43], v[72:75]
    v_mfma_f32_16x16x32_bf16 v[76:79], a[196:199], a[44:47], v[76:79]
    v_mfma_f32_16x16x32_bf16 v[60:63], a[192:195], a[44:47], v[60:63]
    s_waitcnt lgkmcnt(4)
    buffer_load_dwordx4 a[116:119], v2, s[16:19], s67 offen offset:1024 sc1
    v_mfma_f32_16x16x32_bf16 v[92:95], a[200:203], a[44:47], v[92:95]
    ds_read_b64_tr_b16 a[216:217], v18 offset:49152
    v_mfma_f32_16x16x32_bf16 v[108:111], a[204:207], a[44:47], v[108:111]
    ds_read_b64_tr_b16 a[218:219], v18 offset:53248
    v_mfma_f32_16x16x32_bf16 v[104:107], a[204:207], a[40:43], v[104:107]
    v_mfma_f32_16x16x32_bf16 v[88:91], a[200:203], a[40:43], v[88:91]
    ds_read_b64_tr_b16 a[220:221], v19 offset:49152
    v_mfma_f32_16x16x32_bf16 v[84:87], a[200:203], a[36:39], v[84:87]
    ds_read_b64_tr_b16 a[222:223], v19 offset:53248
    v_mfma_f32_16x16x32_bf16 v[100:103], a[204:207], a[36:39], v[100:103]
    buffer_load_dwordx4 a[120:123], v2, s[16:19], s67 offen offset:2048 sc1
    v_mfma_f32_16x16x32_bf16 v[96:99], a[204:207], a[32:35], v[96:99]
    v_mfma_f32_16x16x32_bf16 v[80:83], a[200:203], a[32:35], v[80:83]
    s_waitcnt lgkmcnt(4)
    v_mfma_f32_16x16x32_bf16 v[112:115], a[208:211], a[32:35], v[112:115]
    ds_read_b64_tr_b16 a[192:193], v12 offset:57344
    v_mfma_f32_16x16x32_bf16 v[176:179], a[212:215], a[32:35], v[176:179]
    ds_read_b64_tr_b16 a[194:195], v12 offset:61440
    v_xor_b32 v12, 0x10000, v12
    v_mfma_f32_16x16x32_bf16 v[180:183], a[212:215], a[36:39], v[180:183]
    buffer_load_dwordx4 a[124:127], v2, s[16:19], s67 offen offset:3072 sc1
    v_mfma_f32_16x16x32_bf16 v[116:119], a[208:211], a[36:39], v[116:119]
    s_add_u32 s67, s67, 4096
    ds_read_b64_tr_b16 a[196:197], v13 offset:57344
    v_mfma_f32_16x16x32_bf16 v[120:123], a[208:211], a[40:43], v[120:123]
    ds_read_b64_tr_b16 a[198:199], v13 offset:61440
    v_xor_b32 v13, 0x10000, v13
    v_mfma_f32_16x16x32_bf16 v[184:187], a[212:215], a[40:43], v[184:187]
    s_cmp_eq_u32 s67, s69
    s_cselect_b32 s67, s68, s67
    v_mfma_f32_16x16x32_bf16 v[188:191], a[212:215], a[44:47], v[188:191]
    s_add_u32 m0, s60, 32768
    v_mfma_f32_16x16x32_bf16 v[124:127], a[208:211], a[44:47], v[124:127]
    s_waitcnt lgkmcnt(4)
    buffer_load_dwordx4 v3, s[24:27], s71 offen offset:0  lds
    v_mfma_f32_16x16x32_bf16 v[204:207], a[216:219], a[44:47], v[204:207]
    ds_read_b64_tr_b16 a[200:201], v14 offset:57344
    v_mfma_f32_16x16x32_bf16 v[252:255], a[220:223], a[44:47], v[252:255]
    ds_read_b64_tr_b16 a[202:203], v14 offset:61440
    v_xor_b32 v14, 0x10000, v14
    v_mfma_f32_16x16x32_bf16 v[248:251], a[220:223], a[40:43], v[248:251]
    v_mfma_f32_16x16x32_bf16 v[200:203], a[216:219], a[40:43], v[200:203]
    ds_read_b64_tr_b16 a[204:205], v15 offset:57344
    v_mfma_f32_16x16x32_bf16 v[196:199], a[216:219], a[36:39], v[196:199]
    ds_read_b64_tr_b16 a[206:207], v15 offset:61440
    v_xor_b32 v15, 0x10000, v15
    v_mfma_f32_16x16x32_bf16 v[244:247], a[220:223], a[36:39], v[244:247]
    buffer_load_dwordx4 v4, s[24:27], s71 offen offset:1024  lds
    v_mfma_f32_16x16x32_bf16 v[240:243], a[220:223], a[32:35], v[240:243]
    v_mfma_f32_16x16x32_bf16 v[192:195], a[216:219], a[32:35], v[192:195]
    s_waitcnt vmcnt(26) lgkmcnt(4)
    v_mfma_f32_16x16x32_bf16 v[48:51], a[192:195], a[48:51], v[48:51]
    ds_read_b64_tr_b16 a[208:209], v16 offset:57344
    v_mfma_f32_16x16x32_bf16 v[64:67], a[196:199], a[48:51], v[64:67]
    ds_read_b64_tr_b16 a[210:211], v16 offset:61440
    v_xor_b32 v16, 0x10000, v16
    v_mfma_f32_16x16x32_bf16 v[68:71], a[196:199], a[52:55], v[68:71]
    buffer_load_dwordx4 v5, s[24:27], s71 offen offset:2048  lds
    v_mfma_f32_16x16x32_bf16 v[52:55], a[192:195], a[52:55], v[52:55]
    ds_read_b64_tr_b16 a[212:213], v17 offset:57344
    v_mfma_f32_16x16x32_bf16 v[56:59], a[192:195], a[56:59], v[56:59]
    ds_read_b64_tr_b16 a[214:215], v17 offset:61440
    v_xor_b32 v17, 0x10000, v17
    v_mfma_f32_16x16x32_bf16 v[72:75], a[196:199], a[56:59], v[72:75]
    v_mfma_f32_16x16x32_bf16 v[76:79], a[196:199], a[60:63], v[76:79]
    v_mfma_f32_16x16x32_bf16 v[60:63], a[192:195], a[60:63], v[60:63]
    s_waitcnt lgkmcnt(4)
    buffer_load_dwordx4 v6, s[24:27], s71 offen offset:3072  lds
    v_mfma_f32_16x16x32_bf16 v[92:95], a[200:203], a[60:63], v[92:95]
    ds_read_b64_tr_b16 a[216:217], v18 offset:57344
    v_mfma_f32_16x16x32_bf16 v[108:111], a[204:207], a[60:63], v[108:111]
    ds_read_b64_tr_b16 a[218:219], v18 offset:61440
    v_xor_b32 v18, 0x10000, v18
    v_mfma_f32_16x16x32_bf16 v[104:107], a[204:207], a[56:59], v[104:107]
    v_mfma_f32_16x16x32_bf16 v[88:91], a[200:203], a[56:59], v[88:91]
    ds_read_b64_tr_b16 a[220:221], v19 offset:57344
    v_mfma_f32_16x16x32_bf16 v[84:87], a[200:203], a[52:55], v[84:87]
    s_add_u32 m0, s60, 36864
    ds_read_b64_tr_b16 a[222:223], v19 offset:61440
    v_xor_b32 v19, 0x10000, v19
    v_mfma_f32_16x16x32_bf16 v[100:103], a[204:207], a[52:55], v[100:103]
    buffer_load_dwordx4 v7, s[24:27], s71 offen offset:0  lds
    v_mfma_f32_16x16x32_bf16 v[96:99], a[204:207], a[48:51], v[96:99]
    v_mfma_f32_16x16x32_bf16 v[80:83], a[200:203], a[48:51], v[80:83]
    s_waitcnt vmcnt(21) lgkmcnt(4)
    s_barrier
    v_mfma_f32_16x16x32_bf16 v[112:115], a[208:211], a[48:51], v[112:115]
    ds_read_b64_tr_b16 a[192:193], v12 offset:0
    v_mfma_f32_16x16x32_bf16 v[176:179], a[212:215], a[48:51], v[176:179]
    ds_read_b64_tr_b16 a[194:195], v12 offset:4096
    v_mfma_f32_16x16x32_bf16 v[180:183], a[212:215], a[52:55], v[180:183]
    buffer_load_dwordx4 v8, s[24:27], s71 offen offset:1024  lds
    v_mfma_f32_16x16x32_bf16 v[116:119], a[208:211], a[52:55], v[116:119]
    ds_read_b64_tr_b16 a[196:197], v13 offset:0
    v_mfma_f32_16x16x32_bf16 v[120:123], a[208:211], a[56:59], v[120:123]
    ds_read_b64_tr_b16 a[198:199], v13 offset:4096
    v_mfma_f32_16x16x32_bf16 v[184:187], a[212:215], a[56:59], v[184:187]
    v_mfma_f32_16x16x32_bf16 v[188:191], a[212:215], a[60:63], v[188:191]
    v_mfma_f32_16x16x32_bf16 v[124:127], a[208:211], a[60:63], v[124:127]
    s_waitcnt lgkmcnt(4)
    buffer_load_dwordx4 v9, s[24:27], s71 offen offset:2048  lds
    v_mfma_f32_16x16x32_bf16 v[204:207], a[216:219], a[60:63], v[204:207]
    ds_read_b64_tr_b16 a[200:201], v14 offset:0
    v_mfma_f32_16x16x32_bf16 v[252:255], a[220:223], a[60:63], v[252:255]
    ds_read_b64_tr_b16 a[202:203], v14 offset:4096
    v_mfma_f32_16x16x32_bf16 v[248:251], a[220:223], a[56:59], v[248:251]
    v_mfma_f32_16x16x32_bf16 v[200:203], a[216:219], a[56:59], v[200:203]
    ds_read_b64_tr_b16 a[204:205], v15 offset:0
    v_mfma_f32_16x16x32_bf16 v[196:199], a[216:219], a[52:55], v[196:199]
    ds_read_b64_tr_b16 a[206:207], v15 offset:4096
    v_mfma_f32_16x16x32_bf16 v[244:247], a[220:223], a[52:55], v[244:247]
    buffer_load_dwordx4 v10, s[24:27], s71 offen offset:3072  lds
    v_mfma_f32_16x16x32_bf16 v[240:243], a[220:223], a[48:51], v[240:243]
    s_mul_i32 s71, s48, 458752
    s_add_u32 s71, s71, 196608
    s_add_u32 s71, s71, s89
    v_mfma_f32_16x16x32_bf16 v[192:195], a[216:219], a[48:51], v[192:195]
    s_waitcnt vmcnt(20) lgkmcnt(4)
    v_mfma_f32_16x16x32_bf16 v[48:51], a[192:195], a[64:67], v[48:51]
    ds_read_b64_tr_b16 a[208:209], v16 offset:0
    v_mfma_f32_16x16x32_bf16 v[64:67], a[196:199], a[64:67], v[64:67]
    ds_read_b64_tr_b16 a[210:211], v16 offset:4096
    v_mfma_f32_16x16x32_bf16 v[68:71], a[196:199], a[68:71], v[68:71]
    buffer_load_dwordx4 a[128:131], v2, s[16:19], s67 offen offset:0 sc1
    v_mfma_f32_16x16x32_bf16 v[52:55], a[192:195], a[68:71], v[52:55]
    ds_read_b64_tr_b16 a[212:213], v17 offset:0
    v_mfma_f32_16x16x32_bf16 v[56:59], a[192:195], a[72:75], v[56:59]
    ds_read_b64_tr_b16 a[214:215], v17 offset:4096
    v_mfma_f32_16x16x32_bf16 v[72:75], a[196:199], a[72:75], v[72:75]
    v_mfma_f32_16x16x32_bf16 v[76:79], a[196:199], a[76:79], v[76:79]
    buffer_load_dwordx4 a[132:135], v2, s[16:19], s67 offen offset:1024 sc1
    v_mfma_f32_16x16x32_bf16 v[60:63], a[192:195], a[76:79], v[60:63]
    s_waitcnt lgkmcnt(4)
    v_mfma_f32_16x16x32_bf16 v[92:95], a[200:203], a[76:79], v[92:95]
    ds_read_b64_tr_b16 a[216:217], v18 offset:0
    v_mfma_f32_16x16x32_bf16 v[108:111], a[204:207], a[76:79], v[108:111]
    ds_read_b64_tr_b16 a[218:219], v18 offset:4096
    v_mfma_f32_16x16x32_bf16 v[104:107], a[204:207], a[72:75], v[104:107]
    buffer_load_dwordx4 a[136:139], v2, s[16:19], s67 offen offset:2048 sc1
    v_mfma_f32_16x16x32_bf16 v[88:91], a[200:203], a[72:75], v[88:91]
    ds_read_b64_tr_b16 a[220:221], v19 offset:0
    v_mfma_f32_16x16x32_bf16 v[84:87], a[200:203], a[68:71], v[84:87]
    ds_read_b64_tr_b16 a[222:223], v19 offset:4096
    v_mfma_f32_16x16x32_bf16 v[100:103], a[204:207], a[68:71], v[100:103]
    v_mfma_f32_16x16x32_bf16 v[96:99], a[204:207], a[64:67], v[96:99]
    buffer_load_dwordx4 a[140:143], v2, s[16:19], s67 offen offset:3072 sc1
    v_mfma_f32_16x16x32_bf16 v[80:83], a[200:203], a[64:67], v[80:83]
    s_add_u32 s67, s67, 4096
    s_waitcnt lgkmcnt(4)
    v_mfma_f32_16x16x32_bf16 v[112:115], a[208:211], a[64:67], v[112:115]
    s_cmp_eq_u32 s67, s69
    s_cselect_b32 s67, s68, s67
    ds_read_b64_tr_b16 a[192:193], v12 offset:8192
    v_mfma_f32_16x16x32_bf16 v[176:179], a[212:215], a[64:67], v[176:179]
    ds_read_b64_tr_b16 a[194:195], v12 offset:12288
    v_mfma_f32_16x16x32_bf16 v[180:183], a[212:215], a[68:71], v[180:183]
    buffer_load_dword v38, v39, s[36:39], s61 offen offset:32 sc1
    v_mfma_f32_16x16x32_bf16 v[116:119], a[208:211], a[68:71], v[116:119]
    ds_read_b64_tr_b16 a[196:197], v13 offset:8192
    v_mfma_f32_16x16x32_bf16 v[120:123], a[208:211], a[72:75], v[120:123]
    ds_read_b64_tr_b16 a[198:199], v13 offset:12288
    v_mfma_f32_16x16x32_bf16 v[184:187], a[212:215], a[72:75], v[184:187]
    buffer_load_dwordx4 a[144:147], v2, s[16:19], s67 offen offset:0 sc1
    v_mfma_f32_16x16x32_bf16 v[188:191], a[212:215], a[76:79], v[188:191]
    v_mfma_f32_16x16x32_bf16 v[124:127], a[208:211], a[76:79], v[124:127]
    s_waitcnt lgkmcnt(4)
    v_mfma_f32_16x16x32_bf16 v[204:207], a[216:219], a[76:79], v[204:207]
    ds_read_b64_tr_b16 a[200:201], v14 offset:8192
    v_mfma_f32_16x16x32_bf16 v[252:255], a[220:223], a[76:79], v[252:255]
    ds_read_b64_tr_b16 a[202:203], v14 offset:12288
    v_mfma_f32_16x16x32_bf16 v[248:251], a[220:223], a[72:75], v[248:251]
    buffer_load_dwordx4 a[148:151], v2, s[16:19], s67 offen offset:1024 sc1
    v_mfma_f32_16x16x32_bf16 v[200:203], a[216:219], a[72:75], v[200:203]
    ds_read_b64_tr_b16 a[204:205], v15 offset:8192
    v_mfma_f32_16x16x32_bf16 v[196:199], a[216:219], a[68:71], v[196:199]
    ds_read_b64_tr_b16 a[206:207], v15 offset:12288
    v_mfma_f32_16x16x32_bf16 v[244:247], a[220:223], a[68:71], v[244:247]
    v_mfma_f32_16x16x32_bf16 v[240:243], a[220:223], a[64:67], v[240:243]
    v_mfma_f32_16x16x32_bf16 v[192:195], a[216:219], a[64:67], v[192:195]
    s_waitcnt vmcnt(23) lgkmcnt(4)
    buffer_load_dwordx4 a[152:155], v2, s[16:19], s67 offen offset:2048 sc1
    v_mfma_f32_16x16x32_bf16 v[48:51], a[192:195], a[80:83], v[48:51]
    ds_read_b64_tr_b16 a[208:209], v16 offset:8192
    v_mfma_f32_16x16x32_bf16 v[64:67], a[196:199], a[80:83], v[64:67]
    ds_read_b64_tr_b16 a[210:211], v16 offset:12288
    v_mfma_f32_16x16x32_bf16 v[68:71], a[196:199], a[84:87], v[68:71]
    v_mfma_f32_16x16x32_bf16 v[52:55], a[192:195], a[84:87], v[52:55]
    ds_read_b64_tr_b16 a[212:213], v17 offset:8192
    v_mfma_f32_16x16x32_bf16 v[56:59], a[192:195], a[88:91], v[56:59]
    ds_read_b64_tr_b16 a[214:215], v17 offset:12288
    v_mfma_f32_16x16x32_bf16 v[72:75], a[196:199], a[88:91], v[72:75]
    buffer_load_dwordx4 a[156:159], v2, s[16:19], s67 offen offset:3072 sc1
    v_mfma_f32_16x16x32_bf16 v[76:79], a[196:199], a[92:95], v[76:79]
    s_add_u32 s67, s67, 4096
    s_cmp_eq_u32 s67, s69
    s_cselect_b32 s67, s68, s67
    v_mfma_f32_16x16x32_bf16 v[60:63], a[192:195], a[92:95], v[60:63]
    s_waitcnt lgkmcnt(4)
    v_mfma_f32_16x16x32_bf16 v[92:95], a[200:203], a[92:95], v[92:95]
    ds_read_b64_tr_b16 a[216:217], v18 offset:8192
    v_mfma_f32_16x16x32_bf16 v[108:111], a[204:207], a[92:95], v[108:111]
    ds_read_b64_tr_b16 a[218:219], v18 offset:12288
    v_mfma_f32_16x16x32_bf16 v[104:107], a[204:207], a[88:91], v[104:107]
    buffer_load_dwordx4 a[160:163], v2, s[16:19], s67 offen offset:0 sc1
    v_mfma_f32_16x16x32_bf16 v[88:91], a[200:203], a[88:91], v[88:91]
    ds_read_b64_tr_b16 a[220:221], v19 offset:8192
    v_mfma_f32_16x16x32_bf16 v[84:87], a[200:203], a[84:87], v[84:87]
    ds_read_b64_tr_b16 a[222:223], v19 offset:12288
    v_mfma_f32_16x16x32_bf16 v[100:103], a[204:207], a[84:87], v[100:103]
    v_mfma_f32_16x16x32_bf16 v[96:99], a[204:207], a[80:83], v[96:99]
    v_mfma_f32_16x16x32_bf16 v[80:83], a[200:203], a[80:83], v[80:83]
    s_waitcnt lgkmcnt(4)
    buffer_load_dwordx4 a[164:167], v2, s[16:19], s67 offen offset:1024 sc1
    v_mfma_f32_16x16x32_bf16 v[112:115], a[208:211], a[80:83], v[112:115]
    ds_read_b64_tr_b16 a[192:193], v12 offset:16384
    v_mfma_f32_16x16x32_bf16 v[176:179], a[212:215], a[80:83], v[176:179]
    ds_read_b64_tr_b16 a[194:195], v12 offset:20480
    v_mfma_f32_16x16x32_bf16 v[180:183], a[212:215], a[84:87], v[180:183]
    v_mfma_f32_16x16x32_bf16 v[116:119], a[208:211], a[84:87], v[116:119]
    ds_read_b64_tr_b16 a[196:197], v13 offset:16384
    v_mfma_f32_16x16x32_bf16 v[120:123], a[208:211], a[88:91], v[120:123]
    ds_read_b64_tr_b16 a[198:199], v13 offset:20480
    v_mfma_f32_16x16x32_bf16 v[184:187], a[212:215], a[88:91], v[184:187]
    buffer_load_dwordx4 a[168:171], v2, s[16:19], s67 offen offset:2048 sc1
    v_mfma_f32_16x16x32_bf16 v[188:191], a[212:215], a[92:95], v[188:191]
    v_mfma_f32_16x16x32_bf16 v[124:127], a[208:211], a[92:95], v[124:127]
    s_waitcnt lgkmcnt(4)
    v_mfma_f32_16x16x32_bf16 v[204:207], a[216:219], a[92:95], v[204:207]
    ds_read_b64_tr_b16 a[200:201], v14 offset:16384
    v_mfma_f32_16x16x32_bf16 v[252:255], a[220:223], a[92:95], v[252:255]
    ds_read_b64_tr_b16 a[202:203], v14 offset:20480
    v_mfma_f32_16x16x32_bf16 v[248:251], a[220:223], a[88:91], v[248:251]
    buffer_load_dwordx4 a[172:175], v2, s[16:19], s67 offen offset:3072 sc1
    v_mfma_f32_16x16x32_bf16 v[200:203], a[216:219], a[88:91], v[200:203]
    s_add_u32 s67, s67, 4096
    ds_read_b64_tr_b16 a[204:205], v15 offset:16384
    v_mfma_f32_16x16x32_bf16 v[196:199], a[216:219], a[84:87], v[196:199]
    s_cmp_eq_u32 s67, s69
    s_cselect_b32 s67, s68, s67
    ds_read_b64_tr_b16 a[206:207], v15 offset:20480
    v_mfma_f32_16x16x32_bf16 v[244:247], a[220:223], a[84:87], v[244:247]
    v_mfma_f32_16x16x32_bf16 v[240:243], a[220:223], a[80:83], v[240:243]
    v_mfma_f32_16x16x32_bf16 v[192:195], a[216:219], a[80:83], v[192:195]
    s_waitcnt vmcnt(25) lgkmcnt(4)
    buffer_load_dwordx4 a[176:179], v2, s[16:19], s67 offen offset:0 sc1
    v_mfma_f32_16x16x32_bf16 v[48:51], a[192:195], a[96:99], v[48:51]
    ds_read_b64_tr_b16 a[208:209], v16 offset:16384
    v_mfma_f32_16x16x32_bf16 v[64:67], a[196:199], a[96:99], v[64:67]
    ds_read_b64_tr_b16 a[210:211], v16 offset:20480
    v_mfma_f32_16x16x32_bf16 v[68:71], a[196:199], a[100:103], v[68:71]
    v_mfma_f32_16x16x32_bf16 v[52:55], a[192:195], a[100:103], v[52:55]
    ds_read_b64_tr_b16 a[212:213], v17 offset:16384
    v_mfma_f32_16x16x32_bf16 v[56:59], a[192:195], a[104:107], v[56:59]
    ds_read_b64_tr_b16 a[214:215], v17 offset:20480
    v_mfma_f32_16x16x32_bf16 v[72:75], a[196:199], a[104:107], v[72:75]
    buffer_load_dwordx4 a[180:183], v2, s[16:19], s67 offen offset:1024 sc1
    v_mfma_f32_16x16x32_bf16 v[76:79], a[196:199], a[108:111], v[76:79]
    v_mfma_f32_16x16x32_bf16 v[60:63], a[192:195], a[108:111], v[60:63]
    s_waitcnt lgkmcnt(4)
    v_mfma_f32_16x16x32_bf16 v[92:95], a[200:203], a[108:111], v[92:95]
    ds_read_b64_tr_b16 a[216:217], v18 offset:16384
    v_mfma_f32_16x16x32_bf16 v[108:111], a[204:207], a[108:111], v[108:111]
    ds_read_b64_tr_b16 a[218:219], v18 offset:20480
    v_mfma_f32_16x16x32_bf16 v[104:107], a[204:207], a[104:107], v[104:107]
    buffer_load_dwordx4 a[184:187], v2, s[16:19], s67 offen offset:2048 sc1
    v_mfma_f32_16x16x32_bf16 v[88:91], a[200:203], a[104:107], v[88:91]
    ds_read_b64_tr_b16 a[220:221], v19 offset:16384
    v_mfma_f32_16x16x32_bf16 v[84:87], a[200:203], a[100:103], v[84:87]
    ds_read_b64_tr_b16 a[222:223], v19 offset:20480
    v_mfma_f32_16x16x32_bf16 v[100:103], a[204:207], a[100:103], v[100:103]
    v_mfma_f32_16x16x32_bf16 v[96:99], a[204:207], a[96:99], v[96:99]
    v_mfma_f32_16x16x32_bf16 v[80:83], a[200:203], a[96:99], v[80:83]
    s_waitcnt lgkmcnt(4)
    buffer_load_dwordx4 a[188:191], v2, s[16:19], s67 offen offset:3072 sc1
    v_mfma_f32_16x16x32_bf16 v[112:115], a[208:211], a[96:99], v[112:115]
    s_add_u32 s67, s67, 4096
    ds_read_b64_tr_b16 a[192:193], v12 offset:24576
    v_mfma_f32_16x16x32_bf16 v[176:179], a[212:215], a[96:99], v[176:179]
    s_cmp_eq_u32 s67, s69
    s_cselect_b32 s67, s68, s67
    ds_read_b64_tr_b16 a[194:195], v12 offset:28672
    v_mfma_f32_16x16x32_bf16 v[180:183], a[212:215], a[100:103], v[180:183]
    v_mfma_f32_16x16x32_bf16 v[116:119], a[208:211], a[100:103], v[116:119]
    ds_read_b64_tr_b16 a[196:197], v13 offset:24576
    v_mfma_f32_16x16x32_bf16 v[120:123], a[208:211], a[104:107], v[120:123]
    s_add_u32 m0, s60, 65536
    ds_read_b64_tr_b16 a[198:199], v13 offset:28672
    v_mfma_f32_16x16x32_bf16 v[184:187], a[212:215], a[104:107], v[184:187]
    buffer_load_dwordx4 v3, s[24:27], s71 offen offset:0  lds
    v_mfma_f32_16x16x32_bf16 v[188:191], a[212:215], a[108:111], v[188:191]
    v_mfma_f32_16x16x32_bf16 v[124:127], a[208:211], a[108:111], v[124:127]
    s_waitcnt lgkmcnt(4)
    v_mfma_f32_16x16x32_bf16 v[204:207], a[216:219], a[108:111], v[204:207]
    ds_read_b64_tr_b16 a[200:201], v14 offset:24576
    v_mfma_f32_16x16x32_bf16 v[252:255], a[220:223], a[108:111], v[252:255]
    ds_read_b64_tr_b16 a[202:203], v14 offset:28672
    v_mfma_f32_16x16x32_bf16 v[248:251], a[220:223], a[104:107], v[248:251]
    buffer_load_dwordx4 v4, s[24:27], s71 offen offset:1024  lds
    v_mfma_f32_16x16x32_bf16 v[200:203], a[216:219], a[104:107], v[200:203]
    ds_read_b64_tr_b16 a[204:205], v15 offset:24576
    v_mfma_f32_16x16x32_bf16 v[196:199], a[216:219], a[100:103], v[196:199]
    ds_read_b64_tr_b16 a[206:207], v15 offset:28672
    v_mfma_f32_16x16x32_bf16 v[244:247], a[220:223], a[100:103], v[244:247]
    v_mfma_f32_16x16x32_bf16 v[240:243], a[220:223], a[96:99], v[240:243]
    v_mfma_f32_16x16x32_bf16 v[192:195], a[216:219], a[96:99], v[192:195]
    s_waitcnt vmcnt(27) lgkmcnt(4)
    buffer_load_dwordx4 v5, s[24:27], s71 offen offset:2048  lds
    v_mfma_f32_16x16x32_bf16 v[48:51], a[192:195], a[112:115], v[48:51]
    ds_read_b64_tr_b16 a[208:209], v16 offset:24576
    v_mfma_f32_16x16x32_bf16 v[64:67], a[196:199], a[112:115], v[64:67]
    ds_read_b64_tr_b16 a[210:211], v16 offset:28672
    v_mfma_f32_16x16x32_bf16 v[68:71], a[196:199], a[116:119], v[68:71]
    v_mfma_f32_16x16x32_bf16 v[52:55], a[192:195], a[116:119], v[52:55]
    ds_read_b64_tr_b16 a[212:213], v17 offset:24576
    v_mfma_f32_16x16x32_bf16 v[56:59], a[192:195], a[120:123], v[56:59]
    ds_read_b64_tr_b16 a[214:215], v17 offset:28672
    v_mfma_f32_16x16x32_bf16 v[72:75], a[196:199], a[120:123], v[72:75]
    buffer_load_dwordx4 v6, s[24:27], s71 offen offset:3072  lds
    v_mfma_f32_16x16x32_bf16 v[76:79], a[196:199], a[124:127], v[76:79]
    v_mfma_f32_16x16x32_bf16 v[60:63], a[192:195], a[124:127], v[60:63]
    s_waitcnt lgkmcnt(4)
    v_mfma_f32_16x16x32_bf16 v[92:95], a[200:203], a[124:127], v[92:95]
    ds_read_b64_tr_b16 a[216:217], v18 offset:24576
    v_mfma_f32_16x16x32_bf16 v[108:111], a[204:207], a[124:127], v[108:111]
    s_add_u32 m0, s60, 69632
    ds_read_b64_tr_b16 a[218:219], v18 offset:28672
    v_mfma_f32_16x16x32_bf16 v[104:107], a[204:207], a[120:123], v[104:107]
    buffer_load_dwordx4 v7, s[24:27], s71 offen offset:0  lds
    v_mfma_f32_16x16x32_bf16 v[88:91], a[200:203], a[120:123], v[88:91]
    ds_read_b64_tr_b16 a[220:221], v19 offset:24576
    v_mfma_f32_16x16x32_bf16 v[84:87], a[200:203], a[116:119], v[84:87]
    ds_read_b64_tr_b16 a[222:223], v19 offset:28672
    v_mfma_f32_16x16x32_bf16 v[100:103], a[204:207], a[116:119], v[100:103]
    v_mfma_f32_16x16x32_bf16 v[96:99], a[204:207], a[112:115], v[96:99]
    v_mfma_f32_16x16x32_bf16 v[80:83], a[200:203], a[112:115], v[80:83]
    s_waitcnt vmcnt(22) lgkmcnt(4)
    s_barrier
    v_mfma_f32_16x16x32_bf16 v[112:115], a[208:211], a[112:115], v[112:115]
    ds_read_b64_tr_b16 a[192:193], v12 offset:32768
    v_mfma_f32_16x16x32_bf16 v[176:179], a[212:215], a[112:115], v[176:179]
    ds_read_b64_tr_b16 a[194:195], v12 offset:36864
    v_mfma_f32_16x16x32_bf16 v[180:183], a[212:215], a[116:119], v[180:183]
    buffer_load_dwordx4 v8, s[24:27], s71 offen offset:1024  lds
    v_mfma_f32_16x16x32_bf16 v[116:119], a[208:211], a[116:119], v[116:119]
    ds_read_b64_tr_b16 a[196:197], v13 offset:32768
    v_mfma_f32_16x16x32_bf16 v[120:123], a[208:211], a[120:123], v[120:123]
    ds_read_b64_tr_b16 a[198:199], v13 offset:36864
    v_mfma_f32_16x16x32_bf16 v[184:187], a[212:215], a[120:123], v[184:187]
    v_mfma_f32_16x16x32_bf16 v[188:191], a[212:215], a[124:127], v[188:191]
    v_mfma_f32_16x16x32_bf16 v[124:127], a[208:211], a[124:127], v[124:127]
    s_waitcnt lgkmcnt(4)
    buffer_load_dwordx4 v9, s[24:27], s71 offen offset:2048  lds
    v_mfma_f32_16x16x32_bf16 v[204:207], a[216:219], a[124:127], v[204:207]
    ds_read_b64_tr_b16 a[200:201], v14 offset:32768
    v_mfma_f32_16x16x32_bf16 v[252:255], a[220:223], a[124:127], v[252:255]
    ds_read_b64_tr_b16 a[202:203], v14 offset:36864
    v_mfma_f32_16x16x32_bf16 v[248:251], a[220:223], a[120:123], v[248:251]
    v_mfma_f32_16x16x32_bf16 v[200:203], a[216:219], a[120:123], v[200:203]
    ds_read_b64_tr_b16 a[204:205], v15 offset:32768
    v_mfma_f32_16x16x32_bf16 v[196:199], a[216:219], a[116:119], v[196:199]
    ds_read_b64_tr_b16 a[206:207], v15 offset:36864
    v_mfma_f32_16x16x32_bf16 v[244:247], a[220:223], a[116:119], v[244:247]
    buffer_load_dwordx4 v10, s[24:27], s71 offen offset:3072  lds
    v_mfma_f32_16x16x32_bf16 v[240:243], a[220:223], a[112:115], v[240:243]
    s_mov_b32 s71, s73
    v_mfma_f32_16x16x32_bf16 v[192:195], a[216:219], a[112:115], v[192:195]
    s_waitcnt vmcnt(21) lgkmcnt(4)
    v_mfma_f32_16x16x32_bf16 v[48:51], a[192:195], a[128:131], v[48:51]
    ds_read_b64_tr_b16 a[208:209], v16 offset:32768
    v_mfma_f32_16x16x32_bf16 v[64:67], a[196:199], a[128:131], v[64:67]
    ds_read_b64_tr_b16 a[210:211], v16 offset:36864
    v_mfma_f32_16x16x32_bf16 v[68:71], a[196:199], a[132:135], v[68:71]
    s_waitcnt vmcnt(20)
    v_cmp_ne_u32 vcc, s80, v38
    v_mfma_f32_16x16x32_bf16 v[52:55], a[192:195], a[132:135], v[52:55]
    s_cbranch_vccnz LF_fs_spin
LF_fs_back:
    ds_read_b64_tr_b16 a[212:213], v17 offset:32768
    v_mfma_f32_16x16x32_bf16 v[56:59], a[192:195], a[136:139], v[56:59]
    ds_read_b64_tr_b16 a[214:215], v17 offset:36864
    v_mfma_f32_16x16x32_bf16 v[72:75], a[196:199], a[136:139], v[72:75]
    buffer_load_dwordx2 a[0:1], v11, s[16:19], s67 offen offset:0 sc1
    v_mfma_f32_16x16x32_bf16 v[76:79], a[196:199], a[140:143], v[76:79]
    v_mfma_f32_16x16x32_bf16 v[60:63], a[192:195], a[140:143], v[60:63]
    s_waitcnt lgkmcnt(4)
    buffer_load_dwordx2 a[2:3], v11, s[16:19], s67 offen offset:512 sc1
    v_mfma_f32_16x16x32_bf16 v[92:95], a[200:203], a[140:143], v[92:95]
    ds_read_b64_tr_b16 a[216:217], v18 offset:32768
    v_mfma_f32_16x16x32_bf16 v[108:111], a[204:207], a[140:143], v[108:111]
    ds_read_b64_tr_b16 a[218:219], v18 offset:36864
    v_mfma_f32_16x16x32_bf16 v[104:107], a[204:207], a[136:139], v[104:107]
    buffer_load_dwordx2 a[4:5], v11, s[16:19], s67 offen offset:1024 sc1
    v_mfma_f32_16x16x32_bf16 v[88:91], a[200:203], a[136:139], v[88:91]
    ds_read_b64_tr_b16 a[220:221], v19 offset:32768
    v_mfma_f32_16x16x32_bf16 v[84:87], a[200:203], a[132:135], v[84:87]
    ds_read_b64_tr_b16 a[222:223], v19 offset:36864
    v_mfma_f32_16x16x32_bf16 v[100:103], a[204:207], a[132:135], v[100:103]
    buffer_load_dwordx2 a[6:7], v11, s[16:19], s67 offen offset:1536 sc1
    v_mfma_f32_16x16x32_bf16 v[96:99], a[204:207], a[128:131], v[96:99]
    v_mfma_f32_16x16x32_bf16 v[80:83], a[200:203], a[128:131], v[80:83]
    s_waitcnt lgkmcnt(4)
    buffer_load_dwordx2 a[8:9], v11, s[16:19], s67 offen offset:2048 sc1
    v_mfma_f32_16x16x32_bf16 v[112:115], a[208:211], a[128:131], v[112:115]
    ds_read_b64_tr_b16 a[192:193], v12 offset:40960
    v_mfma_f32_16x16x32_bf16 v[176:179], a[212:215], a[128:131], v[176:179]
    ds_read_b64_tr_b16 a[194:195], v12 offset:45056
    v_mfma_f32_16x16x32_bf16 v[180:183], a[212:215], a[132:135], v[180:183]
    buffer_load_dwordx2 a[10:11], v11, s[16:19], s67 offen offset:2560 sc1
    v_mfma_f32_16x16x32_bf16 v[116:119], a[208:211], a[132:135], v[116:119]
    ds_read_b64_tr_b16 a[196:197], v13 offset:40960
    v_mfma_f32_16x16x32_bf16 v[120:123], a[208:211], a[136:139], v[120:123]
    ds_read_b64_tr_b16 a[198:199], v13 offset:45056
    v_mfma_f32_16x16x32_bf16 v[184:187], a[212:215], a[136:139], v[184:187]
    buffer_load_dwordx2 a[12:13], v11, s[16:19], s67 offen offset:3072 sc1
    v_mfma_f32_16x16x32_bf16 v[188:191], a[212:215], a[140:143], v[188:191]
    v_mfma_f32_16x16x32_bf16 v[124:127], a[208:211], a[140:143], v[124:127]
    s_waitcnt lgkmcnt(4)
    buffer_load_dwordx2 a[14:15], v11, s[16:19], s67 offen offset:3584 sc1
    v_mfma_f32_16x16x32_bf16 v[204:207], a[216:219], a[140:143], v[204:207]
    s_add_u32 s67, s67, 4096
    ds_read_b64_tr_b16 a[200:201], v14 offset:40960
    v_mfma_f32_16x16x32_bf16 v[252:255], a[220:223], a[140:143], v[252:255]
    s_cmp_eq_u32 s67, s69
    s_cselect_b32 s67, s68, s67
    ds_read_b64_tr_b16 a[202:203], v14 offset:45056
    v_mfma_f32_16x16x32_bf16 v[248:251], a[220:223], a[136:139], v[248:251]
    buffer_load_dwordx2 a[16:17], v11, s[16:19], s67 offen offset:0 sc1
    v_mfma_f32_16x16x32_bf16 v[200:203], a[216:219], a[136:139], v[200:203]
    ds_read_b64_tr_b16 a[204:205], v15 offset:40960
    v_mfma_f32_16x16x32_bf16 v[196:199], a[216:219], a[132:135], v[196:199]
    ds_read_b64_tr_b16 a[206:207], v15 offset:45056
    v_mfma_f32_16x16x32_bf16 v[244:247], a[220:223], a[132:135], v[244:247]
    buffer_load_dwordx2 a[18:19], v11, s[16:19], s67 offen offset:512 sc1
    v_mfma_f32_16x16x32_bf16 v[240:243], a[220:223], a[128:131], v[240:243]
    v_mfma_f32_16x16x32_bf16 v[192:195], a[216:219], a[128:131], v[192:195]
    s_waitcnt vmcnt(26) lgkmcnt(4)
    v_mfma_f32_16x16x32_bf16 v[48:51], a[192:195], a[144:147], v[48:51]
    ds_read_b64_tr_b16 a[208:209], v16 offset:40960
    v_mfma_f32_16x16x32_bf16 v[64:67], a[196:199], a[144:147], v[64:67]
    ds_read_b64_tr_b16 a[210:211], v16 offset:45056
    v_mfma_f32_16x16x32_bf16 v[68:71], a[196:199], a[148:151], v[68:71]
    buffer_load_dwordx2 a[20:21], v11, s[16:19], s67 offen offset:1024 sc1
    v_mfma_f32_16x16x32_bf16 v[52:55], a[192:195], a[148:151], v[52:55]
    ds_read_b64_tr_b16 a[212:213], v17 offset:40960
    v_mfma_f32_16x16x32_bf16 v[56:59], a[192:195], a[152:155], v[56:59]
    ds_read_b64_tr_b16 a[214:215], v17 offset:45056
    v_mfma_f32_16x16x32_bf16 v[72:75], a[196:199], a[152:155], v[72:75]
    buffer_load_dwordx2 a[22:23], v11, s[16:19], s67 offen offset:1536 sc1
    v_mfma_f32_16x16x32_bf16 v[76:79], a[196:199], a[156:159], v[76:79]
    v_mfma_f32_16x16x32_bf16 v[60:63], a[192:195], a[156:159], v[60:63]
    s_waitcnt lgkmcnt(4)
    v_mfma_f32_16x16x32_bf16 v[92:95], a[200:203], a[156:159], v[92:95]
    ds_read_b64_tr_b16 a[216:217], v18 offset:40960
    v_mfma_f32_16x16x32_bf16 v[108:111], a[204:207], a[156:159], v[108:111]
    ds_read_b64_tr_b16 a[218:219], v18 offset:45056
    v_mfma_f32_16x16x32_bf16 v[104:107], a[204:207], a[152:155], v[104:107]
    buffer_load_dwordx2 a[24:25], v11, s[16:19], s67 offen offset:2048 sc1
    v_mfma_f32_16x16x32_bf16 v[88:91], a[200:203], a[152:155], v[88:91]
    ds_read_b64_tr_b16 a[220:221], v19 offset:40960
    v_mfma_f32_16x16x32_bf16 v[84:87], a[200:203], a[148:151], v[84:87]
    ds_read_b64_tr_b16 a[222:223], v19 offset:45056
    v_mfma_f32_16x16x32_bf16 v[100:103], a[204:207], a[148:151], v[100:103]
    buffer_load_dwordx2 a[26:27], v11, s[16:19], s67 offen offset:2560 sc1
    v_mfma_f32_16x16x32_bf16 v[96:99], a[204:207], a[144:147], v[96:99]
    v_mfma_f32_16x16x32_bf16 v[80:83], a[200:203], a[144:147], v[80:83]
    s_waitcnt lgkmcnt(4)
    v_mfma_f32_16x16x32_bf16 v[112:115], a[208:211], a[144:147], v[112:115]
    ds_read_b64_tr_b16 a[192:193], v12 offset:49152
    v_mfma_f32_16x16x32_bf16 v[176:179], a[212:215], a[144:147], v[176:179]
    ds_read_b64_tr_b16 a[194:195], v12 offset:53248
    v_mfma_f32_16x16x32_bf16 v[180:183], a[212:215], a[148:151], v[180:183]
    buffer_load_dwordx2 a[28:29], v11, s[16:19], s67 offen offset:3072 sc1
    v_mfma_f32_16x16x32_bf16 v[116:119], a[208:211], a[148:151], v[116:119]
    ds_read_b64_tr_b16 a[196:197], v13 offset:49152
    v_mfma_f32_16x16x32_bf16 v[120:123], a[208:211], a[152:155], v[120:123]
    ds_read_b64_tr_b16 a[198:199], v13 offset:53248
    v_mfma_f32_16x16x32_bf16 v[184:187], a[212:215], a[152:155], v[184:187]
    buffer_load_dwordx2 a[30:31], v11, s[16:19], s67 offen offset:3584 sc1
    v_mfma_f32_16x16x32_bf16 v[188:191], a[212:215], a[156:159], v[188:191]
    s_add_u32 s67, s67, 4096
    s_cmp_eq_u32 s67, s69
    s_cselect_b32 s67, s68, s67
    v_mfma_f32_16x16x32_bf16 v[124:127], a[208:211], a[156:159], v[124:127]
    s_waitcnt lgkmcnt(4)
    v_mfma_f32_16x16x32_bf16 v[204:207], a[216:219], a[156:159], v[204:207]
    ds_read_b64_tr_b16 a[200:201], v14 offset:49152
    v_mfma_f32_16x16x32_bf16 v[252:255], a[220:223], a[156:159], v[252:255]
    ds_read_b64_tr_b16 a[202:203], v14 offset:53248
    v_mfma_f32_16x16x32_bf16 v[248:251], a[220:223], a[152:155], v[248:251]
    buffer_load_dwordx2 a[32:33], v11, s[16:19], s67 offen offset:0 sc1
    v_mfma_f32_16x16x32_bf16 v[200:203], a[216:219], a[152:155], v[200:203]
    ds_read_b64_tr_b16 a[204:205], v15 offset:49152
    v_mfma_f32_16x16x32_bf16 v[196:199], a[216:219], a[148:151], v[196:199]
    ds_read_b64_tr_b16 a[206:207], v15 offset:53248
    v_mfma_f32_16x16x32_bf16 v[244:247], a[220:223], a[148:151], v[244:247]
    buffer_load_dwordx2 a[34:35], v11, s[16:19], s67 offen offset:512 sc1
    v_mfma_f32_16x16x32_bf16 v[240:243], a[220:223], a[144:147], v[240:243]
    v_mfma_f32_16x16x32_bf16 v[192:195], a[216:219], a[144:147], v[192:195]
LF_pad11:
    s_cbranch_execz LF_walked
    s_waitcnt vmcnt(30) lgkmcnt(4)
    v_mfma_f32_16x16x32_bf16 v[48:51], a[192:195], a[160:163], v[48:51]
    ds_read_b64_tr_b16 a[208:209], v16 offset:49152
    v_mfma_f32_16x16x32_bf16 v[64:67], a[196:199], a[160:163], v[64:67]
    ds_read_b64_tr_b16 a[210:211], v16 offset:53248
    v_mfma_f32_16x16x32_bf16 v[68:71], a[196:199], a[164:167], v[68:71]
    buffer_load_dwordx2 a[36:37], v11, s[16:19], s67 offen offset:1024 sc1
    v_mfma_f32_16x16x32_bf16 v[52:55], a[192:195], a[164:167], v[52:55]
    ds_read_b64_tr_b16 a[212:213], v17 offset:49152
    v_mfma_f32_16x16x32_bf16 v[56:59], a[192:195], a[168:171], v[56:59]
    ds_read_b64_tr_b16 a[214:215], v17 offset:53248
    v_mfma_f32_16x16x32_bf16 v[72:75], a[196:199], a[168:171], v[72:75]
    buffer_load_dwordx2 a[38:39], v11, s[16:19], s67 offen offset:1536 sc1
    v_mfma_f32_16x16x32_bf16 v[76:79], a[196:199], a[172:175], v[76:79]
    v_mfma_f32_16x16x32_bf16 v[60:63], a[192:195], a[172:175], v[60:63]
    s_waitcnt lgkmcnt(4)
    v_mfma_f32_16x16x32_bf16 v[92:95], a[200:203], a[172:175], v[92:95]
    ds_read_b64_tr_b16 a[216:217], v18 offset:49152
    v_mfma_f32_16x16x32_bf16 v[108:111], a[204:207], a[172:175], v[108:111]
    ds_read_b64_tr_b16 a[218:219], v18 offset:53248
    v_mfma_f32_16x16x32_bf16 v[104:107], a[204:207], a[168:171], v[104:107]
    buffer_load_dwordx2 a[40:41], v11, s[16:19], s67 offen offset:2048 sc1
    v_mfma_f32_16x16x32_bf16 v[88:91], a[200:203], a[168:171], v[88:91]
    ds_read_b64_tr_b16 a[220:221], v19 offset:49152
    v_mfma_f32_16x16x32_bf16 v[84:87], a[200:203], a[164:167], v[84:87]
    ds_read_b64_tr_b16 a[222:223], v19 offset:53248
    v_mfma_f32_16x16x32_bf16 v[100:103], a[204:207], a[164:167], v[100:103]
    buffer_load_dwordx2 a[42:43], v11, s[16:19], s67 offen offset:2560 sc1
    v_mfma_f32_16x16x32_bf16 v[96:99], a[204:207], a[160:163], v[96:99]
    v_mfma_f32_16x16x32_bf16 v[80:83], a[200:203], a[160:163], v[80:83]
    s_waitcnt lgkmcnt(4)
    v_mfma_f32_16x16x32_bf16 v[112:115], a[208:211], a[160:163], v[112:115]
    ds_read_b64_tr_b16 a[192:193], v12 offset:57344
    v_mfma_f32_16x16x32_bf16 v[176:179], a[212:215], a[160:163], v[176:179]
    ds_read_b64_tr_b16 a[194:195], v12 offset:61440
    v_xor_b32 v12, 0x10000, v12
    v_mfma_f32_16x16x32_bf16 v[180:183], a[212:215], a[164:167], v[180:183]
    buffer_load_dwordx2 a[44:45], v11, s[16:19], s67 offen offset:3072 sc1
    v_mfma_f32_16x16x32_bf16 v[116:119], a[208:211], a[164:167], v[116:119]
    ds_read_b64_tr_b16 a[196:197], v13 offset:57344
    v_mfma_f32_16x16x32_bf16 v[120:123], a[208:211], a[168:171], v[120:123]
    ds_read_b64_tr_b16 a[198:199], v13 offset:61440
    v_xor_b32 v13, 0x10000, v13
    v_mfma_f32_16x16x32_bf16 v[184:187], a[212:215], a[168:171], v[184:187]
    buffer_load_dwordx2 a[46:47], v11, s[16:19], s67 offen offset:3584 sc1
    v_mfma_f32_16x16x32_bf16 v[188:191], a[212:215], a[172:175], v[188:191]
    s_add_u32 s67, s67, 4096
    s_cmp_eq_u32 s67, s69
    s_cselect_b32 s67, s68, s67
    v_mfma_f32_16x16x32_bf16 v[124:127], a[208:211], a[172:175], v[124:127]
    s_waitcnt lgkmcnt(4)
    v_mfma_f32_16x16x32_bf16 v[204:207], a[216:219], a[172:175], v[204:207]
    ds_read_b64_tr_b16 a[200:201], v14 offset:57344
    v_mfma_f32_16x16x32_bf16 v[252:255], a[220:223], a[172:175], v[252:255]
    ds_read_b64_tr_b16 a[202:203], v14 offset:61440
    v_xor_b32 v14, 0x10000, v14
    v_mfma_f32_16x16x32_bf16 v[248:251], a[220:223], a[168:171], v[248:251]
    buffer_load_dwordx2 a[48:49], v11, s[16:19], s67 offen offset:0 sc1
    v_mfma_f32_16x16x32_bf16 v[200:203], a[216:219], a[168:171], v[200:203]
    ds_read_b64_tr_b16 a[204:205], v15 offset:57344
    v_mfma_f32_16x16x32_bf16 v[196:199], a[216:219], a[164:167], v[196:199]
    ds_read_b64_tr_b16 a[206:207], v15 offset:61440
    v_xor_b32 v15, 0x10000, v15
    v_mfma_f32_16x16x32_bf16 v[244:247], a[220:223], a[164:167], v[244:247]
    buffer_load_dwordx2 a[50:51], v11, s[16:19], s67 offen offset:512 sc1
    v_mfma_f32_16x16x32_bf16 v[240:243], a[220:223], a[160:163], v[240:243]
    v_mfma_f32_16x16x32_bf16 v[192:195], a[216:219], a[160:163], v[192:195]
    s_waitcnt vmcnt(34) lgkmcnt(4)
    v_mfma_f32_16x16x32_bf16 v[48:51], a[192:195], a[176:179], v[48:51]
    ds_read_b64_tr_b16 a[208:209], v16 offset:57344
    v_mfma_f32_16x16x32_bf16 v[64:67], a[196:199], a[176:179], v[64:67]
    ds_read_b64_tr_b16 a[210:211], v16 offset:61440
    v_xor_b32 v16, 0x10000, v16
    v_mfma_f32_16x16x32_bf16 v[68:71], a[196:199], a[180:183], v[68:71]
    buffer_load_dwordx2 a[52:53], v11, s[16:19], s67 offen offset:1024 sc1
    v_mfma_f32_16x16x32_bf16 v[52:55], a[192:195], a[180:183], v[52:55]
    ds_read_b64_tr_b16 a[212:213], v17 offset:57344
    v_mfma_f32_16x16x32_bf16 v[56:59], a[192:195], a[184:187], v[56:59]
    ds_read_b64_tr_b16 a[214:215], v17 offset:61440
    v_xor_b32 v17, 0x10000, v17
    v_mfma_f32_16x16x32_bf16 v[72:75], a[196:199], a[184:187], v[72:75]
    buffer_load_dwordx2 a[54:55], v11, s[16:19], s67 offen offset:1536 sc1
    v_mfma_f32_16x16x32_bf16 v[76:79], a[196:199], a[188:191], v[76:79]
    v_mfma_f32_16x16x32_bf16 v[60:63], a[192:195], a[188:191], v[60:63]
    s_waitcnt lgkmcnt(4)
    v_mfma_f32_16x16x32_bf16 v[92:95], a[200:203], a[188:191], v[92:95]
    ds_read_b64_tr_b16 a[216:217], v18 offset:57344
    v_mfma_f32_16x16x32_bf16 v[108:111], a[204:207], a[188:191], v[108:111]
    ds_read_b64_tr_b16 a[218:219], v18 offset:61440
    v_xor_b32 v18, 0x10000, v18
    v_mfma_f32_16x16x32_bf16 v[104:107], a[204:207], a[184:187], v[104:107]
    buffer_load_dwordx2 a[56:57], v11, s[16:19], s67 offen offset:2048 sc1
    v_mfma_f32_16x16x32_bf16 v[88:91], a[200:203], a[184:187], v[88:91]
    ds_read_b64_tr_b16 a[220:221], v19 offset:57344
    v_mfma_f32_16x16x32_bf16 v[84:87], a[200:203], a[180:183], v[84:87]
    ds_read_b64_tr_b16 a[222:223], v19 offset:61440
    v_xor_b32 v19, 0x10000, v19
    v_mfma_f32_16x16x32_bf16 v[100:103], a[204:207], a[180:183], v[100:103]
    buffer_load_dwordx2 a[58:59], v11, s[16:19], s67 offen offset:2560 sc1
    v_mfma_f32_16x16x32_bf16 v[96:99], a[204:207], a[176:179], v[96:99]
    v_mfma_f32_16x16x32_bf16 v[80:83], a[200:203], a[176:179], v[80:83]
    s_waitcnt vmcnt(30) lgkmcnt(4)
    s_barrier
    v_mfma_f32_16x16x32_bf16 v[112:115], a[208:211], a[176:179], v[112:115]
    ds_read_b64_tr_b16 a[192:193], v12 offset:0
    v_mfma_f32_16x16x32_bf16 v[176:179], a[212:215], a[176:179], v[176:179]
    ds_read_b64_tr_b16 a[194:195], v12 offset:4096
    v_mfma_f32_16x16x32_bf16 v[180:183], a[212:215], a[180:183], v[180:183]
    buffer_load_dwordx2 a[60:61], v11, s[16:19], s67 offen offset:3072 sc1
    v_mfma_f32_16x16x32_bf16 v[116:119], a[208:211], a[180:183], v[116:119]
    ds_read_b64_tr_b16 a[196:197], v13 offset:0
    v_mfma_f32_16x16x32_bf16 v[120:123], a[208:211], a[184:187], v[120:123]
    ds_read_b64_tr_b16 a[198:199], v13 offset:4096
    v_mfma_f32_16x16x32_bf16 v[184:187], a[212:215], a[184:187], v[184:187]
    buffer_load_dwordx2 a[62:63], v11, s[16:19], s67 offen offset:3584 sc1
    v_mfma_f32_16x16x32_bf16 v[188:191], a[212:215], a[188:191], v[188:191]
    s_mov_b32 s67, s70
    v_mfma_f32_16x16x32_bf16 v[124:127], a[208:211], a[188:191], v[124:127]
    s_waitcnt lgkmcnt(4)
    v_mfma_f32_16x16x32_bf16 v[204:207], a[216:219], a[188:191], v[204:207]
    ds_read_b64_tr_b16 a[200:201], v14 offset:0
    v_mfma_f32_16x16x32_bf16 v[252:255], a[220:223], a[188:191], v[252:255]
    s_add_u32 m0, s60, 98304
    ds_read_b64_tr_b16 a[202:203], v14 offset:4096
    v_mfma_f32_16x16x32_bf16 v[248:251], a[220:223], a[184:187], v[248:251]
    buffer_load_dwordx4 v20, s[28:31], s71 offen offset:0  lds
    v_mfma_f32_16x16x32_bf16 v[200:203], a[216:219], a[184:187], v[200:203]
    ds_read_b64_tr_b16 a[204:205], v15 offset:0
    v_mfma_f32_16x16x32_bf16 v[196:199], a[216:219], a[180:183], v[196:199]
    ds_read_b64_tr_b16 a[206:207], v15 offset:4096
    v_mfma_f32_16x16x32_bf16 v[244:247], a[220:223], a[180:183], v[244:247]
    v_mfma_f32_16x16x32_bf16 v[240:243], a[220:223], a[176:179], v[240:243]
    buffer_load_dwordx4 v21, s[28:31], s71 offen offset:1024  lds
    v_mfma_f32_16x16x32_bf16 v[192:195], a[216:219], a[176:179], v[192:195]
    s_waitcnt vmcnt(26) lgkmcnt(4)
    v_mfma_f32_16x16x32_bf16 v[48:51], a[192:195], a[0:3], v[48:51]
    ds_read_b64_tr_b16 a[208:209], v16 offset:0
    v_mfma_f32_16x16x32_bf16 v[64:67], a[196:199], a[0:3], v[64:67]
    ds_read_b64_tr_b16 a[210:211], v16 offset:4096
    v_mfma_f32_16x16x32_bf16 v[68:71], a[196:199], a[4:7], v[68:71]
    buffer_load_dwordx4 v22, s[28:31], s71 offen offset:2048  lds
    v_mfma_f32_16x16x32_bf16 v[52:55], a[192:195], a[4:7], v[52:55]
    ds_read_b64_tr_b16 a[212:213], v17 offset:0
    v_mfma_f32_16x16x32_bf16 v[56:59], a[192:195], a[8:11], v[56:59]
    ds_read_b64_tr_b16 a[214:215], v17 offset:4096
    v_mfma_f32_16x16x32_bf16 v[72:75], a[196:199], a[8:11], v[72:75]
    v_mfma_f32_16x16x32_bf16 v[76:79], a[196:199], a[12:15], v[76:79]
    buffer_load_dwordx4 v23, s[28:31], s71 offen offset:3072  lds
    v_mfma_f32_16x16x32_bf16 v[60:63], a[192:195], a[12:15], v[60:63]
    s_waitcnt lgkmcnt(4)
    v_mfma_f32_16x16x32_bf16 v[92:95], a[200:203], a[12:15], v[92:95]
    ds_read_b64_tr_b16 a[216:217], v18 offset:0
    v_mfma_f32_16x16x32_bf16 v[108:111], a[204:207], a[12:15], v[108:111]
    s_add_u32 m0, s60, 102400
    ds_read_b64_tr_b16 a[218:219], v18 offset:4096
    v_mfma_f32_16x16x32_bf16 v[104:107], a[204:207], a[8:11], v[104:107]
    buffer_load_dwordx4 v24, s[28:31], s71 offen offset:0  lds
    v_mfma_f32_16x16x32_bf16 v[88:91], a[200:203], a[8:11], v[88:91]
    ds_read_b64_tr_b16 a[220:221], v19 offset:0
    v_mfma_f32_16x16x32_bf16 v[84:87], a[200:203], a[4:7], v[84:87]
    ds_read_b64_tr_b16 a[222:223], v19 offset:4096
    v_mfma_f32_16x16x32_bf16 v[100:103], a[204:207], a[4:7], v[100:103]
    v_mfma_f32_16x16x32_bf16 v[96:99], a[204:207], a[0:3], v[96:99]
    buffer_load_dwordx4 v25, s[28:31], s71 offen offset:1024  lds
    v_mfma_f32_16x16x32_bf16 v[80:83], a[200:203], a[0:3], v[80:83]
    s_waitcnt lgkmcnt(4)
    v_mfma_f32_16x16x32_bf16 v[112:115], a[208:211], a[0:3], v[112:115]
    ds_read_b64_tr_b16 a[192:193], v12 offset:8192
    v_mfma_f32_16x16x32_bf16 v[176:179], a[212:215], a[0:3], v[176:179]
    ds_read_b64_tr_b16 a[194:195], v12 offset:12288
    v_mfma_f32_16x16x32_bf16 v[180:183], a[212:215], a[4:7], v[180:183]
    buffer_load_dwordx4 v26, s[28:31], s71 offen offset:2048  lds
    v_mfma_f32_16x16x32_bf16 v[116:119], a[208:211], a[4:7], v[116:119]
    ds_read_b64_tr_b16 a[196:197], v13 offset:8192
    v_mfma_f32_16x16x32_bf16 v[120:123], a[208:211], a[8:11], v[120:123]
    ds_read_b64_tr_b16 a[198:199], v13 offset:12288
    v_mfma_f32_16x16x32_bf16 v[184:187], a[212:215], a[8:11], v[184:187]
    v_mfma_f32_16x16x32_bf16 v[188:191], a[212:215], a[12:15], v[188:191]
    buffer_load_dwordx4 v27, s[28:31], s71 offen offset:3072  lds
    v_mfma_f32_16x16x32_bf16 v[124:127], a[208:211], a[12:15], v[124:127]
    s_add_u32 s71, s71, 128
    s_waitcnt lgkmcnt(4)
    v_mfma_f32_16x16x32_bf16 v[204:207], a[216:219], a[12:15], v[204:207]
    ds_read_b64_tr_b16 a[200:201], v14 offset:8192
    v_mfma_f32_16x16x32_bf16 v[252:255], a[220:223], a[12:15], v[252:255]
    ds_read_b64_tr_b16 a[202:203], v14 offset:12288
    v_mfma_f32_16x16x32_bf16 v[248:251], a[220:223], a[8:11], v[248:251]
    buffer_load_dwordx4 a[64:67], v2, s[16:19], s67 offen offset:0 sc1
    v_mfma_f32_16x16x32_bf16 v[200:203], a[216:219], a[8:11], v[200:203]
    ds_read_b64_tr_b16 a[204:205], v15 offset:8192
    v_mfma_f32_16x16x32_bf16 v[196:199], a[216:219], a[4:7], v[196:199]
    ds_read_b64_tr_b16 a[206:207], v15 offset:12288
    v_mfma_f32_16x16x32_bf16 v[244:247], a[220:223], a[4:7], v[244:247]
    v_mfma_f32_16x16x32_bf16 v[240:243], a[220:223], a[0:3], v[240:243]
    buffer_load_dwordx4 a[68:71], v2, s[16:19], s67 offen offset:1024 sc1
    v_mfma_f32_16x16x32_bf16 v[192:195], a[216:219], a[0:3], v[192:195]
    s_waitcnt vmcnt(26) lgkmcnt(4)
    v_mfma_f32_16x16x32_bf16 v[48:51], a[192:195], a[16:19], v[48:51]
    ds_read_b64_tr_b16 a[208:209], v16 offset:8192
    v_mfma_f32_16x16x32_bf16 v[64:67], a[196:199], a[16:19], v[64:67]
    ds_read_b64_tr_b16 a[210:211], v16 offset:12288
    v_mfma_f32_16x16x32_bf16 v[68:71], a[196:199], a[20:23], v[68:71]
    buffer_load_dwordx4 a[72:75], v2, s[16:19], s67 offen offset:2048 sc1
    v_mfma_f32_16x16x32_bf16 v[52:55], a[192:195], a[20:23], v[52:55]
    ds_read_b64_tr_b16 a[212:213], v17 offset:8192
    v_mfma_f32_16x16x32_bf16 v[56:59], a[192:195], a[24:27], v[56:59]
    ds_read_b64_tr_b16 a[214:215], v17 offset:12288
    v_mfma_f32_16x16x32_bf16 v[72:75], a[196:199], a[24:27], v[72:75]
    v_mfma_f32_16x16x32_bf16 v[76:79], a[196:199], a[28:31], v[76:79]
    buffer_load_dwordx4 a[76:79], v2, s[16:19], s67 offen offset:3072 sc1
    v_mfma_f32_16x16x32_bf16 v[60:63], a[192:195], a[28:31], v[60:63]
    s_add_u32 s67, s67, 4096
    s_waitcnt lgkmcnt(4)
    v_mfma_f32_16x16x32_bf16 v[92:95], a[200:203], a[28:31], v[92:95]
    ds_read_b64_tr_b16 a[216:217], v18 offset:8192
    v_mfma_f32_16x16x32_bf16 v[108:111], a[204:207], a[28:31], v[108:111]
    ds_read_b64_tr_b16 a[218:219], v18 offset:12288
    v_mfma_f32_16x16x32_bf16 v[104:107], a[204:207], a[24:27], v[104:107]
    buffer_load_dwordx4 a[80:83], v2, s[16:19], s67 offen offset:0 sc1
    v_mfma_f32_16x16x32_bf16 v[88:91], a[200:203], a[24:27], v[88:91]
    ds_read_b64_tr_b16 a[220:221], v19 offset:8192
    v_mfma_f32_16x16x32_bf16 v[84:87], a[200:203], a[20:23], v[84:87]
    ds_read_b64_tr_b16 a[222:223], v19 offset:12288
    v_mfma_f32_16x16x32_bf16 v[100:103], a[204:207], a[20:23], v[100:103]
    v_mfma_f32_16x16x32_bf16 v[96:99], a[204:207], a[16:19], v[96:99]
    buffer_load_dwordx4 a[84:87], v2, s[16:19], s67 offen offset:1024 sc1
    v_mfma_f32_16x16x32_bf16 v[80:83], a[200:203], a[16:19], v[80:83]
    s_waitcnt lgkmcnt(4)
    v_mfma_f32_16x16x32_bf16 v[112:115], a[208:211], a[16:19], v[112:115]
    ds_read_b64_tr_b16 a[192:193], v12 offset:16384
    v_mfma_f32_16x16x32_bf16 v[176:179], a[212:215], a[16:19], v[176:179]
    ds_read_b64_tr_b16 a[194:195], v12 offset:20480
    v_mfma_f32_16x16x32_bf16 v[180:183], a[212:215], a[20:23], v[180:183]
    buffer_load_dwordx4 a[88:91], v2, s[16:19], s67 offen offset:2048 sc1
    v_mfma_f32_16x16x32_bf16 v[116:119], a[208:211], a[20:23], v[116:119]
    ds_read_b64_tr_b16 a[196:197], v13 offset:16384
    v_mfma_f32_16x16x32_bf16 v[120:123], a[208:211], a[24:27], v[120:123]
    ds_read_b64_tr_b16 a[198:199], v13 offset:20480
    v_mfma_f32_16x16x32_bf16 v[184:187], a[212:215], a[24:27], v[184:187]
    v_mfma_f32_16x16x32_bf16 v[188:191], a[212:215], a[28:31], v[188:191]
    buffer_load_dwordx4 a[92:95], v2, s[16:19], s67 offen offset:3072 sc1
    v_mfma_f32_16x16x32_bf16 v[124:127], a[208:211], a[28:31], v[124:127]
    s_add_u32 s67, s67, 4096
    s_waitcnt lgkmcnt(4)
    v_mfma_f32_16x16x32_bf16 v[204:207], a[216:219], a[28:31], v[204:207]
    ds_read_b64_tr_b16 a[200:201], v14 offset:16384
    v_mfma_f32_16x16x32_bf16 v[252:255], a[220:223], a[28:31], v[252:255]
    ds_read_b64_tr_b16 a[202:203], v14 offset:20480
    v_mfma_f32_16x16x32_bf16 v[248:251], a[220:223], a[24:27], v[248:251]
    buffer_load_dwordx4 a[96:99], v2, s[16:19], s67 offen offset:0 sc1
    v_mfma_f32_16x16x32_bf16 v[200:203], a[216:219], a[24:27], v[200:203]
    ds_read_b64_tr_b16 a[204:205], v15 offset:16384
    v_mfma_f32_16x16x32_bf16 v[196:199], a[216:219], a[20:23], v[196:199]
    ds_read_b64_tr_b16 a[206:207], v15 offset:20480
    v_mfma_f32_16x16x32_bf16 v[244:247], a[220:223], a[20:23], v[244:247]
    v_mfma_f32_16x16x32_bf16 v[240:243], a[220:223], a[16:19], v[240:243]
    v_mfma_f32_16x16x32_bf16 v[192:195], a[216:219], a[16:19], v[192:195]
    s_waitcnt vmcnt(25) lgkmcnt(4)
    buffer_load_dwordx4 a[100:103], v2, s[16:19], s67 offen offset:1024 sc1
    v_mfma_f32_16x16x32_bf16 v[48:51], a[192:195], a[32:35], v[48:51]
    ds_read_b64_tr_b16 a[208:209], v16 offset:16384
    v_mfma_f32_16x16x32_bf16 v[64:67], a[196:199], a[32:35], v[64:67]
    ds_read_b64_tr_b16 a[210:211], v16 offset:20480
    v_mfma_f32_16x16x32_bf16 v[68:71], a[196:199], a[36:39], v[68:71]
    v_mfma_f32_16x16x32_bf16 v[52:55], a[192:195], a[36:39], v[52:55]
    ds_read_b64_tr_b16 a[212:213], v17 offset:16384
    v_mfma_f32_16x16x32_bf16 v[56:59], a[192:195], a[40:43], v[56:59]
    ds_read_b64_tr_b16 a[214:215], v17 offset:20480
    v_mfma_f32_16x16x32_bf16 v[72:75], a[196:199], a[40:43], v[72:75]
    buffer_load_dwordx4 a[104:107], v2, s[16:19], s67 offen offset:2048 sc1
    v_mfma_f32_16x16x32_bf16 v[76:79], a[196:199], a[44:47], v[76:79]
    v_mfma_f32_16x16x32_bf16 v[60:63], a[192:195], a[44:47], v[60:63]
    s_waitcnt lgkmcnt(4)
    v_mfma_f32_16x16x32_bf16 v[92:95], a[200:203], a[44:47], v[92:95]
    ds_read_b64_tr_b16 a[216:217], v18 offset:16384
    v_mfma_f32_16x16x32_bf16 v[108:111], a[204:207], a[44:47], v[108:111]
    ds_read_b64_tr_b16 a[218:219], v18 offset:20480
    v_mfma_f32_16x16x32_bf16 v[104:107], a[204:207], a[40:43], v[104:107]
    buffer_load_dwordx4 a[108:111], v2, s[16:19], s67 offen offset:3072 sc1
    v_mfma_f32_16x16x32_bf16 v[88:91], a[200:203], a[40:43], v[88:91]
    s_add_u32 s67, s67, 4096
    ds_read_b64_tr_b16 a[220:221], v19 offset:16384
    v_mfma_f32_16x16x32_bf16 v[84:87], a[200:203], a[36:39], v[84:87]
    ds_read_b64_tr_b16 a[222:223], v19 offset:20480
    v_mfma_f32_16x16x32_bf16 v[100:103], a[204:207], a[36:39], v[100:103]
    v_mfma_f32_16x16x32_bf16 v[96:99], a[204:207], a[32:35], v[96:99]
    v_mfma_f32_16x16x32_bf16 v[80:83], a[200:203], a[32:35], v[80:83]
    s_waitcnt lgkmcnt(4)
    buffer_load_dwordx4 a[112:115], v2, s[16:19], s67 offen offset:0 sc1
    v_mfma_f32_16x16x32_bf16 v[112:115], a[208:211], a[32:35], v[112:115]
    ds_read_b64_tr_b16 a[192:193], v12 offset:24576
    v_mfma_f32_16x16x32_bf16 v[176:179], a[212:215], a[32:35], v[176:179]
    ds_read_b64_tr_b16 a[194:195], v12 offset:28672
    v_mfma_f32_16x16x32_bf16 v[180:183], a[212:215], a[36:39], v[180:183]
    v_mfma_f32_16x16x32_bf16 v[116:119], a[208:211], a[36:39], v[116:119]
    ds_read_b64_tr_b16 a[196:197], v13 offset:24576
    v_mfma_f32_16x16x32_bf16 v[120:123], a[208:211], a[40:43], v[120:123]
    ds_read_b64_tr_b16 a[198:199], v13 offset:28672
    v_mfma_f32_16x16x32_bf16 v[184:187], a[212:215], a[40:43], v[184:187]
    buffer_load_dwordx4 a[116:119], v2, s[16:19], s67 offen offset:1024 sc1
    v_mfma_f32_16x16x32_bf16 v[188:191], a[212:215], a[44:47], v[188:191]
    v_mfma_f32_16x16x32_bf16 v[124:127], a[208:211], a[44:47], v[124:127]
    s_waitcnt lgkmcnt(4)
    v_mfma_f32_16x16x32_bf16 v[204:207], a[216:219], a[44:47], v[204:207]
    ds_read_b64_tr_b16 a[200:201], v14 offset:24576
    v_mfma_f32_16x16x32_bf16 v[252:255], a[220:223], a[44:47], v[252:255]
    ds_read_b64_tr_b16 a[202:203], v14 offset:28672
    v_mfma_f32_16x16x32_bf16 v[248:251], a[220:223], a[40:43], v[248:251]
    buffer_load_dwordx4 a[120:123], v2, s[16:19], s67 offen offset:2048 sc1
    v_mfma_f32_16x16x32_bf16 v[200:203], a[216:219], a[40:43], v[200:203]
    ds_read_b64_tr_b16 a[204:205], v15 offset:24576
    v_mfma_f32_16x16x32_bf16 v[196:199], a[216:219], a[36:39], v[196:199]
    ds_read_b64_tr_b16 a[206:207], v15 offset:28672
    v_mfma_f32_16x16x32_bf16 v[244:247], a[220:223], a[36:39], v[244:247]
    v_mfma_f32_16x16x32_bf16 v[240:243], a[220:223], a[32:35], v[240:243]
    v_mfma_f32_16x16x32_bf16 v[192:195], a[216:219], a[32:35], v[192:195]
    s_waitcnt vmcnt(23) lgkmcnt(4)
    buffer_load_dwordx4 a[124:127], v2, s[16:19], s67 offen offset:3072 sc1
    v_mfma_f32_16x16x32_bf16 v[48:51], a[192:195], a[48:51], v[48:51]
    s_add_u32 s67, s67, 4096
    ds_read_b64_tr_b16 a[208:209], v16 offset:24576
    v_mfma_f32_16x16x32_bf16 v[64:67], a[196:199], a[48:51], v[64:67]
    ds_read_b64_tr_b16 a[210:211], v16 offset:28672
    v_mfma_f32_16x16x32_bf16 v[68:71], a[196:199], a[52:55], v[68:71]
    v_mfma_f32_16x16x32_bf16 v[52:55], a[192:195], a[52:55], v[52:55]
    ds_read_b64_tr_b16 a[212:213], v17 offset:24576
    v_mfma_f32_16x16x32_bf16 v[56:59], a[192:195], a[56:59], v[56:59]
    s_add_u32 m0, s60, 0
    ds_read_b64_tr_b16 a[214:215], v17 offset:28672
    v_mfma_f32_16x16x32_bf16 v[72:75], a[196:199], a[56:59], v[72:75]
    buffer_load_dwordx4 v20, s[28:31], s71 offen offset:0  lds
    v_mfma_f32_16x16x32_bf16 v[76:79], a[196:199], a[60:63], v[76:79]
    v_mfma_f32_16x16x32_bf16 v[60:63], a[192:195], a[60:63], v[60:63]
    s_waitcnt lgkmcnt(4)
    v_mfma_f32_16x16x32_bf16 v[92:95], a[200:203], a[60:63], v[92:95]
    ds_read_b64_tr_b16 a[216:217], v18 offset:24576
    v_mfma_f32_16x16x32_bf16 v[108:111], a[204:207], a[60:63], v[108:111]
    ds_read_b64_tr_b16 a[218:219], v18 offset:28672
    v_mfma_f32_16x16x32_bf16 v[104:107], a[204:207], a[56:59], v[104:107]
    buffer_load_dwordx4 v21, s[28:31], s71 offen offset:1024  lds
    v_mfma_f32_16x16x32_bf16 v[88:91], a[200:203], a[56:59], v[88:91]
    ds_read_b64_tr_b16 a[220:221], v19 offset:24576
    v_mfma_f32_16x16x32_bf16 v[84:87], a[200:203], a[52:55], v[84:87]
    ds_read_b64_tr_b16 a[222:223], v19 offset:28672
    v_mfma_f32_16x16x32_bf16 v[100:103], a[204:207], a[52:55], v[100:103]
    v_mfma_f32_16x16x32_bf16 v[96:99], a[204:207], a[48:51], v[96:99]
    v_mfma_f32_16x16x32_bf16 v[80:83], a[200:203], a[48:51], v[80:83]
    s_waitcnt vmcnt(18) lgkmcnt(4)
    s_barrier
    v_mfma_f32_16x16x32_bf16 v[112:115], a[208:211], a[48:51], v[112:115]
    ds_read_b128 a[192:195], v30 offset:32768
    v_mfma_f32_16x16x32_bf16 v[176:179], a[212:215], a[48:51], v[176:179]
    buffer_load_dwordx4 v22, s[28:31], s71 offen offset:2048  lds
    v_mfma_f32_16x16x32_bf16 v[180:183], a[212:215], a[52:55], v[180:183]
    v_mfma_f32_16x16x32_bf16 v[116:119], a[208:211], a[52:55], v[116:119]
    ds_read_b128 a[196:199], v30 offset:34816
    v_mfma_f32_16x16x32_bf16 v[120:123], a[208:211], a[56:59], v[120:123]
    v_mfma_f32_16x16x32_bf16 v[184:187], a[212:215], a[56:59], v[184:187]
    v_mfma_f32_16x16x32_bf16 v[188:191], a[212:215], a[60:63], v[188:191]
    buffer_load_dwordx4 v23, s[28:31], s71 offen offset:3072  lds
    v_mfma_f32_16x16x32_bf16 v[124:127], a[208:211], a[60:63], v[124:127]
    s_waitcnt lgkmcnt(2)
    v_mfma_f32_16x16x32_bf16 v[204:207], a[216:219], a[60:63], v[204:207]
    ds_read_b128 a[200:203], v30 offset:36864
    v_mfma_f32_16x16x32_bf16 v[252:255], a[220:223], a[60:63], v[252:255]
    v_mfma_f32_16x16x32_bf16 v[248:251], a[220:223], a[56:59], v[248:251]
    v_mfma_f32_16x16x32_bf16 v[200:203], a[216:219], a[56:59], v[200:203]
    s_add_u32 m0, s60, 4096
    ds_read_b128 a[204:207], v30 offset:38912
    v_mfma_f32_16x16x32_bf16 v[196:199], a[216:219], a[52:55], v[196:199]
    buffer_load_dwordx4 v24, s[28:31], s71 offen offset:0  lds
    v_mfma_f32_16x16x32_bf16 v[244:247], a[220:223], a[52:55], v[244:247]
    v_mfma_f32_16x16x32_bf16 v[240:243], a[220:223], a[48:51], v[240:243]
    v_mfma_f32_16x16x32_bf16 v[192:195], a[216:219], a[48:51], v[192:195]
    s_waitcnt vmcnt(17) lgkmcnt(2)
    v_mfma_f32_16x16x32_bf16 v[48:51], a[192:195], a[64:67], v[48:51]
    ds_read_b128 a[208:211], v30 offset:40960
    v_mfma_f32_16x16x32_bf16 v[64:67], a[196:199], a[64:67], v[64:67]
    buffer_load_dwordx4 v25, s[28:31], s71 offen offset:1024  lds
    v_mfma_f32_16x16x32_bf16 v[68:71], a[196:199], a[68:71], v[68:71]
    v_mfma_f32_16x16x32_bf16 v[52:55], a[192:195], a[68:71], v[52:55]
    ds_read_b128 a[212:215], v30 offset:43008
    v_mfma_f32_16x16x32_bf16 v[56:59], a[192:195], a[72:75], v[56:59]
    v_mfma_f32_16x16x32_bf16 v[72:75], a[196:199], a[72:75], v[72:75]
    v_mfma_f32_16x16x32_bf16 v[76:79], a[196:199], a[76:79], v[76:79]
    buffer_load_dwordx4 v26, s[28:31], s71 offen offset:2048  lds
    v_mfma_f32_16x16x32_bf16 v[60:63], a[192:195], a[76:79], v[60:63]
    s_waitcnt lgkmcnt(2)
    v_mfma_f32_16x16x32_bf16 v[92:95], a[200:203], a[76:79], v[92:95]
    ds_read_b128 a[216:219], v30 offset:45056
    v_mfma_f32_16x16x32_bf16 v[108:111], a[204:207], a[76:79], v[108:111]
    v_mfma_f32_16x16x32_bf16 v[104:107], a[204:207], a[72:75], v[104:107]
    v_mfma_f32_16x16x32_bf16 v[88:91], a[200:203], a[72:75], v[88:91]
    ds_read_b128 a[220:223], v30 offset:47104
    v_mfma_f32_16x16x32_bf16 v[84:87], a[200:203], a[68:71], v[84:87]
    buffer_load_dwordx4 v27, s[28:31], s71 offen offset:3072  lds
    v_mfma_f32_16x16x32_bf16 v[100:103], a[204:207], a[68:71], v[100:103]
    s_add_u32 s71, s71, 128
    v_mfma_f32_16x16x32_bf16 v[96:99], a[204:207], a[64:67], v[96:99]
    v_mfma_f32_16x16x32_bf16 v[80:83], a[200:203], a[64:67], v[80:83]
    s_waitcnt lgkmcnt(2)
    v_mfma_f32_16x16x32_bf16 v[112:115], a[208:211], a[64:67], v[112:115]
    ds_read_b128 a[192:195], v30 offset:49152
    v_mfma_f32_16x16x32_bf16 v[176:179], a[212:215], a[64:67], v[176:179]
    buffer_load_dwordx4 a[128:131], v2, s[16:19], s67 offen offset:0 sc1
    v_mfma_f32_16x16x32_bf16 v[180:183], a[212:215], a[68:71], v[180:183]
    v_mfma_f32_16x16x32_bf16 v[116:119], a[208:211], a[68:71], v[116:119]
    ds_read_b128 a[196:199], v30 offset:51200
    v_mfma_f32_16x16x32_bf16 v[120:123], a[208:211], a[72:75], v[120:123]
    v_mfma_f32_16x16x32_bf16 v[184:187], a[212:215], a[72:75], v[184:187]
    buffer_load_dwordx4 a[132:135], v2, s[16:19], s67 offen offset:1024 sc1
    v_mfma_f32_16x16x32_bf16 v[188:191], a[212:215], a[76:79], v[188:191]
    v_mfma_f32_16x16x32_bf16 v[124:127], a[208:211], a[76:79], v[124:127]
    s_waitcnt lgkmcnt(2)
    v_mfma_f32_16x16x32_bf16 v[204:207], a[216:219], a[76:79], v[204:207]
    ds_read_b128 a[200:203], v30 offset:53248
    v_mfma_f32_16x16x32_bf16 v[252:255], a[220:223], a[76:79], v[252:255]
    buffer_load_dwordx4 a[136:139], v2, s[16:19], s67 offen offset:2048 sc1
    v_mfma_f32_16x16x32_bf16 v[248:251], a[220:223], a[72:75], v[248:251]
    v_mfma_f32_16x16x32_bf16 v[200:203], a[216:219], a[72:75], v[200:203]
    ds_read_b128 a[204:207], v30 offset:55296
    v_mfma_f32_16x16x32_bf16 v[196:199], a[216:219], a[68:71], v[196:199]
    v_mfma_f32_16x16x32_bf16 v[244:247], a[220:223], a[68:71], v[244:247]
    buffer_load_dwordx4 a[140:143], v2, s[16:19], s67 offen offset:3072 sc1
    v_mfma_f32_16x16x32_bf16 v[240:243], a[220:223], a[64:67], v[240:243]
    s_add_u32 s67, s67, 4096
    v_mfma_f32_16x16x32_bf16 v[192:195], a[216:219], a[64:67], v[192:195]
    s_waitcnt vmcnt(20) lgkmcnt(2)
    v_mfma_f32_16x16x32_bf16 v[48:51], a[192:195], a[80:83], v[48:51]
    ds_read_b128 a[208:211], v30 offset:57344
    v_mfma_f32_16x16x32_bf16 v[64:67], a[196:199], a[80:83], v[64:67]
    buffer_load_dwordx4 a[144:147], v2, s[16:19], s67 offen offset:0 sc1
    v_mfma_f32_16x16x32_bf16 v[68:71], a[196:199], a[84:87], v[68:71]
    v_mfma_f32_16x16x32_bf16 v[52:55], a[192:195], a[84:87], v[52:55]
    ds_read_b128 a[212:215], v30 offset:59392
    v_mfma_f32_16x16x32_bf16 v[56:59], a[192:195], a[88:91], v[56:59]
    v_mfma_f32_16x16x32_bf16 v[72:75], a[196:199], a[88:91], v[72:75]
    buffer_load_dwordx4 a[148:151], v2, s[16:19], s67 offen offset:1024 sc1
    v_mfma_f32_16x16x32_bf16 v[76:79], a[196:199], a[92:95], v[76:79]
    v_mfma_f32_16x16x32_bf16 v[60:63], a[192:195], a[92:95], v[60:63]
    s_waitcnt lgkmcnt(2)
    v_mfma_f32_16x16x32_bf16 v[92:95], a[200:203], a[92:95], v[92:95]
    ds_read_b128 a[216:219], v30 offset:61440
    v_mfma_f32_16x16x32_bf16 v[108:111], a[204:207], a[92:95], v[108:111]
    buffer_load_dwordx4 a[152:155], v2, s[16:19], s67 offen offset:2048 sc1
    v_mfma_f32_16x16x32_bf16 v[104:107], a[204:207], a[88:91], v[104:107]
    v_mfma_f32_16x16x32_bf16 v[88:91], a[200:203], a[88:91], v[88:91]
    ds_read_b128 a[220:223], v30 offset:63488
    v_mfma_f32_16x16x32_bf16 v[84:87], a[200:203], a[84:87], v[84:87]
    v_mfma_f32_16x16x32_bf16 v[100:103], a[204:207], a[84:87], v[100:103]
    buffer_load_dwordx4 a[156:159], v2, s[16:19], s67 offen offset:3072 sc1
    v_mfma_f32_16x16x32_bf16 v[96:99], a[204:207], a[80:83], v[96:99]
    s_add_u32 s67, s67, 4096
    v_mfma_f32_16x16x32_bf16 v[80:83], a[200:203], a[80:83], v[80:83]
    s_waitcnt lgkmcnt(2)
    v_mfma_f32_16x16x32_bf16 v[112:115], a[208:211], a[80:83], v[112:115]
    ds_read_b128 a[192:195], v31 offset:32768
    v_mfma_f32_16x16x32_bf16 v[176:179], a[212:215], a[80:83], v[176:179]
    buffer_load_dwordx4 a[160:163], v2, s[16:19], s67 offen offset:0 sc1
    v_mfma_f32_16x16x32_bf16 v[180:183], a[212:215], a[84:87], v[180:183]
    v_mfma_f32_16x16x32_bf16 v[116:119], a[208:211], a[84:87], v[116:119]
    ds_read_b128 a[196:199], v31 offset:34816
    v_mfma_f32_16x16x32_bf16 v[120:123], a[208:211], a[88:91], v[120:123]
    v_mfma_f32_16x16x32_bf16 v[184:187], a[212:215], a[88:91], v[184:187]
    buffer_load_dwordx4 a[164:167], v2, s[16:19], s67 offen offset:1024 sc1
    v_mfma_f32_16x16x32_bf16 v[188:191], a[212:215], a[92:95], v[188:191]
    v_mfma_f32_16x16x32_bf16 v[124:127], a[208:211], a[92:95], v[124:127]
    s_waitcnt lgkmcnt(2)
    v_mfma_f32_16x16x32_bf16 v[204:207], a[216:219], a[92:95], v[204:207]
    ds_read_b128 a[200:203], v31 offset:36864
    v_mfma_f32_16x16x32_bf16 v[252:255], a[220:223], a[92:95], v[252:255]
    buffer_load_dwordx4 a[168:171], v2, s[16:19], s67 offen offset:2048 sc1
    v_mfma_f32_16x16x32_bf16 v[248:251], a[220:223], a[88:91], v[248:251]
    v_mfma_f32_16x16x32_bf16 v[200:203], a[216:219], a[88:91], v[200:203]
    ds_read_b128 a[204:207], v31 offset:38912
    v_mfma_f32_16x16x32_bf16 v[196:199], a[216:219], a[84:87], v[196:199]
    v_mfma_f32_16x16x32_bf16 v[244:247], a[220:223], a[84:87], v[244:247]
    buffer_load_dwordx4 a[172:175], v2, s[16:19], s67 offen offset:3072 sc1
    v_mfma_f32_16x16x32_bf16 v[240:243], a[220:223], a[80:83], v[240:243]
    s_add_u32 s67, s67, 4096
    v_mfma_f32_16x16x32_bf16 v[192:195], a[216:219], a[80:83], v[192:195]
    s_waitcnt vmcnt(24) lgkmcnt(2)
    v_mfma_f32_16x16x32_bf16 v[48:51], a[192:195], a[96:99], v[48:51]
    ds_read_b128 a[208:211], v31 offset:40960
    v_mfma_f32_16x16x32_bf16 v[64:67], a[196:199], a[96:99], v[64:67]
    buffer_load_dwordx4 a[176:179], v2, s[16:19], s67 offen offset:0 sc1
    v_mfma_f32_16x16x32_bf16 v[68:71], a[196:199], a[100:103], v[68:71]
    v_mfma_f32_16x16x32_bf16 v[52:55], a[192:195], a[100:103], v[52:55]
    ds_read_b128 a[212:215], v31 offset:43008
    v_mfma_f32_16x16x32_bf16 v[56:59], a[192:195], a[104:107], v[56:59]
    v_mfma_f32_16x16x32_bf16 v[72:75], a[196:199], a[104:107], v[72:75]
    v_mfma_f32_16x16x32_bf16 v[76:79], a[196:199], a[108:111], v[76:79]
    buffer_load_dwordx4 a[180:183], v2, s[16:19], s67 offen offset:1024 sc1
    v_mfma_f32_16x16x32_bf16 v[60:63], a[192:195], a[108:111], v[60:63]
    s_waitcnt lgkmcnt(2)
    v_mfma_f32_16x16x32_bf16 v[92:95], a[200:203], a[108:111], v[92:95]
    ds_read_b128 a[216:219], v31 offset:45056
    v_mfma_f32_16x16x32_bf16 v[108:111], a[204:207], a[108:111], v[108:111]
    v_mfma_f32_16x16x32_bf16 v[104:107], a[204:207], a[104:107], v[104:107]
    v_mfma_f32_16x16x32_bf16 v[88:91], a[200:203], a[104:107], v[88:91]
    ds_read_b128 a[220:223], v31 offset:47104
    v_mfma_f32_16x16x32_bf16 v[84:87], a[200:203], a[100:103], v[84:87]
    buffer_load_dwordx4 a[184:187], v2, s[16:19], s67 offen offset:2048 sc1
    v_mfma_f32_16x16x32_bf16 v[100:103], a[204:207], a[100:103], v[100:103]
    v_mfma_f32_16x16x32_bf16 v[96:99], a[204:207], a[96:99], v[96:99]
    v_mfma_f32_16x16x32_bf16 v[80:83], a[200:203], a[96:99], v[80:83]
    s_waitcnt lgkmcnt(2)
    v_mfma_f32_16x16x32_bf16 v[112:115], a[208:211], a[96:99], v[112:115]
    ds_read_b128 a[192:195], v31 offset:49152
    v_mfma_f32_16x16x32_bf16 v[176:179], a[212:215], a[96:99], v[176:179]
    buffer_load_dwordx4 a[188:191], v2, s[16:19], s67 offen offset:3072 sc1
    v_mfma_f32_16x16x32_bf16 v[180:183], a[212:215], a[100:103], v[180:183]
    s_add_u32 s67, s67, 4096
    v_mfma_f32_16x16x32_bf16 v[116:119], a[208:211], a[100:103], v[116:119]
    ds_read_b128 a[196:199], v31 offset:51200
    v_mfma_f32_16x16x32_bf16 v[120:123], a[208:211], a[104:107], v[120:123]
    v_mfma_f32_16x16x32_bf16 v[184:187], a[212:215], a[104:107], v[184:187]
    s_add_u32 m0, s60, 32768
    v_mfma_f32_16x16x32_bf16 v[188:191], a[212:215], a[108:111], v[188:191]
    buffer_load_dwordx4 v20, s[28:31], s71 offen offset:0  lds
    v_mfma_f32_16x16x32_bf16 v[124:127], a[208:211], a[108:111], v[124:127]
    s_waitcnt lgkmcnt(2)
    v_mfma_f32_16x16x32_bf16 v[204:207], a[216:219], a[108:111], v[204:207]
    ds_read_b128 a[200:203], v31 offset:53248
    v_mfma_f32_16x16x32_bf16 v[252:255], a[220:223], a[108:111], v[252:255]
    v_mfma_f32_16x16x32_bf16 v[248:251], a[220:223], a[104:107], v[248:251]
    buffer_load_dwordx4 v21, s[28:31], s71 offen offset:1024  lds
    v_mfma_f32_16x16x32_bf16 v[200:203], a[216:219], a[104:107], v[200:203]
    ds_read_b128 a[204:207], v31 offset:55296
    v_mfma_f32_16x16x32_bf16 v[196:199], a[216:219], a[100:103], v[196:199]
    v_mfma_f32_16x16x32_bf16 v[244:247], a[220:223], a[100:103], v[244:247]
    v_mfma_f32_16x16x32_bf16 v[240:243], a[220:223], a[96:99], v[240:243]
    buffer_load_dwordx4 v22, s[28:31], s71 offen offset:2048  lds
    v_mfma_f32_16x16x32_bf16 v[192:195], a[216:219], a[96:99], v[192:195]
LF_pad12:
    s_cbranch_execz LF_walked
    s_waitcnt vmcnt(27) lgkmcnt(2)
    v_mfma_f32_16x16x32_bf16 v[48:51], a[192:195], a[112:115], v[48:51]
    ds_read_b128 a[208:211], v31 offset:57344
    v_mfma_f32_16x16x32_bf16 v[64:67], a[196:199], a[112:115], v[64:67]
    v_mfma_f32_16x16x32_bf16 v[68:71], a[196:199], a[116:119], v[68:71]
    buffer_load_dwordx4 v23, s[28:31], s71 offen offset:3072  lds
    v_mfma_f32_16x16x32_bf16 v[52:55], a[192:195], a[116:119], v[52:55]
    ds_read_b128 a[212:215], v31 offset:59392
    v_mfma_f32_16x16x32_bf16 v[56:59], a[192:195], a[120:123], v[56:59]
    v_mfma_f32_16x16x32_bf16 v[72:75], a[196:199], a[120:123], v[72:75]
    s_add_u32 m0, s60, 36864
    v_mfma_f32_16x16x32_bf16 v[76:79], a[196:199], a[124:127], v[76:79]
    buffer_load_dwordx4 v24, s[28:31], s71 offen offset:0  lds
    v_mfma_f32_16x16x32_bf16 v[60:63], a[192:195], a[124:127], v[60:63]
    s_waitcnt lgkmcnt(2)
    v_mfma_f32_16x16x32_bf16 v[92:95], a[200:203], a[124:127], v[92:95]
    ds_read_b128 a[216:219], v31 offset:61440
    v_mfma_f32_16x16x32_bf16 v[108:111], a[204:207], a[124:127], v[108:111]
    v_mfma_f32_16x16x32_bf16 v[104:107], a[204:207], a[120:123], v[104:107]
    buffer_load_dwordx4 v25, s[28:31], s71 offen offset:1024  lds
    v_mfma_f32_16x16x32_bf16 v[88:91], a[200:203], a[120:123], v[88:91]
    ds_read_b128 a[220:223], v31 offset:63488
    v_mfma_f32_16x16x32_bf16 v[84:87], a[200:203], a[116:119], v[84:87]
    v_mfma_f32_16x16x32_bf16 v[100:103], a[204:207], a[116:119], v[100:103]
    v_mfma_f32_16x16x32_bf16 v[96:99], a[204:207], a[112:115], v[96:99]
    buffer_load_dwordx4 v26, s[28:31], s71 offen offset:2048  lds
    v_mfma_f32_16x16x32_bf16 v[80:83], a[200:203], a[112:115], v[80:83]
    s_waitcnt vmcnt(23) lgkmcnt(2)
    s_barrier
    v_mfma_f32_16x16x32_bf16 v[112:115], a[208:211], a[112:115], v[112:115]
    ds_read_b128 a[192:195], v28 offset:4096
    v_mfma_f32_16x16x32_bf16 v[176:179], a[212:215], a[112:115], v[176:179]
    v_mfma_f32_16x16x32_bf16 v[180:183], a[212:215], a[116:119], v[180:183]
    buffer_load_dwordx4 v27, s[28:31], s71 offen offset:3072  lds
    v_mfma_f32_16x16x32_bf16 v[116:119], a[208:211], a[116:119], v[116:119]
    s_add_u32 s71, s71, 128
    ds_read_b128 a[196:199], v28 offset:6144
    v_mfma_f32_16x16x32_bf16 v[120:123], a[208:211], a[120:123], v[120:123]
    v_mfma_f32_16x16x32_bf16 v[184:187], a[212:215], a[120:123], v[184:187]
    v_mfma_f32_16x16x32_bf16 v[188:191], a[212:215], a[124:127], v[188:191]
    buffer_load_dwordx4 a[0:3], v2, s[16:19], s67 offen offset:0 sc1
    v_mfma_f32_16x16x32_bf16 v[124:127], a[208:211], a[124:127], v[124:127]
    s_waitcnt lgkmcnt(2)
    v_mfma_f32_16x16x32_bf16 v[204:207], a[216:219], a[124:127], v[204:207]
    ds_read_b128 a[200:203], v28 offset:8192
    v_mfma_f32_16x16x32_bf16 v[252:255], a[220:223], a[124:127], v[252:255]
    v_mfma_f32_16x16x32_bf16 v[248:251], a[220:223], a[120:123], v[248:251]
    buffer_load_dwordx4 a[4:7], v2, s[16:19], s67 offen offset:1024 sc1
    v_mfma_f32_16x16x32_bf16 v[200:203], a[216:219], a[120:123], v[200:203]
    ds_read_b128 a[204:207], v28 offset:10240
    v_mfma_f32_16x16x32_bf16 v[196:199], a[216:219], a[116:119], v[196:199]
    v_mfma_f32_16x16x32_bf16 v[244:247], a[220:223], a[116:119], v[244:247]
    v_mfma_f32_16x16x32_bf16 v[240:243], a[220:223], a[112:115], v[240:243]
    buffer_load_dwordx4 a[8:11], v2, s[16:19], s67 offen offset:2048 sc1
    v_mfma_f32_16x16x32_bf16 v[192:195], a[216:219], a[112:115], v[192:195]
    s_waitcnt vmcnt(23) lgkmcnt(2)
    v_mfma_f32_16x16x32_bf16 v[80:83], a[192:195], a[128:131], v[80:83]
    ds_read_b128 a[208:211], v28 offset:12288
    v_mfma_f32_16x16x32_bf16 v[96:99], a[196:199], a[128:131], v[96:99]
    v_mfma_f32_16x16x32_bf16 v[100:103], a[196:199], a[132:135], v[100:103]
    buffer_load_dwordx4 a[12:15], v2, s[16:19], s67 offen offset:3072 sc1
    v_mfma_f32_16x16x32_bf16 v[84:87], a[192:195], a[132:135], v[84:87]
    s_add_u32 s67, s67, 4096
    ds_read_b128 a[212:215], v28 offset:14336
    v_mfma_f32_16x16x32_bf16 v[88:91], a[192:195], a[136:139], v[88:91]
    v_mfma_f32_16x16x32_bf16 v[104:107], a[196:199], a[136:139], v[104:107]
    v_mfma_f32_16x16x32_bf16 v[108:111], a[196:199], a[140:143], v[108:111]
    buffer_load_dwordx4 a[16:19], v2, s[16:19], s67 offen offset:0 sc1
    v_mfma_f32_16x16x32_bf16 v[92:95], a[192:195], a[140:143], v[92:95]
    s_waitcnt lgkmcnt(2)
    v_mfma_f32_16x16x32_bf16 v[124:127], a[200:203], a[140:143], v[124:127]
    ds_read_b128 a[216:219], v28 offset:20480
    v_mfma_f32_16x16x32_bf16 v[188:191], a[204:207], a[140:143], v[188:191]
    v_mfma_f32_16x16x32_bf16 v[184:187], a[204:207], a[136:139], v[184:187]
    buffer_load_dwordx4 a[20:23], v2, s[16:19], s67 offen offset:1024 sc1
    v_mfma_f32_16x16x32_bf16 v[120:123], a[200:203], a[136:139], v[120:123]
    ds_read_b128 a[220:223], v28 offset:22528
    v_mfma_f32_16x16x32_bf16 v[116:119], a[200:203], a[132:135], v[116:119]
    v_mfma_f32_16x16x32_bf16 v[180:183], a[204:207], a[132:135], v[180:183]
    v_mfma_f32_16x16x32_bf16 v[176:179], a[204:207], a[128:131], v[176:179]
    buffer_load_dwordx4 a[24:27], v2, s[16:19], s67 offen offset:2048 sc1
    v_mfma_f32_16x16x32_bf16 v[112:115], a[200:203], a[128:131], v[112:115]
    s_waitcnt lgkmcnt(2)
    v_mfma_f32_16x16x32_bf16 v[192:195], a[208:211], a[128:131], v[192:195]
    ds_read_b128 a[192:195], v28 offset:24576
    v_mfma_f32_16x16x32_bf16 v[240:243], a[212:215], a[128:131], v[240:243]
    v_mfma_f32_16x16x32_bf16 v[244:247], a[212:215], a[132:135], v[244:247]
    buffer_load_dwordx4 a[28:31], v2, s[16:19], s67 offen offset:3072 sc1
    v_mfma_f32_16x16x32_bf16 v[196:199], a[208:211], a[132:135], v[196:199]
    s_add_u32 s67, s67, 4096
    ds_read_b128 a[196:199], v28 offset:26624
    v_mfma_f32_16x16x32_bf16 v[200:203], a[208:211], a[136:139], v[200:203]
    v_mfma_f32_16x16x32_bf16 v[248:251], a[212:215], a[136:139], v[248:251]
    v_mfma_f32_16x16x32_bf16 v[252:255], a[212:215], a[140:143], v[252:255]
    buffer_load_dwordx4 a[32:35], v2, s[16:19], s67 offen offset:0 sc1
    v_mfma_f32_16x16x32_bf16 v[204:207], a[208:211], a[140:143], v[204:207]
    s_waitcnt vmcnt(25) lgkmcnt(2)
    v_mfma_f32_16x16x32_bf16 v[92:95], a[216:219], a[156:159], v[92:95]
    ds_read_b128 a[200:203], v28 offset:28672
    v_mfma_f32_16x16x32_bf16 v[108:111], a[220:223], a[156:159], v[108:111]
    v_mfma_f32_16x16x32_bf16 v[104:107], a[220:223], a[152:155], v[104:107]
    buffer_load_dwordx4 a[36:39], v2, s[16:19], s67 offen offset:1024 sc1
    v_mfma_f32_16x16x32_bf16 v[88:91], a[216:219], a[152:155], v[88:91]
    ds_read_b128 a[204:207], v28 offset:30720
    v_mfma_f32_16x16x32_bf16 v[84:87], a[216:219], a[148:151], v[84:87]
    v_mfma_f32_16x16x32_bf16 v[100:103], a[220:223], a[148:151], v[100:103]
    v_mfma_f32_16x16x32_bf16 v[96:99], a[220:223], a[144:147], v[96:99]
    buffer_load_dwordx4 a[40:43], v2, s[16:19], s67 offen offset:2048 sc1
    v_mfma_f32_16x16x32_bf16 v[80:83], a[216:219], a[144:147], v[80:83]
    s_waitcnt lgkmcnt(2)
    v_mfma_f32_16x16x32_bf16 v[112:115], a[192:195], a[144:147], v[112:115]
    ds_read_b128 a[208:211], v29 offset:4096
    v_mfma_f32_16x16x32_bf16 v[176:179], a[196:199], a[144:147], v[176:179]
    v_mfma_f32_16x16x32_bf16 v[180:183], a[196:199], a[148:151], v[180:183]
    buffer_load_dwordx4 a[44:47], v2, s[16:19], s67 offen offset:3072 sc1
    v_mfma_f32_16x16x32_bf16 v[116:119], a[192:195], a[148:151], v[116:119]
    s_add_u32 s67, s67, 4096
    ds_read_b128 a[212:215], v29 offset:6144
    v_mfma_f32_16x16x32_bf16 v[120:123], a[192:195], a[152:155], v[120:123]
    v_mfma_f32_16x16x32_bf16 v[184:187], a[196:199], a[152:155], v[184:187]
    s_add_u32 m0, s60, 65536
    v_mfma_f32_16x16x32_bf16 v[188:191], a[196:199], a[156:159], v[188:191]
    buffer_load_dwordx4 v20, s[28:31], s71 offen offset:0  lds
    v_mfma_f32_16x16x32_bf16 v[124:127], a[192:195], a[156:159], v[124:127]
    s_waitcnt lgkmcnt(2)
    v_mfma_f32_16x16x32_bf16 v[204:207], a[200:203], a[156:159], v[204:207]
    ds_read_b128 a[216:219], v29 offset:8192
    v_mfma_f32_16x16x32_bf16 v[252:255], a[204:207], a[156:159], v[252:255]
    buffer_load_dwordx4 v21, s[28:31], s71 offen offset:1024  lds
    v_mfma_f32_16x16x32_bf16 v[248:251], a[204:207], a[152:155], v[248:251]
    v_mfma_f32_16x16x32_bf16 v[200:203], a[200:203], a[152:155], v[200:203]
    ds_read_b128 a[220:223], v29 offset:10240
    v_mfma_f32_16x16x32_bf16 v[196:199], a[200:203], a[148:151], v[196:199]
    buffer_load_dwordx4 v22, s[28:31], s71 offen offset:2048  lds
    v_mfma_f32_16x16x32_bf16 v[244:247], a[204:207], a[148:151], v[244:247]
    v_mfma_f32_16x16x32_bf16 v[240:243], a[204:207], a[144:147], v[240:243]
    buffer_load_dwordx4 v23, s[28:31], s71 offen offset:3072  lds
    v_mfma_f32_16x16x32_bf16 v[192:195], a[200:203], a[144:147], v[192:195]
    s_waitcnt vmcnt(28) lgkmcnt(2)
    v_mfma_f32_16x16x32_bf16 v[80:83], a[208:211], a[160:163], v[80:83]
    s_add_u32 m0, s60, 69632
    ds_read_b128 a[192:195], v29 offset:12288
    v_mfma_f32_16x16x32_bf16 v[96:99], a[212:215], a[160:163], v[96:99]
    buffer_load_dwordx4 v24, s[28:31], s71 offen offset:0  lds
    v_mfma_f32_16x16x32_bf16 v[100:103], a[212:215], a[164:167], v[100:103]
    v_mfma_f32_16x16x32_bf16 v[84:87], a[208:211], a[164:167], v[84:87]
    ds_read_b128 a[196:199], v29 offset:14336
    v_mfma_f32_16x16x32_bf16 v[88:91], a[208:211], a[168:171], v[88:91]
    buffer_load_dwordx4 v25, s[28:31], s71 offen offset:1024  lds
    v_mfma_f32_16x16x32_bf16 v[104:107], a[212:215], a[168:171], v[104:107]
    v_mfma_f32_16x16x32_bf16 v[108:111], a[212:215], a[172:175], v[108:111]
    buffer_load_dwordx4 v26, s[28:31], s71 offen offset:2048  lds
    v_mfma_f32_16x16x32_bf16 v[92:95], a[208:211], a[172:175], v[92:95]
    s_waitcnt lgkmcnt(2)
    v_mfma_f32_16x16x32_bf16 v[124:127], a[216:219], a[172:175], v[124:127]
    ds_read_b128 a[200:203], v29 offset:20480
    v_mfma_f32_16x16x32_bf16 v[188:191], a[220:223], a[172:175], v[188:191]
    buffer_load_dwordx4 v27, s[28:31], s71 offen offset:3072  lds
    v_mfma_f32_16x16x32_bf16 v[184:187], a[220:223], a[168:171], v[184:187]
    s_add_u32 s71, s71, 128
    v_mfma_f32_16x16x32_bf16 v[120:123], a[216:219], a[168:171], v[120:123]
    ds_read_b128 a[204:207], v29 offset:22528
    v_mfma_f32_16x16x32_bf16 v[116:119], a[216:219], a[164:167], v[116:119]
    buffer_load_dwordx4 a[48:51], v2, s[16:19], s67 offen offset:0 sc1
    v_mfma_f32_16x16x32_bf16 v[180:183], a[220:223], a[164:167], v[180:183]
    v_mfma_f32_16x16x32_bf16 v[176:179], a[220:223], a[160:163], v[176:179]
    buffer_load_dwordx4 a[52:55], v2, s[16:19], s67 offen offset:1024 sc1
    v_mfma_f32_16x16x32_bf16 v[112:115], a[216:219], a[160:163], v[112:115]
    s_waitcnt lgkmcnt(2)
    v_mfma_f32_16x16x32_bf16 v[192:195], a[192:195], a[160:163], v[192:195]
    ds_read_b128 a[208:211], v29 offset:24576
    v_mfma_f32_16x16x32_bf16 v[240:243], a[196:199], a[160:163], v[240:243]
    buffer_load_dwordx4 a[56:59], v2, s[16:19], s67 offen offset:2048 sc1
    v_mfma_f32_16x16x32_bf16 v[244:247], a[196:199], a[164:167], v[244:247]
    v_mfma_f32_16x16x32_bf16 v[196:199], a[192:195], a[164:167], v[196:199]
    ds_read_b128 a[212:215], v29 offset:26624
    v_mfma_f32_16x16x32_bf16 v[200:203], a[192:195], a[168:171], v[200:203]
    buffer_load_dwordx4 a[60:63], v2, s[16:19], s67 offen offset:3072 sc1
    v_mfma_f32_16x16x32_bf16 v[248:251], a[196:199], a[168:171], v[248:251]
    s_add_u32 s67, s67, 4096
    v_mfma_f32_16x16x32_bf16 v[252:255], a[196:199], a[172:175], v[252:255]
    buffer_load_dwordx4 a[64:67], v2, s[16:19], s67 offen offset:0 sc1
    v_mfma_f32_16x16x32_bf16 v[204:207], a[192:195], a[172:175], v[204:207]
    s_waitcnt vmcnt(33) lgkmcnt(2)
    v_mfma_f32_16x16x32_bf16 v[92:95], a[200:203], a[188:191], v[92:95]
    ds_read_b128 a[216:219], v29 offset:28672
    v_mfma_f32_16x16x32_bf16 v[108:111], a[204:207], a[188:191], v[108:111]
    buffer_load_dwordx4 a[68:71], v2, s[16:19], s67 offen offset:1024 sc1
    v_mfma_f32_16x16x32_bf16 v[104:107], a[204:207], a[184:187], v[104:107]
    v_mfma_f32_16x16x32_bf16 v[88:91], a[200:203], a[184:187], v[88:91]
    ds_read_b128 a[220:223], v29 offset:30720
    v_mfma_f32_16x16x32_bf16 v[84:87], a[200:203], a[180:183], v[84:87]
    buffer_load_dwordx4 a[72:75], v2, s[16:19], s67 offen offset:2048 sc1
    v_mfma_f32_16x16x32_bf16 v[100:103], a[204:207], a[180:183], v[100:103]
    v_mfma_f32_16x16x32_bf16 v[96:99], a[204:207], a[176:179], v[96:99]
    buffer_load_dwordx4 a[76:79], v2, s[16:19], s67 offen offset:3072 sc1
    v_mfma_f32_16x16x32_bf16 v[80:83], a[200:203], a[176:179], v[80:83]
    s_add_u32 s67, s67, 4096
    s_waitcnt vmcnt(28) lgkmcnt(2)
    s_barrier
    v_mfma_f32_16x16x32_bf16 v[112:115], a[208:211], a[176:179], v[112:115]
    ds_read_b128 a[192:195], v28 offset:36864
    v_mfma_f32_16x16x32_bf16 v[176:179], a[212:215], a[176:179], v[176:179]
    buffer_load_dwordx4 a[80:83], v2, s[16:19], s67 offen offset:0 sc1
    v_mfma_f32_16x16x32_bf16 v[180:183], a[212:215], a[180:183], v[180:183]
    v_mfma_f32_16x16x32_bf16 v[116:119], a[208:211], a[180:183], v[116:119]
    ds_read_b128 a[196:199], v28 offset:38912
    v_mfma_f32_16x16x32_bf16 v[120:123], a[208:211], a[184:187], v[120:123]
    buffer_load_dwordx4 a[84:87], v2, s[16:19], s67 offen offset:1024 sc1
    v_mfma_f32_16x16x32_bf16 v[184:187], a[212:215], a[184:187], v[184:187]
    v_mfma_f32_16x16x32_bf16 v[188:191], a[212:215], a[188:191], v[188:191]
    buffer_load_dwordx4 a[88:91], v2, s[16:19], s67 offen offset:2048 sc1
    v_mfma_f32_16x16x32_bf16 v[124:127], a[208:211], a[188:191], v[124:127]
    s_waitcnt lgkmcnt(2)
    v_mfma_f32_16x16x32_bf16 v[204:207], a[216:219], a[188:191], v[204:207]
    ds_read_b128 a[200:203], v28 offset:53248
    v_mfma_f32_16x16x32_bf16 v[252:255], a[220:223], a[188:191], v[252:255]
    buffer_load_dwordx4 a[92:95], v2, s[16:19], s67 offen offset:3072 sc1
    v_mfma_f32_16x16x32_bf16 v[248:251], a[220:223], a[184:187], v[248:251]
    s_add_u32 s67, s67, 4096
    v_mfma_f32_16x16x32_bf16 v[200:203], a[216:219], a[184:187], v[200:203]
    ds_read_b128 a[204:207], v28 offset:55296
    v_mfma_f32_16x16x32_bf16 v[196:199], a[216:219], a[180:183], v[196:199]
    buffer_load_dwordx4 a[96:99], v2, s[16:19], s67 offen offset:0 sc1
    v_mfma_f32_16x16x32_bf16 v[244:247], a[220:223], a[180:183], v[244:247]
    v_mfma_f32_16x16x32_bf16 v[240:243], a[220:223], a[176:179], v[240:243]
    buffer_load_dwordx4 a[100:103], v2, s[16:19], s67 offen offset:1024 sc1
    v_mfma_f32_16x16x32_bf16 v[192:195], a[216:219], a[176:179], v[192:195]
    s_waitcnt vmcnt(30) lgkmcnt(2)
    v_mfma_f32_16x16x32_bf16 v[80:83], a[192:195], a[0:3], v[80:83]
    ds_read_b128 a[208:211], v29 offset:36864
    v_mfma_f32_16x16x32_bf16 v[96:99], a[196:199], a[0:3], v[96:99]
    buffer_load_dwordx4 a[104:107], v2, s[16:19], s67 offen offset:2048 sc1
    v_mfma_f32_16x16x32_bf16 v[100:103], a[196:199], a[4:7], v[100:103]
    v_mfma_f32_16x16x32_bf16 v[84:87], a[192:195], a[4:7], v[84:87]
    ds_read_b128 a[212:215], v29 offset:38912
    v_mfma_f32_16x16x32_bf16 v[88:91], a[192:195], a[8:11], v[88:91]
    buffer_load_dwordx4 a[108:111], v2, s[16:19], s67 offen offset:3072 sc1
    v_mfma_f32_16x16x32_bf16 v[104:107], a[196:199], a[8:11], v[104:107]
    s_add_u32 s67, s67, 4096
    v_mfma_f32_16x16x32_bf16 v[108:111], a[196:199], a[12:15], v[108:111]
    buffer_load_dwordx4 a[112:115], v2, s[16:19], s67 offen offset:0 sc1
    v_mfma_f32_16x16x32_bf16 v[92:95], a[192:195], a[12:15], v[92:95]
    s_waitcnt vmcnt(29) lgkmcnt(2)
    v_mfma_f32_16x16x32_bf16 v[92:95], a[200:203], a[28:31], v[92:95]
    ds_read_b128 a[216:219], v29 offset:53248
    v_mfma_f32_16x16x32_bf16 v[108:111], a[204:207], a[28:31], v[108:111]
    buffer_load_dwordx4 a[116:119], v2, s[16:19], s67 offen offset:1024 sc1
    v_mfma_f32_16x16x32_bf16 v[104:107], a[204:207], a[24:27], v[104:107]
    v_mfma_f32_16x16x32_bf16 v[88:91], a[200:203], a[24:27], v[88:91]
    ds_read_b128 a[220:223], v29 offset:55296
    v_mfma_f32_16x16x32_bf16 v[84:87], a[200:203], a[20:23], v[84:87]
    buffer_load_dwordx4 a[120:123], v2, s[16:19], s67 offen offset:2048 sc1
    v_mfma_f32_16x16x32_bf16 v[100:103], a[204:207], a[20:23], v[100:103]
    v_mfma_f32_16x16x32_bf16 v[96:99], a[204:207], a[16:19], v[96:99]
    buffer_load_dwordx4 a[124:127], v2, s[16:19], s67 offen offset:3072 sc1
    v_mfma_f32_16x16x32_bf16 v[80:83], a[200:203], a[16:19], v[80:83]
    s_add_u32 s67, s67, 4096
    s_waitcnt vmcnt(20) lgkmcnt(2)
    s_barrier
    v_mfma_f32_16x16x32_bf16 v[80:83], a[208:211], a[32:35], v[80:83]
    ds_read_b128 a[192:195], v30 offset:4096
    v_mfma_f32_16x16x32_bf16 v[96:99], a[212:215], a[32:35], v[96:99]
    v_mfma_f32_16x16x32_bf16 v[100:103], a[212:215], a[36:39], v[100:103]
    v_mfma_f32_16x16x32_bf16 v[84:87], a[208:211], a[36:39], v[84:87]
    ds_read_b128 a[196:199], v30 offset:6144
    v_mfma_f32_16x16x32_bf16 v[88:91], a[208:211], a[40:43], v[88:91]
    v_mfma_f32_16x16x32_bf16 v[104:107], a[212:215], a[40:43], v[104:107]
    v_mfma_f32_16x16x32_bf16 v[108:111], a[212:215], a[44:47], v[108:111]
    v_mfma_f32_16x16x32_bf16 v[92:95], a[208:211], a[44:47], v[92:95]
    s_waitcnt vmcnt(16) lgkmcnt(2)
    v_mfma_f32_16x16x32_bf16 v[92:95], a[216:219], a[60:63], v[92:95]
    ds_read_b128 a[200:203], v30 offset:20480
    v_mfma_f32_16x16x32_bf16 v[108:111], a[220:223], a[60:63], v[108:111]
    v_mfma_f32_16x16x32_bf16 v[104:107], a[220:223], a[56:59], v[104:107]
    v_mfma_f32_16x16x32_bf16 v[88:91], a[216:219], a[56:59], v[88:91]
    ds_read_b128 a[204:207], v30 offset:22528
    v_mfma_f32_16x16x32_bf16 v[84:87], a[216:219], a[52:55], v[84:87]
    v_mfma_f32_16x16x32_bf16 v[100:103], a[220:223], a[52:55], v[100:103]
    v_mfma_f32_16x16x32_bf16 v[96:99], a[220:223], a[48:51], v[96:99]
    v_mfma_f32_16x16x32_bf16 v[80:83], a[216:219], a[48:51], v[80:83]
    s_waitcnt vmcnt(12) lgkmcnt(2)
    v_mfma_f32_16x16x32_bf16 v[80:83], a[192:195], a[64:67], v[80:83]
    ds_read_b128 a[208:211], v31 offset:4096
    v_mfma_f32_16x16x32_bf16 v[96:99], a[196:199], a[64:67], v[96:99]
    v_mfma_f32_16x16x32_bf16 v[100:103], a[196:199], a[68:71], v[100:103]
    v_mfma_f32_16x16x32_bf16 v[84:87], a[192:195], a[68:71], v[84:87]
    ds_read_b128 a[212:215], v31 offset:6144
    v_mfma_f32_16x16x32_bf16 v[88:91], a[192:195], a[72:75], v[88:91]
    v_mfma_f32_16x16x32_bf16 v[104:107], a[196:199], a[72:75], v[104:107]
    v_mfma_f32_16x16x32_bf16 v[108:111], a[196:199], a[76:79], v[108:111]
    v_mfma_f32_16x16x32_bf16 v[92:95], a[192:195], a[76:79], v[92:95]
    s_waitcnt vmcnt(8) lgkmcnt(2)
    v_mfma_f32_16x16x32_bf16 v[92:95], a[200:203], a[92:95], v[92:95]
    ds_read_b128 a[216:219], v31 offset:20480
    v_mfma_f32_16x16x32_bf16 v[108:111], a[204:207], a[92:95], v[108:111]
    v_mfma_f32_16x16x32_bf16 v[104:107], a[204:207], a[88:91], v[104:107]
    v_mfma_f32_16x16x32_bf16 v[88:91], a[200:203], a[88:91], v[88:91]
    ds_read_b128 a[220:223], v31 offset:22528
    v_mfma_f32_16x16x32_bf16 v[84:87], a[200:203], a[84:87], v[84:87]
    v_mfma_f32_16x16x32_bf16 v[100:103], a[204:207], a[84:87], v[100:103]
    v_mfma_f32_16x16x32_bf16 v[96:99], a[204:207], a[80:83], v[96:99]
    v_mfma_f32_16x16x32_bf16 v[80:83], a[200:203], a[80:83], v[80:83]
    s_waitcnt vmcnt(4) lgkmcnt(2)
    v_mfma_f32_16x16x32_bf16 v[80:83], a[208:211], a[96:99], v[80:83]
    ds_read_b128 a[192:195], v28 offset:40960
    v_mfma_f32_16x16x32_bf16 v[96:99], a[212:215], a[96:99], v[96:99]
    v_mfma_f32_16x16x32_bf16 v[100:103], a[212:215], a[100:103], v[100:103]
    v_mfma_f32_16x16x32_bf16 v[84:87], a[208:211], a[100:103], v[84:87]
    ds_read_b128 a[196:199], v28 offset:43008
    v_mfma_f32_16x16x32_bf16 v[88:91], a[208:211], a[104:107], v[88:91]
    v_mfma_f32_16x16x32_bf16 v[104:107], a[212:215], a[104:107], v[104:107]
    v_mfma_f32_16x16x32_bf16 v[108:111], a[212:215], a[108:111], v[108:111]
    v_mfma_f32_16x16x32_bf16 v[92:95], a[208:211], a[108:111], v[92:95]
    s_waitcnt vmcnt(0) lgkmcnt(2)
    v_mfma_f32_16x16x32_bf16 v[92:95], a[216:219], a[124:127], v[92:95]
    ds_read_b128 a[200:203], v28 offset:57344
    v_mfma_f32_16x16x32_bf16 v[108:111], a[220:223], a[124:127], v[108:111]
    v_mfma_f32_16x16x32_bf16 v[104:107], a[220:223], a[120:123], v[104:107]
    v_mfma_f32_16x16x32_bf16 v[88:91], a[216:219], a[120:123], v[88:91]
    ds_read_b128 a[204:207], v28 offset:59392
    v_mfma_f32_16x16x32_bf16 v[84:87], a[216:219], a[116:119], v[84:87]
    v_mfma_f32_16x16x32_bf16 v[100:103], a[220:223], a[116:119], v[100:103]
    v_mfma_f32_16x16x32_bf16 v[96:99], a[220:223], a[112:115], v[96:99]
    v_mfma_f32_16x16x32_bf16 v[80:83], a[216:219], a[112:115], v[80:83]
    s_waitcnt lgkmcnt(2)
    v_mfma_f32_16x16x32_bf16 v[112:115], a[192:195], a[0:3], v[112:115]
    ds_read_b128 a[208:211], v29 offset:40960
    v_mfma_f32_16x16x32_bf16 v[176:179], a[196:199], a[0:3], v[176:179]
    v_mfma_f32_16x16x32_bf16 v[180:183], a[196:199], a[4:7], v[180:183]
    v_mfma_f32_16x16x32_bf16 v[116:119], a[192:195], a[4:7], v[116:119]
    ds_read_b128 a[212:215], v29 offset:43008
    v_mfma_f32_16x16x32_bf16 v[120:123], a[192:195], a[8:11], v[120:123]
    v_mfma_f32_16x16x32_bf16 v[184:187], a[196:199], a[8:11], v[184:187]
    v_mfma_f32_16x16x32_bf16 v[188:191], a[196:199], a[12:15], v[188:191]
    v_cvt_pk_bf16_f32 v80, v80, v81
    v_cvt_pk_bf16_f32 v81, v82, v83
    v_mfma_f32_16x16x32_bf16 v[124:127], a[192:195], a[12:15], v[124:127]
    s_waitcnt lgkmcnt(2)
    v_cvt_pk_bf16_f32 v82, v96, v97
    v_cvt_pk_bf16_f32 v83, v98, v99
    v_mfma_f32_16x16x32_bf16 v[124:127], a[200:203], a[28:31], v[124:127]
    ds_read_b128 a[216:219], v29 offset:57344
    v_mfma_f32_16x16x32_bf16 v[188:191], a[204:207], a[28:31], v[188:191]
    buffer_store_dwordx4 v[80:83], v2, s[32:35], s81 offen offset:0 sc1
    v_mfma_f32_16x16x32_bf16 v[184:187], a[204:207], a[24:27], v[184:187]
    v_cvt_pk_bf16_f32 v84, v84, v85
    v_cvt_pk_bf16_f32 v85, v86, v87
    v_mfma_f32_16x16x32_bf16 v[120:123], a[200:203], a[24:27], v[120:123]
    ds_read_b128 a[220:223], v29 offset:59392
    v_cvt_pk_bf16_f32 v86, v100, v101
    v_mfma_f32_16x16x32_bf16 v[116:119], a[200:203], a[20:23], v[116:119]
    v_cvt_pk_bf16_f32 v87, v102, v103
    v_mfma_f32_16x16x32_bf16 v[180:183], a[204:207], a[20:23], v[180:183]
    buffer_store_dwordx4 v[84:87], v2, s[32:35], s81 offen offset:1024 sc1
    v_mfma_f32_16x16x32_bf16 v[176:179], a[204:207], a[16:19], v[176:179]
    v_cvt_pk_bf16_f32 v88, v88, v89
    v_cvt_pk_bf16_f32 v89, v90, v91
    v_mfma_f32_16x16x32_bf16 v[112:115], a[200:203], a[16:19], v[112:115]
    s_waitcnt lgkmcnt(2)
    v_cvt_pk_bf16_f32 v90, v104, v105
    v_cvt_pk_bf16_f32 v91, v106, v107
    v_mfma_f32_16x16x32_bf16 v[112:115], a[208:211], a[32:35], v[112:115]
    ds_read_b128 a[192:195], v30 offset:8192
    v_mfma_f32_16x16x32_bf16 v[176:179], a[212:215], a[32:35], v[176:179]
    buffer_store_dwordx4 v[88:91], v2, s[32:35], s81 offen offset:2048 sc1
    v_mfma_f32_16x16x32_bf16 v[180:183], a[212:215], a[36:39], v[180:183]
    v_cvt_pk_bf16_f32 v92, v92, v93
    v_cvt_pk_bf16_f32 v93, v94, v95
    v_mfma_f32_16x16x32_bf16 v[116:119], a[208:211], a[36:39], v[116:119]
    ds_read_b128 a[196:199], v30 offset:10240
    v_cvt_pk_bf16_f32 v94, v108, v109
    v_mfma_f32_16x16x32_bf16 v[120:123], a[208:211], a[40:43], v[120:123]
    v_cvt_pk_bf16_f32 v95, v110, v111
    v_mfma_f32_16x16x32_bf16 v[184:187], a[212:215], a[40:43], v[184:187]
    buffer_store_dwordx4 v[92:95], v2, s[32:35], s81 offen offset:3072 sc1
    v_mfma_f32_16x16x32_bf16 v[188:191], a[212:215], a[44:47], v[188:191]
    v_mfma_f32_16x16x32_bf16 v[124:127], a[208:211], a[44:47], v[124:127]
    s_waitcnt lgkmcnt(2)
    v_mfma_f32_16x16x32_bf16 v[124:127], a[216:219], a[60:63], v[124:127]
    ds_read_b128 a[200:203], v30 offset:24576
    v_mfma_f32_16x16x32_bf16 v[188:191], a[220:223], a[60:63], v[188:191]
    v_mfma_f32_16x16x32_bf16 v[184:187], a[220:223], a[56:59], v[184:187]
    v_mfma_f32_16x16x32_bf16 v[120:123], a[216:219], a[56:59], v[120:123]
    ds_read_b128 a[204:207], v30 offset:26624
    v_mfma_f32_16x16x32_bf16 v[116:119], a[216:219], a[52:55], v[116:119]
    v_mfma_f32_16x16x32_bf16 v[180:183], a[220:223], a[52:55], v[180:183]
    v_mfma_f32_16x16x32_bf16 v[176:179], a[220:223], a[48:51], v[176:179]
    v_mfma_f32_16x16x32_bf16 v[112:115], a[216:219], a[48:51], v[112:115]
    s_waitcnt lgkmcnt(2)
    v_mfma_f32_16x16x32_bf16 v[112:115], a[192:195], a[64:67], v[112:115]
    ds_read_b128 a[208:211], v31 offset:8192
    v_mfma_f32_16x16x32_bf16 v[176:179], a[196:199], a[64:67], v[176:179]
    v_mfma_f32_16x16x32_bf16 v[180:183], a[196:199], a[68:71], v[180:183]
    v_mfma_f32_16x16x32_bf16 v[116:119], a[192:195], a[68:71], v[116:119]
    ds_read_b128 a[212:215], v31 offset:10240
    v_mfma_f32_16x16x32_bf16 v[120:123], a[192:195], a[72:75], v[120:123]
    v_mfma_f32_16x16x32_bf16 v[184:187], a[196:199], a[72:75], v[184:187]
    v_mfma_f32_16x16x32_bf16 v[188:191], a[196:199], a[76:79], v[188:191]
    v_mfma_f32_16x16x32_bf16 v[124:127], a[192:195], a[76:79], v[124:127]
    s_waitcnt lgkmcnt(2)
    v_mfma_f32_16x16x32_bf16 v[124:127], a[200:203], a[92:95], v[124:127]
    ds_read_b128 a[216:219], v31 offset:24576
    v_mfma_f32_16x16x32_bf16 v[188:191], a[204:207], a[92:95], v[188:191]
    v_mfma_f32_16x16x32_bf16 v[184:187], a[204:207], a[88:91], v[184:187]
    v_mfma_f32_16x16x32_bf16 v[120:123], a[200:203], a[88:91], v[120:123]
    ds_read_b128 a[220:223], v31 offset:26624
    v_mfma_f32_16x16x32_bf16 v[116:119], a[200:203], a[84:87], v[116:119]
    v_mfma_f32_16x16x32_bf16 v[180:183], a[204:207], a[84:87], v[180:183]
    v_mfma_f32_16x16x32_bf16 v[176:179], a[204:207], a[80:83], v[176:179]
    v_mfma_f32_16x16x32_bf16 v[112:115], a[200:203], a[80:83], v[112:115]
    s_waitcnt lgkmcnt(2)
    v_mfma_f32_16x16x32_bf16 v[112:115], a[208:211], a[96:99], v[112:115]
    ds_read_b128 a[192:195], v28 offset:45056
    v_mfma_f32_16x16x32_bf16 v[176:179], a[212:215], a[96:99], v[176:179]
    v_mfma_f32_16x16x32_bf16 v[180:183], a[212:215], a[100:103], v[180:183]
    v_mfma_f32_16x16x32_bf16 v[116:119], a[208:211], a[100:103], v[116:119]
    ds_read_b128 a[196:199], v28 offset:47104
    v_mfma_f32_16x16x32_bf16 v[120:123], a[208:211], a[104:107], v[120:123]
    v_mfma_f32_16x16x32_bf16 v[184:187], a[212:215], a[104:107], v[184:187]
    v_mfma_f32_16x16x32_bf16 v[188:191], a[212:215], a[108:111], v[188:191]
    v_mfma_f32_16x16x32_bf16 v[124:127], a[208:211], a[108:111], v[124:127]
    s_waitcnt lgkmcnt(2)
    v_mfma_f32_16x16x32_bf16 v[124:127], a[216:219], a[124:127], v[124:127]
    ds_read_b128 a[200:203], v28 offset:61440
    v_mfma_f32_16x16x32_bf16 v[188:191], a[220:223], a[124:127], v[188:191]
    v_mfma_f32_16x16x32_bf16 v[184:187], a[220:223], a[120:123], v[184:187]
    v_mfma_f32_16x16x32_bf16 v[120:123], a[216:219], a[120:123], v[120:123]
    ds_read_b128 a[204:207], v28 offset:63488
    v_mfma_f32_16x16x32_bf16 v[116:119], a[216:219], a[116:119], v[116:119]
    v_mfma_f32_16x16x32_bf16 v[180:183], a[220:223], a[116:119], v[180:183]
    v_mfma_f32_16x16x32_bf16 v[176:179], a[220:223], a[112:115], v[176:179]
    v_mfma_f32_16x16x32_bf16 v[112:115], a[216:219], a[112:115], v[112:115]
    s_waitcnt lgkmcnt(2)
    v_mfma_f32_16x16x32_bf16 v[192:195], a[192:195], a[0:3], v[192:195]
    ds_read_b128 a[208:211], v29 offset:45056
    v_mfma_f32_16x16x32_bf16 v[240:243], a[196:199], a[0:3], v[240:243]
    v_mfma_f32_16x16x32_bf16 v[244:247], a[196:199], a[4:7], v[244:247]
    v_mfma_f32_16x16x32_bf16 v[196:199], a[192:195], a[4:7], v[196:199]
    ds_read_b128 a[212:215], v29 offset:47104
    v_mfma_f32_16x16x32_bf16 v[200:203], a[192:195], a[8:11], v[200:203]
    v_mfma_f32_16x16x32_bf16 v[248:251], a[196:199], a[8:11], v[248:251]
    v_mfma_f32_16x16x32_bf16 v[252:255], a[196:199], a[12:15], v[252:255]
    v_cvt_pk_bf16_f32 v112, v112, v113
    v_cvt_pk_bf16_f32 v113, v114, v115
    v_mfma_f32_16x16x32_bf16 v[204:207], a[192:195], a[12:15], v[204:207]
    s_waitcnt lgkmcnt(2)
    v_cvt_pk_bf16_f32 v114, v176, v177
    v_cvt_pk_bf16_f32 v115, v178, v179
    v_mfma_f32_16x16x32_bf16 v[204:207], a[200:203], a[28:31], v[204:207]
    ds_read_b128 a[216:219], v29 offset:61440
    v_mfma_f32_16x16x32_bf16 v[252:255], a[204:207], a[28:31], v[252:255]
    buffer_store_dwordx4 v[112:115], v2, s[32:35], s83 offen offset:0 sc1
    v_mfma_f32_16x16x32_bf16 v[248:251], a[204:207], a[24:27], v[248:251]
    v_cvt_pk_bf16_f32 v116, v116, v117
    v_cvt_pk_bf16_f32 v117, v118, v119
    v_mfma_f32_16x16x32_bf16 v[200:203], a[200:203], a[24:27], v[200:203]
    ds_read_b128 a[220:223], v29 offset:63488
    v_cvt_pk_bf16_f32 v118, v180, v181
    v_mfma_f32_16x16x32_bf16 v[196:199], a[200:203], a[20:23], v[196:199]
    v_cvt_pk_bf16_f32 v119, v182, v183
    v_mfma_f32_16x16x32_bf16 v[244:247], a[204:207], a[20:23], v[244:247]
    buffer_store_dwordx4 v[116:119], v2, s[32:35], s83 offen offset:1024 sc1
    v_mfma_f32_16x16x32_bf16 v[240:243], a[204:207], a[16:19], v[240:243]
    v_cvt_pk_bf16_f32 v120, v120, v121
    v_cvt_pk_bf16_f32 v121, v122, v123
    v_mfma_f32_16x16x32_bf16 v[192:195], a[200:203], a[16:19], v[192:195]
    s_waitcnt lgkmcnt(2)
    v_cvt_pk_bf16_f32 v122, v184, v185
    v_cvt_pk_bf16_f32 v123, v186, v187
    v_mfma_f32_16x16x32_bf16 v[192:195], a[208:211], a[32:35], v[192:195]
    ds_read_b128 a[192:195], v30 offset:12288
    v_mfma_f32_16x16x32_bf16 v[240:243], a[212:215], a[32:35], v[240:243]
    buffer_store_dwordx4 v[120:123], v2, s[32:35], s83 offen offset:2048 sc1
    v_mfma_f32_16x16x32_bf16 v[244:247], a[212:215], a[36:39], v[244:247]
    v_cvt_pk_bf16_f32 v124, v124, v125
    v_cvt_pk_bf16_f32 v125, v126, v127
    v_mfma_f32_16x16x32_bf16 v[196:199], a[208:211], a[36:39], v[196:199]
    ds_read_b128 a[196:199], v30 offset:14336
    v_cvt_pk_bf16_f32 v126, v188, v189
    v_mfma_f32_16x16x32_bf16 v[200:203], a[208:211], a[40:43], v[200:203]
    v_cvt_pk_bf16_f32 v127, v190, v191
    v_mfma_f32_16x16x32_bf16 v[248:251], a[212:215], a[40:43], v[248:251]
    buffer_store_dwordx4 v[124:127], v2, s[32:35], s83 offen offset:3072 sc1
    v_mfma_f32_16x16x32_bf16 v[252:255], a[212:215], a[44:47], v[252:255]
    s_waitcnt vmcnt(4)
    buffer_store_dword v43, v45, s[36:39], s82 offen offset:0 sc1
    v_mfma_f32_16x16x32_bf16 v[204:207], a[208:211], a[44:47], v[204:207]
    s_waitcnt lgkmcnt(2)
    v_mfma_f32_16x16x32_bf16 v[204:207], a[216:219], a[60:63], v[204:207]
    ds_read_b128 a[200:203], v30 offset:28672
    v_mfma_f32_16x16x32_bf16 v[252:255], a[220:223], a[60:63], v[252:255]
    v_mfma_f32_16x16x32_bf16 v[248:251], a[220:223], a[56:59], v[248:251]
    v_mfma_f32_16x16x32_bf16 v[200:203], a[216:219], a[56:59], v[200:203]
    ds_read_b128 a[204:207], v30 offset:30720
    v_mfma_f32_16x16x32_bf16 v[196:199], a[216:219], a[52:55], v[196:199]
    v_mfma_f32_16x16x32_bf16 v[244:247], a[220:223], a[52:55], v[244:247]
    v_mfma_f32_16x16x32_bf16 v[240:243], a[220:223], a[48:51], v[240:243]
    v_mfma_f32_16x16x32_bf16 v[192:195], a[216:219], a[48:51], v[192:195]
    s_waitcnt lgkmcnt(2)
    v_mfma_f32_16x16x32_bf16 v[192:195], a[192:195], a[64:67], v[192:195]
    ds_read_b128 a[208:211], v31 offset:12288
    v_mfma_f32_16x16x32_bf16 v[240:243], a[196:199], a[64:67], v[240:243]
    v_mfma_f32_16x16x32_bf16 v[244:247], a[196:199], a[68:71], v[244:247]
    v_mfma_f32_16x16x32_bf16 v[196:199], a[192:195], a[68:71], v[196:199]
    ds_read_b128 a[212:215], v31 offset:14336
    v_mfma_f32_16x16x32_bf16 v[200:203], a[192:195], a[72:75], v[200:203]
    v_mfma_f32_16x16x32_bf16 v[248:251], a[196:199], a[72:75], v[248:251]
    v_mfma_f32_16x16x32_bf16 v[252:255], a[196:199], a[76:79], v[252:255]
    v_mfma_f32_16x16x32_bf16 v[204:207], a[192:195], a[76:79], v[204:207]
    s_waitcnt lgkmcnt(2)
    v_mfma_f32_16x16x32_bf16 v[204:207], a[200:203], a[92:95], v[204:207]
    ds_read_b128 a[216:219], v31 offset:28672
    v_mfma_f32_16x16x32_bf16 v[252:255], a[204:207], a[92:95], v[252:255]
    v_mfma_f32_16x16x32_bf16 v[248:251], a[204:207], a[88:91], v[248:251]
    v_mfma_f32_16x16x32_bf16 v[200:203], a[200:203], a[88:91], v[200:203]
    ds_read_b128 a[220:223], v31 offset:30720
    v_mfma_f32_16x16x32_bf16 v[196:199], a[200:203], a[84:87], v[196:199]
    v_mfma_f32_16x16x32_bf16 v[244:247], a[204:207], a[84:87], v[244:247]
    v_mfma_f32_16x16x32_bf16 v[240:243], a[204:207], a[80:83], v[240:243]
    v_mfma_f32_16x16x32_bf16 v[192:195], a[200:203], a[80:83], v[192:195]
    s_waitcnt lgkmcnt(2)
    v_mfma_f32_16x16x32_bf16 v[192:195], a[208:211], a[96:99], v[192:195]
    ds_read_b128 a[192:195], v28 offset:0
    v_mfma_f32_16x16x32_bf16 v[240:243], a[212:215], a[96:99], v[240:243]
    v_mfma_f32_16x16x32_bf16 v[244:247], a[212:215], a[100:103], v[244:247]
    v_mfma_f32_16x16x32_bf16 v[196:199], a[208:211], a[100:103], v[196:199]
    ds_read_b128 a[196:199], v28 offset:2048
    v_mfma_f32_16x16x32_bf16 v[200:203], a[208:211], a[104:107], v[200:203]
    v_mfma_f32_16x16x32_bf16 v[248:251], a[212:215], a[104:107], v[248:251]
    v_mfma_f32_16x16x32_bf16 v[252:255], a[212:215], a[108:111], v[252:255]
    v_mfma_f32_16x16x32_bf16 v[204:207], a[208:211], a[108:111], v[204:207]
LF_pad13:
    s_cbranch_execz LF_walked
    s_waitcnt lgkmcnt(2)
    v_mfma_f32_16x16x32_bf16 v[204:207], a[216:219], a[124:127], v[204:207]
    ds_read_b128 a[200:203], v28 offset:16384
    v_mfma_f32_16x16x32_bf16 v[252:255], a[220:223], a[124:127], v[252:255]
    v_mfma_f32_16x16x32_bf16 v[248:251], a[220:223], a[120:123], v[248:251]
    v_mfma_f32_16x16x32_bf16 v[200:203], a[216:219], a[120:123], v[200:203]
    ds_read_b128 a[204:207], v28 offset:18432
    v_mfma_f32_16x16x32_bf16 v[196:199], a[216:219], a[116:119], v[196:199]
    v_mfma_f32_16x16x32_bf16 v[244:247], a[220:223], a[116:119], v[244:247]
    buffer_load_dword v38, v45, s[36:39], s57 offen offset:0 sc1
    v_mfma_f32_16x16x32_bf16 v[240:243], a[220:223], a[112:115], v[240:243]
    v_mfma_f32_16x16x32_bf16 v[192:195], a[216:219], a[112:115], v[192:195]
    s_waitcnt lgkmcnt(2)
    v_mfma_f32_16x16x32_bf16 v[48:51], a[192:195], a[128:131], v[48:51]
    ds_read_b128 a[208:211], v29 offset:0
    v_mfma_f32_16x16x32_bf16 v[64:67], a[196:199], a[128:131], v[64:67]
    v_mfma_f32_16x16x32_bf16 v[68:71], a[196:199], a[132:135], v[68:71]
    v_mfma_f32_16x16x32_bf16 v[52:55], a[192:195], a[132:135], v[52:55]
    ds_read_b128 a[212:215], v29 offset:2048
    v_mfma_f32_16x16x32_bf16 v[56:59], a[192:195], a[136:139], v[56:59]
    v_mfma_f32_16x16x32_bf16 v[72:75], a[196:199], a[136:139], v[72:75]
    v_mfma_f32_16x16x32_bf16 v[76:79], a[196:199], a[140:143], v[76:79]
    v_cvt_pk_bf16_f32 v192, v192, v193
    v_cvt_pk_bf16_f32 v193, v194, v195
    v_mfma_f32_16x16x32_bf16 v[60:63], a[192:195], a[140:143], v[60:63]
    s_waitcnt lgkmcnt(2)
    v_cvt_pk_bf16_f32 v194, v240, v241
    v_cvt_pk_bf16_f32 v195, v242, v243
    v_mfma_f32_16x16x32_bf16 v[60:63], a[200:203], a[156:159], v[60:63]
    ds_read_b128 a[216:219], v29 offset:16384
    v_mfma_f32_16x16x32_bf16 v[76:79], a[204:207], a[156:159], v[76:79]
    buffer_store_dwordx4 v[192:195], v2, s[32:35], s85 offen offset:0 sc1
    v_mfma_f32_16x16x32_bf16 v[72:75], a[204:207], a[152:155], v[72:75]
    v_cvt_pk_bf16_f32 v196, v196, v197
    v_cvt_pk_bf16_f32 v197, v198, v199
    v_mfma_f32_16x16x32_bf16 v[56:59], a[200:203], a[152:155], v[56:59]
    ds_read_b128 a[220:223], v29 offset:18432
    v_cvt_pk_bf16_f32 v198, v244, v245
    v_mfma_f32_16x16x32_bf16 v[52:55], a[200:203], a[148:151], v[52:55]
    v_cvt_pk_bf16_f32 v199, v246, v247
    v_mfma_f32_16x16x32_bf16 v[68:71], a[204:207], a[148:151], v[68:71]
    buffer_store_dwordx4 v[196:199], v2, s[32:35], s85 offen offset:1024 sc1
    v_mfma_f32_16x16x32_bf16 v[64:67], a[204:207], a[144:147], v[64:67]
    v_cvt_pk_bf16_f32 v200, v200, v201
    v_cvt_pk_bf16_f32 v201, v202, v203
    v_mfma_f32_16x16x32_bf16 v[48:51], a[200:203], a[144:147], v[48:51]
    s_waitcnt lgkmcnt(2)
    v_cvt_pk_bf16_f32 v202, v248, v249
    v_cvt_pk_bf16_f32 v203, v250, v251
    v_mfma_f32_16x16x32_bf16 v[48:51], a[208:211], a[160:163], v[48:51]
    ds_read_b128 a[192:195], v28 offset:32768
    v_mfma_f32_16x16x32_bf16 v[64:67], a[212:215], a[160:163], v[64:67]
    buffer_store_dwordx4 v[200:203], v2, s[32:35], s85 offen offset:2048 sc1
    v_mfma_f32_16x16x32_bf16 v[68:71], a[212:215], a[164:167], v[68:71]
    v_cvt_pk_bf16_f32 v204, v204, v205
    v_cvt_pk_bf16_f32 v205, v206, v207
    v_mfma_f32_16x16x32_bf16 v[52:55], a[208:211], a[164:167], v[52:55]
    ds_read_b128 a[196:199], v28 offset:34816
    v_cvt_pk_bf16_f32 v206, v252, v253
    v_mfma_f32_16x16x32_bf16 v[56:59], a[208:211], a[168:171], v[56:59]
    v_cvt_pk_bf16_f32 v207, v254, v255
    v_mfma_f32_16x16x32_bf16 v[72:75], a[212:215], a[168:171], v[72:75]
    buffer_store_dwordx4 v[204:207], v2, s[32:35], s85 offen offset:3072 sc1
    v_mfma_f32_16x16x32_bf16 v[76:79], a[212:215], a[172:175], v[76:79]
    s_waitcnt vmcnt(6)
    buffer_store_dword v43, v45, s[36:39], s84 offen offset:4 sc1
    v_mfma_f32_16x16x32_bf16 v[60:63], a[208:211], a[172:175], v[60:63]
    s_waitcnt lgkmcnt(2)
    v_mfma_f32_16x16x32_bf16 v[60:63], a[216:219], a[188:191], v[60:63]
    ds_read_b128 a[200:203], v28 offset:49152
    v_mfma_f32_16x16x32_bf16 v[76:79], a[220:223], a[188:191], v[76:79]
    v_mfma_f32_16x16x32_bf16 v[72:75], a[220:223], a[184:187], v[72:75]
    v_mfma_f32_16x16x32_bf16 v[56:59], a[216:219], a[184:187], v[56:59]
    ds_read_b128 a[204:207], v28 offset:51200
    v_mfma_f32_16x16x32_bf16 v[52:55], a[216:219], a[180:183], v[52:55]
    v_mfma_f32_16x16x32_bf16 v[68:71], a[220:223], a[180:183], v[68:71]
    v_mfma_f32_16x16x32_bf16 v[64:67], a[220:223], a[176:179], v[64:67]
    v_mfma_f32_16x16x32_bf16 v[48:51], a[216:219], a[176:179], v[48:51]
    s_waitcnt lgkmcnt(2)
    v_mfma_f32_16x16x32_bf16 v[48:51], a[192:195], a[0:3], v[48:51]
    ds_read_b128 a[208:211], v29 offset:32768
    v_mfma_f32_16x16x32_bf16 v[64:67], a[196:199], a[0:3], v[64:67]
    v_mfma_f32_16x16x32_bf16 v[68:71], a[196:199], a[4:7], v[68:71]
    v_mfma_f32_16x16x32_bf16 v[52:55], a[192:195], a[4:7], v[52:55]
    ds_read_b128 a[212:215], v29 offset:34816
    v_mfma_f32_16x16x32_bf16 v[56:59], a[192:195], a[8:11], v[56:59]
    v_mfma_f32_16x16x32_bf16 v[72:75], a[196:199], a[8:11], v[72:75]
    v_mfma_f32_16x16x32_bf16 v[76:79], a[196:199], a[12:15], v[76:79]
    v_mfma_f32_16x16x32_bf16 v[60:63], a[192:195], a[12:15], v[60:63]
    s_waitcnt lgkmcnt(2)
    s_waitcnt vmcnt(5)
    v_cmp_ne_u32 vcc, s80, v38
    v_mfma_f32_16x16x32_bf16 v[60:63], a[200:203], a[28:31], v[60:63]
    s_cbranch_vccnz LF_rx0_spin
LF_rx0_back:
    ds_read_b128 a[216:219], v29 offset:49152
    v_mfma_f32_16x16x32_bf16 v[76:79], a[204:207], a[28:31], v[76:79]
    buffer_load_dwordx4 v[128:131], v2, s[32:35], s58 offen offset:0 sc1
    v_mfma_f32_16x16x32_bf16 v[72:75], a[204:207], a[24:27], v[72:75]
    buffer_load_dwordx4 v[132:135], v2, s[32:35], s58 offen offset:1024 sc1
    v_mfma_f32_16x16x32_bf16 v[56:59], a[200:203], a[24:27], v[56:59]
    ds_read_b128 a[220:223], v29 offset:51200
    v_mfma_f32_16x16x32_bf16 v[52:55], a[200:203], a[20:23], v[52:55]
    buffer_load_dwordx4 v[136:139], v2, s[32:35], s58 offen offset:2048 sc1
    v_mfma_f32_16x16x32_bf16 v[68:71], a[204:207], a[20:23], v[68:71]
    buffer_load_dwordx4 v[140:143], v2, s[32:35], s58 offen offset:3072 sc1
    v_mfma_f32_16x16x32_bf16 v[64:67], a[204:207], a[16:19], v[64:67]
    v_mfma_f32_16x16x32_bf16 v[48:51], a[200:203], a[16:19], v[48:51]
    s_waitcnt lgkmcnt(2)
    v_mfma_f32_16x16x32_bf16 v[48:51], a[208:211], a[32:35], v[48:51]
    ds_read_b128 a[192:195], v30 offset:0
    v_mfma_f32_16x16x32_bf16 v[64:67], a[212:215], a[32:35], v[64:67]
    v_mfma_f32_16x16x32_bf16 v[68:71], a[212:215], a[36:39], v[68:71]
    v_mfma_f32_16x16x32_bf16 v[52:55], a[208:211], a[36:39], v[52:55]
    ds_read_b128 a[196:199], v30 offset:2048
    v_mfma_f32_16x16x32_bf16 v[56:59], a[208:211], a[40:43], v[56:59]
    v_mfma_f32_16x16x32_bf16 v[72:75], a[212:215], a[40:43], v[72:75]
    v_mfma_f32_16x16x32_bf16 v[76:79], a[212:215], a[44:47], v[76:79]
    v_mfma_f32_16x16x32_bf16 v[60:63], a[208:211], a[44:47], v[60:63]
    s_waitcnt lgkmcnt(2)
    buffer_load_dword v39, v45, s[36:39], s57 offen offset:4 sc1
    v_mfma_f32_16x16x32_bf16 v[60:63], a[216:219], a[60:63], v[60:63]
    ds_read_b128 a[200:203], v30 offset:16384
    v_mfma_f32_16x16x32_bf16 v[76:79], a[220:223], a[60:63], v[76:79]
    v_mfma_f32_16x16x32_bf16 v[72:75], a[220:223], a[56:59], v[72:75]
    v_mfma_f32_16x16x32_bf16 v[56:59], a[216:219], a[56:59], v[56:59]
    ds_read_b128 a[204:207], v30 offset:18432
    v_mfma_f32_16x16x32_bf16 v[52:55], a[216:219], a[52:55], v[52:55]
    v_mfma_f32_16x16x32_bf16 v[68:71], a[220:223], a[52:55], v[68:71]
    v_mfma_f32_16x16x32_bf16 v[64:67], a[220:223], a[48:51], v[64:67]
    v_mfma_f32_16x16x32_bf16 v[48:51], a[216:219], a[48:51], v[48:51]
    s_waitcnt lgkmcnt(2)
    v_mfma_f32_16x16x32_bf16 v[48:51], a[192:195], a[64:67], v[48:51]
    ds_read_b128 a[208:211], v31 offset:0
    v_mfma_f32_16x16x32_bf16 v[64:67], a[196:199], a[64:67], v[64:67]
    v_mfma_f32_16x16x32_bf16 v[68:71], a[196:199], a[68:71], v[68:71]
    v_mfma_f32_16x16x32_bf16 v[52:55], a[192:195], a[68:71], v[52:55]
    ds_read_b128 a[212:215], v31 offset:2048
    v_mfma_f32_16x16x32_bf16 v[56:59], a[192:195], a[72:75], v[56:59]
    v_mfma_f32_16x16x32_bf16 v[72:75], a[196:199], a[72:75], v[72:75]
    v_mfma_f32_16x16x32_bf16 v[76:79], a[196:199], a[76:79], v[76:79]
    v_mfma_f32_16x16x32_bf16 v[60:63], a[192:195], a[76:79], v[60:63]
    s_waitcnt lgkmcnt(2)
    v_mfma_f32_16x16x32_bf16 v[60:63], a[200:203], a[92:95], v[60:63]
    ds_read_b128 a[216:219], v31 offset:16384
    v_mfma_f32_16x16x32_bf16 v[76:79], a[204:207], a[92:95], v[76:79]
    v_mfma_f32_16x16x32_bf16 v[72:75], a[204:207], a[88:91], v[72:75]
    v_mfma_f32_16x16x32_bf16 v[56:59], a[200:203], a[88:91], v[56:59]
    ds_read_b128 a[220:223], v31 offset:18432
    v_mfma_f32_16x16x32_bf16 v[52:55], a[200:203], a[84:87], v[52:55]
    v_mfma_f32_16x16x32_bf16 v[68:71], a[204:207], a[84:87], v[68:71]
    v_mfma_f32_16x16x32_bf16 v[64:67], a[204:207], a[80:83], v[64:67]
    v_mfma_f32_16x16x32_bf16 v[48:51], a[200:203], a[80:83], v[48:51]
    s_waitcnt lgkmcnt(2)
    v_mfma_f32_16x16x32_bf16 v[48:51], a[208:211], a[96:99], v[48:51]
    v_mfma_f32_16x16x32_bf16 v[64:67], a[212:215], a[96:99], v[64:67]
    v_mfma_f32_16x16x32_bf16 v[68:71], a[212:215], a[100:103], v[68:71]
    v_mfma_f32_16x16x32_bf16 v[52:55], a[208:211], a[100:103], v[52:55]
    v_mfma_f32_16x16x32_bf16 v[56:59], a[208:211], a[104:107], v[56:59]
    v_mfma_f32_16x16x32_bf16 v[72:75], a[212:215], a[104:107], v[72:75]
    s_waitcnt vmcnt(6)
    buffer_store_dword v43, v45, s[36:39], s86 offen offset:8 sc1
    v_mfma_f32_16x16x32_bf16 v[76:79], a[212:215], a[108:111], v[76:79]
    v_mfma_f32_16x16x32_bf16 v[60:63], a[208:211], a[108:111], v[60:63]
    s_waitcnt lgkmcnt(0)
    v_mfma_f32_16x16x32_bf16 v[60:63], a[216:219], a[124:127], v[60:63]
    v_mfma_f32_16x16x32_bf16 v[76:79], a[220:223], a[124:127], v[76:79]
    v_mfma_f32_16x16x32_bf16 v[72:75], a[220:223], a[120:123], v[72:75]
    v_mfma_f32_16x16x32_bf16 v[56:59], a[216:219], a[120:123], v[56:59]
    v_mfma_f32_16x16x32_bf16 v[52:55], a[216:219], a[116:119], v[52:55]
    v_mfma_f32_16x16x32_bf16 v[68:71], a[220:223], a[116:119], v[68:71]
    v_mfma_f32_16x16x32_bf16 v[64:67], a[220:223], a[112:115], v[64:67]
    v_mfma_f32_16x16x32_bf16 v[48:51], a[216:219], a[112:115], v[48:51]
    s_waitcnt vmcnt(5)
    buffer_load_dword v46, v45, s[36:39], s57 offen offset:8 sc1
    s_waitcnt vmcnt(2)
    v_cmp_ne_u32 vcc, s80, v39
    s_nop 0
    s_cbranch_vccnz LF_rx1_spin
LF_rx1_back:
    s_nop 0
    buffer_load_dwordx4 v[144:147], v2, s[32:35], s59 offen offset:0 sc1
    buffer_load_dwordx4 v[148:151], v2, s[32:35], s59 offen offset:1024 sc1
    buffer_load_dwordx4 v[152:155], v2, s[32:35], s59 offen offset:2048 sc1
    buffer_load_dwordx4 v[156:159], v2, s[32:35], s59 offen offset:3072 sc1
    s_waitcnt vmcnt(4)
    v_cmp_ne_u32 vcc, s80, v46
    s_nop 0
    s_cbranch_vccnz LF_rx2_spin
LF_rx2_back:
    buffer_load_dwordx4 v[160:163], v2, s[32:35], s63 offen offset:0 sc1
    buffer_load_dwordx4 v[164:167], v2, s[32:35], s63 offen offset:1024 sc1
    buffer_load_dwordx4 v[168:171], v2, s[32:35], s63 offen offset:2048 sc1
    buffer_load_dwordx4 v[172:175], v2, s[32:35], s63 offen offset:3072 sc1
    v_mfma_f32_16x16x32_bf16 v[48:51], v[34:37], v[128:131], v[48:51]
    v_mfma_f32_16x16x32_bf16 v[64:67], v[32:35], v[128:131], v[64:67]
    v_mfma_f32_16x16x32_bf16 v[52:55], v[34:37], v[132:135], v[52:55]
    v_mfma_f32_16x16x32_bf16 v[68:71], v[32:35], v[132:135], v[68:71]
    v_mfma_f32_16x16x32_bf16 v[56:59], v[34:37], v[136:139], v[56:59]
    v_mfma_f32_16x16x32_bf16 v[72:75], v[32:35], v[136:139], v[72:75]
    v_mfma_f32_16x16x32_bf16 v[60:63], v[34:37], v[140:143], v[60:63]
    v_mfma_f32_16x16x32_bf16 v[76:79], v[32:35], v[140:143], v[76:79]
    s_waitcnt vmcnt(7)
    v_mfma_f32_16x16x32_bf16 v[48:51], v[34:37], v[144:147], v[48:51]
    v_mfma_f32_16x16x32_bf16 v[64:67], v[32:35], v[144:147], v[64:67]
    s_waitcnt vmcnt(6)
    v_mfma_f32_16x16x32_bf16 v[52:55], v[34:37], v[148:151], v[52:55]
    v_mfma_f32_16x16x32_bf16 v[68:71], v[32:35], v[148:151], v[68:71]
    s_waitcnt vmcnt(5)
    v_mfma_f32_16x16x32_bf16 v[56:59], v[34:37], v[152:155], v[56:59]
    v_mfma_f32_16x16x32_bf16 v[72:75], v[32:35], v[152:155], v[72:75]
    s_waitcnt vmcnt(4)
    v_mfma_f32_16x16x32_bf16 v[60:63], v[34:37], v[156:159], v[60:63]
    v_mfma_f32_16x16x32_bf16 v[76:79], v[32:35], v[156:159], v[76:79]
    s_waitcnt vmcnt(3)
    v_mfma_f32_16x16x32_bf16 v[48:51], v[34:37], v[160:163], v[48:51]
    v_mfma_f32_16x16x32_bf16 v[64:67], v[32:35], v[160:163], v[64:67]
    s_waitcnt vmcnt(2)
    v_mfma_f32_16x16x32_bf16 v[52:55], v[34:37], v[164:167], v[52:55]
    v_mfma_f32_16x16x32_bf16 v[68:71], v[32:35], v[164:167], v[68:71]
    s_waitcnt vmcnt(1)
    v_mfma_f32_16x16x32_bf16 v[56:59], v[34:37], v[168:171], v[56:59]
    v_mfma_f32_16x16x32_bf16 v[72:75], v[32:35], v[168:171], v[72:75]
    s_waitcnt vmcnt(0)
    v_mfma_f32_16x16x32_bf16 v[60:63], v[34:37], v[172:175], v[60:63]
    v_mfma_f32_16x16x32_bf16 v[76:79], v[32:35], v[172:175], v[76:79]
    s_nop 6
    s_nop 0
    v_pk_add_f32 v[48:49], v[48:49], v[208:209]
    v_pk_add_f32 v[50:51], v[50:51], v[210:211]
    buffer_store_dwordx4 v[48:51], v44, s[40:43], s56 offen offset:0 sc1
    v_pk_add_f32 v[64:65], v[64:65], v[224:225]
    v_pk_add_f32 v[66:67], v[66:67], v[226:227]
    buffer_store_dwordx4 v[64:67], v44, s[40:43], s56 offen offset:64 sc1
    s_add_u32 s56, s56, 4096
    v_pk_add_f32 v[52:53], v[52:53], v[212:213]
    v_pk_add_f32 v[54:55], v[54:55], v[214:215]
    buffer_store_dwordx4 v[52:55], v44, s[40:43], s56 offen offset:0 sc1
    v_pk_add_f32 v[68:69], v[68:69], v[228:229]
    v_pk_add_f32 v[70:71], v[70:71], v[230:231]
    buffer_store_dwordx4 v[68:71], v44, s[40:43], s56 offen offset:64 sc1
    s_add_u32 s56, s56, 4096
    v_pk_add_f32 v[56:57], v[56:57], v[216:217]
    v_pk_add_f32 v[58:59], v[58:59], v[218:219]
    buffer_store_dwordx4 v[56:59], v44, s[40:43], s56 offen offset:0 sc1
    v_pk_add_f32 v[72:73], v[72:73], v[232:233]
    v_pk_add_f32 v[74:75], v[74:75], v[234:235]
    buffer_store_dwordx4 v[72:75], v44, s[40:43], s56 offen offset:64 sc1
    s_add_u32 s56, s56, 4096
    v_pk_add_f32 v[60:61], v[60:61], v[220:221]
    v_pk_add_f32 v[62:63], v[62:63], v[222:223]
    buffer_store_dwordx4 v[60:63], v44, s[40:43], s56 offen offset:0 sc1
    v_pk_add_f32 v[76:77], v[76:77], v[236:237]
    v_pk_add_f32 v[78:79], v[78:79], v[238:239]
    buffer_store_dwordx4 v[76:79], v44, s[40:43], s56 offen offset:64 sc1
    s_endpgm
LF_lbspin:
    s_cmp_gt_u32 s85, 0x40000
    s_cbranch_scc1 LF_lbok
    buffer_load_dwordx4 v[192:195], v0, s[20:23], 0 offen offset:0 sc1
    buffer_load_dwordx4 v[196:199], v0, s[20:23], 0 offen offset:256 sc1
    buffer_load_dwordx4 v[200:203], v0, s[20:23], 0 offen offset:512 sc1
    buffer_load_dwordx4 v[204:207], v0, s[20:23], 0 offen offset:768 sc1
    buffer_load_dwordx4 v[208:211], v0, s[20:23], 0 offen offset:1024 sc1
    buffer_load_dwordx4 v[212:215], v0, s[20:23], 0 offen offset:1280 sc1
    buffer_load_dwordx4 v[216:219], v0, s[20:23], 0 offen offset:1536 sc1
    buffer_load_dwordx4 v[220:223], v0, s[20:23], 0 offen offset:1792 sc1
    s_waitcnt vmcnt(0)
    s_branch LF_lbchk
LF_c_spin:
    s_mov_b32 s87, 0
LF_c_loop:
    buffer_load_dwordx4 v[28:31], v2, s[36:39], s79 offen sc1
    s_add_u32 s87, s87, 1
    s_waitcnt vmcnt(0)
    v_min3_u32 v42, v28, v29, v30
    v_max3_u32 v43, v28, v29, v30
    v_min_u32 v42, v42, v31
    v_max_u32 v43, v43, v31
    v_cmp_ne_u32 s[84:85], s80, v42
    v_cmp_ne_u32 vcc, s80, v43
    s_or_b64 vcc, vcc, s[84:85]
    s_cmp_gt_u32 s87, 0x8000
    s_cbranch_scc1 LF_c_back
    s_cbranch_vccnz LF_c_loop
    s_branch LF_c_back
LF_cs_spin:
    s_mov_b32 s87, 0
LF_cs_loop:
    s_nop 0
    s_mul_i32 s81, s50, 448
    s_add_u32 s81, s81, 589824
    buffer_load_dwordx4 a[184:187], v62, s[36:39], s81 offen sc1
    s_add_u32 s81, s81, 28672
    buffer_load_dwordx4 a[188:191], v62, s[36:39], s81 offen sc1
    s_add_u32 s81, s81, 28672
    buffer_load_dwordx4 a[192:195], v62, s[36:39], s81 offen sc1
    s_add_u32 s81, s81, 28672
    buffer_load_dwordx4 a[196:199], v62, s[36:39], s81 offen sc1
    s_add_u32 s81, s81, 28672
    buffer_load_dwordx4 a[228:231], v62, s[36:39], s81 offen sc1
    s_add_u32 s81, s81, 28672
    buffer_load_dwordx4 a[232:235], v62, s[36:39], s81 offen sc1
    s_add_u32 s81, s81, 28672
    buffer_load_dwordx4 a[236:239], v62, s[36:39], s81 offen sc1
    s_add_u32 s81, s81, 28672
    buffer_load_dwordx4 a[240:243], v62, s[36:39], s81 offen sc1
    s_add_u32 s87, s87, 1
    s_waitcnt vmcnt(0)
    v_accvgpr_read_b32 v44, a184
    v_accvgpr_read_b32 v45, a185
    v_accvgpr_read_b32 v46, a186
    v_accvgpr_read_b32 v47, a187
    v_accvgpr_read_b32 v48, a188
    v_accvgpr_read_b32 v49, a189
    v_accvgpr_read_b32 v50, a190
    v_accvgpr_read_b32 v51, a191
    v_add_f32 v44, v44, v48
    v_add_f32 v45, v45, v49
    v_add_f32 v46, v46, v50
    v_add_f32 v47, v47, v51
    v_accvgpr_read_b32 v48, a192
    v_accvgpr_read_b32 v49, a193
    v_accvgpr_read_b32 v50, a194
    v_accvgpr_read_b32 v51, a195
    v_add_f32 v44, v44, v48
    v_add_f32 v45, v45, v49
    v_add_f32 v46, v46, v50
    v_add_f32 v47, v47, v51
    v_accvgpr_read_b32 v48, a196
    v_accvgpr_read_b32 v49, a197
    v_accvgpr_read_b32 v50, a198
    v_accvgpr_read_b32 v51, a199
    v_add_f32 v44, v44, v48
    v_add_f32 v45, v45, v49
    v_add_f32 v46, v46, v50
    v_add_f32 v47, v47, v51
    v_accvgpr_read_b32 v48, a228
    v_accvgpr_read_b32 v49, a229
    v_accvgpr_read_b32 v50, a230
    v_accvgpr_read_b32 v51, a231
    v_add_f32 v44, v44, v48
    v_add_f32 v45, v45, v49
    v_add_f32 v46, v46, v50
    v_add_f32 v47, v47, v51
    v_accvgpr_read_b32 v48, a232
    v_accvgpr_read_b32 v49, a233
    v_accvgpr_read_b32 v50, a234
    v_accvgpr_read_b32 v51, a235
    v_add_f32 v44, v44, v48
    v_add_f32 v45, v45, v49
    v_add_f32 v46, v46, v50
    v_add_f32 v47, v47, v51
    v_accvgpr_read_b32 v48, a236
    v_accvgpr_read_b32 v49, a237
    v_accvgpr_read_b32 v50, a238
    v_accvgpr_read_b32 v51, a239
    v_add_f32 v44, v44, v48
    v_add_f32 v45, v45, v49
    v_add_f32 v46, v46, v50
    v_add_f32 v47, v47, v51
    v_accvgpr_read_b32 v48, a240
    v_accvgpr_read_b32 v49, a241
    v_accvgpr_read_b32 v50, a242
    v_accvgpr_read_b32 v51, a243
    v_add_f32 v44, v44, v48
    v_add_f32 v45, v45, v49
    v_add_f32 v46, v46, v50
    v_add_f32 v47, v47, v51
    v_cmp_u_f32 s[82:83], v44, v45
    v_cmp_u_f32 vcc, v46, v47
    s_or_b64 vcc, vcc, s[82:83]
    s_cmp_gt_u32 s87, 0x8000
    s_cbranch_scc1 LF_cs_back
    s_cbranch_vccnz LF_cs_loop
    s_branch LF_cs_back
LF_fa_spin:
    s_mov_b32 s87, 0
LF_fa_loop:
    buffer_load_dword v38, v39, s[36:39], s61 offen sc1
    s_add_u32 s87, s87, 1
    s_waitcnt vmcnt(0)
    v_cmp_ne_u32 vcc, s80, v38
    s_cmp_gt_u32 s87, 0x8000
    s_cbranch_scc1 LF_fa_back
    s_cbranch_vccnz LF_fa_loop
    s_branch LF_fa_back
LF_fs_spin:
    s_mov_b32 s87, 0
LF_fs_loop:
    buffer_load_dword v38, v39, s[36:39], s61 offen offset:32 sc1
    s_add_u32 s87, s87, 1
    s_waitcnt vmcnt(0)
    v_cmp_ne_u32 vcc, s80, v38
    s_cmp_gt_u32 s87, 0x8000
    s_cbranch_scc1 LF_fs_back
    s_cbranch_vccnz LF_fs_loop
    s_branch LF_fs_back
LF_rx0_spin:
    s_mov_b32 s87, 0
LF_rx0_loop:
    buffer_load_dword v38, v45, s[36:39], s57 offen offset:0 sc1
    s_add_u32 s87, s87, 1
    s_waitcnt vmcnt(0)
    v_cmp_ne_u32 vcc, s80, v38
    s_cmp_gt_u32 s87, 0x8000
    s_cbranch_scc1 LF_rx0_back
    s_cbranch_vccnz LF_rx0_loop
    s_branch LF_rx0_back
LF_rx1_spin:
    s_mov_b32 s87, 0
LF_rx1_loop:
    buffer_load_dword v39, v45, s[36:39], s57 offen offset:4 sc1
    s_add_u32 s87, s87, 1
    s_waitcnt vmcnt(0)
    v_cmp_ne_u32 vcc, s80, v39
    s_cmp_gt_u32 s87, 0x8000
    s_cbranch_scc1 LF_rx1_back
    s_cbranch_vccnz LF_rx1_loop
    s_branch LF_rx1_back
LF_rx2_spin:
    s_mov_b32 s87, 0
LF_rx2_loop:
    buffer_load_dword v46, v45, s[36:39], s57 offen offset:8 sc1
    s_add_u32 s87, s87, 1
    s_waitcnt vmcnt(0)
    v_cmp_ne_u32 vcc, s80, v46
    s_cmp_gt_u32 s87, 0x8000
    s_cbranch_scc1 LF_rx2_back
    s_cbranch_vccnz LF_rx2_loop
    s_branch LF_rx2_back
LF_end:
    s_endpgm
.section .rodata,"a"
.p2align 6
.amdhsa_kernel parallel_sum__ssm_conv_s5__geglu_ffn__prompt_kernel
  .amdhsa_next_free_vgpr 512
  .amdhsa_next_free_sgpr 102
  .amdhsa_accum_offset 256
  .amdhsa_group_segment_fixed_size 0
  .amdhsa_kernarg_size 128
  .amdhsa_user_sgpr_count 2
  .amdhsa_user_sgpr_kernarg_segment_ptr 1
  .amdhsa_system_sgpr_workgroup_id_x 1
.end_amdhsa_kernel
```
